```python
import torch

def _softmax(x, axis=-1):
    return torch.softmax(x, dim=axis)

def _gelu(x):
    return torch.nn.functional.gelu(x, approximate='tanh')

def _silu(x):
    return torch.nn.functional.silu(x)

def _sigmoid(x):
    return torch.sigmoid(x)

def _layernorm(x, axis=-1, eps=1e-05):
    m = x.mean(dim=axis, keepdim=True)
    v = x.var(dim=axis, keepdim=True, unbiased=False)
    return (x - m) / torch.sqrt(v + eps)

def _scatter_add(tgt, idx, src, axis=0):
    return tgt.clone().index_add_(axis, idx, src)

def _segment_sum(src, seg, n):
    out = torch.zeros((n,) + src.shape[1:], dtype=src.dtype)
    return out.index_add_(0, seg, src)

def _pad(x, pw):
    flat = tuple((v for pair in reversed(pw) for v in pair))
    return torch.nn.functional.pad(x, flat)
kernel_name = 'concat_heads__memory_aug_recurrent_mem_tr__grouped_kv_mqa__prompt'

def setup_inputs():

    _w = lambda a: (lambda t: t.to(torch.bfloat16) if t.is_floating_point() else t)(torch.as_tensor(a))

    def _A_setup():
        B, S, Dm = (1, 2048, 576)
        H, Dh = (32, 128)
        M, seg = (8, 32)
        seg = min(seg, S)
        S = S // seg * seg
        return {'x': _w((lambda *s: torch.randn(*s, dtype=torch.bfloat16) * 0.05)(B, S, Dm)), 'mem0': _w((lambda *s: torch.randn(*s, dtype=torch.bfloat16) * 0.8)(B, M, Dm)), 'Wq': _w((lambda *s: torch.randn(*s, dtype=torch.bfloat16) * 1.6)(Dm, H, Dh) * Dm ** (-0.5)), 'Wk': _w((lambda *s: torch.randn(*s, dtype=torch.bfloat16) * 1.6)(Dm, H, Dh) * Dm ** (-0.5)), 'Wv': _w((lambda *s: torch.randn(*s, dtype=torch.bfloat16) * 0.8)(Dm, H, Dh) * Dm ** (-0.5)), 'Wo': _w((lambda *s: torch.randn(*s, dtype=torch.bfloat16) * 0.8)(H, Dh, Dm) * (H * Dh) ** (-0.5)), 'seg_len': seg}
    _A_in = _A_setup()

    def _B_setup():
        B, S, D, H = (1, 2048, 576, 32)
        Dh = D // H
        return {'x': _w((lambda *s: torch.randn(*s, dtype=torch.bfloat16) * 0.05)(B, S, D)), 'wq': _w((lambda *s: torch.randn(*s, dtype=torch.bfloat16) * 1.6)(D, H * Dh)), 'wk': _w((lambda *s: torch.randn(*s, dtype=torch.bfloat16) * 1.6)(D, Dh)), 'wv': _w((lambda *s: torch.randn(*s, dtype=torch.bfloat16) * 0.05)(D, Dh)), 'wo': _w((lambda *s: torch.randn(*s, dtype=torch.bfloat16) * 0.05)(H * Dh, D))}
    _B_in = _B_setup()
    return {'A_x': _A_in['x'], 'A_mem0': _A_in['mem0'], 'A_Wq': _A_in['Wq'], 'A_Wk': _A_in['Wk'], 'A_Wv': _A_in['Wv'], 'A_Wo': _A_in['Wo'], 'A_seg_len': _A_in['seg_len'], 'B_x': _B_in['x'], 'B_wq': _B_in['wq'], 'B_wk': _B_in['wk'], 'B_wv': _B_in['wv'], 'B_wo': _B_in['wo']}

def reference(A_x, A_mem0, A_Wq, A_Wk, A_Wv, A_Wo, A_seg_len, B_x, B_wq, B_wk, B_wv, B_wo):

    def _A_ref(x, mem0, Wq, Wk, Wv, Wo, seg_len):
        B, S, Dm = x.shape
        H, Dh = (Wq.shape[1], Wq.shape[2])
        M = mem0.shape[1]
        scale = Dh ** (-0.5)
        n_seg = S // seg_len
        L = M + seg_len
        idx = torch.arange(L)
        mask = (idx[:, None] < M) | (idx[:, None] >= idx[None, :])
        mem = mem0
        outs = []
        for s in range(n_seg):
            xs = x[:, s * seg_len:(s + 1) * seg_len, :].clone()
            h = torch.concatenate([mem, xs], axis=1)
            q = torch.einsum('btd,dhe->bhte', h, Wq)
            k = torch.einsum('btd,dhe->bhte', h, Wk)
            v = torch.einsum('btd,dhe->bhte', h, Wv)
            scores = torch.einsum('bhqe,bhke->bhqk', q, k) * scale
            scores = torch.where(mask[None, None], scores, -1000000000.0)
            p = _softmax(scores, axis=-1)
            o = torch.einsum('bhqk,bhke->bhqe', p, v)
            o = torch.einsum('bhte,hed->btd', o, Wo)
            mem = o[:, :M, :].clone()
            outs.append(o[:, M:, :])
        return torch.concatenate(outs, axis=1)

    def _B_ref(x, wq, wk, wv, wo):
        B, S, D = x.shape
        H = 32
        Dh = D // H
        q = (lambda x, *d: x.permute(*d))((x @ wq).reshape(B, S, H, Dh), 0, 2, 1, 3)
        k = x @ wk
        v = x @ wv
        scores = torch.einsum('bhqd,bkd->bhqk', q, k) * Dh ** (-0.5)
        p = _softmax(scores, axis=-1)
        o = torch.einsum('bhqk,bkd->bhqd', p, v)
        return (lambda x, *d: x.permute(*d))(o, 0, 2, 1, 3).reshape(B, S, H * Dh) @ wo
    a = _A_ref(A_x, A_mem0, A_Wq, A_Wk, A_Wv, A_Wo, A_seg_len)
    b = _B_ref(B_x, B_wq, B_wk, B_wv, B_wo)
    return torch.concatenate([a, b], axis=-1)
```

```asm
; @launch grid=(256,1,1) block=(256,1,1) lds=163840
.amdgcn_target "amdgcn-amd-amdhsa--gfx950"
.text
.globl concat_heads__memory_aug_recurrent_mem_tr__grouped_kv_mqa__prompt_kernel
.p2align 8
.type concat_heads__memory_aug_recurrent_mem_tr__grouped_kv_mqa__prompt_kernel,@function
concat_heads__memory_aug_recurrent_mem_tr__grouped_kv_mqa__prompt_kernel:
    s_cmp_ge_u32 s2, 256
    s_cbranch_scc1 L_end
    s_load_dwordx2 s[72:73], s[0:1], 0
    s_load_dwordx2 s[74:75], s[0:1], 8
    s_load_dwordx2 s[76:77], s[0:1], 16
    s_load_dwordx2 s[78:79], s[0:1], 24
    s_load_dwordx2 s[80:81], s[0:1], 32
    s_load_dwordx2 s[82:83], s[0:1], 40
    s_load_dwordx2 s[84:85], s[0:1], 56
    s_load_dwordx2 s[86:87], s[0:1], 64
    s_load_dwordx2 s[88:89], s[0:1], 72
    s_load_dwordx2 s[90:91], s[0:1], 80
    s_load_dwordx2 s[92:93], s[0:1], 88
    s_load_dwordx2 s[94:95], s[0:1], 96
    s_load_dwordx2 s[16:17], s[0:1], 104
    s_load_dwordx2 s[46:47], s[0:1], 112
    s_waitcnt lgkmcnt(0)
    s_mov_b32 s4, s46
    s_and_b32 s5, s47, 0xffff
    s_mov_b32 s6, 268435456
    s_mov_b32 s7, 0x20000
    s_mov_b32 s99, 0
    v_lshrrev_b32 v32, 6, v0
    v_and_b32 v33, 63, v0
    v_readfirstlane_b32 s19, v32
    v_and_b32 v34, 15, v33
    v_lshrrev_b32 v35, 4, v33
    v_and_b32 v36, 7, v33
    v_bfe_u32 v37, v33, 3, 1
    v_lshlrev_b32 v0, 4, v33
    v_lshrrev_b32 v38, 2, v34
    v_lshlrev_b32 v38, 1, v38
    v_and_b32 v39, 1, v34
    v_or_b32 v38, v38, v39
    v_bfe_u32 v39, v34, 1, 1
    v_mov_b32 v40, 0x44444444
    v_mov_b32 v41, 0xeeeeeeee
    v_cmp_eq_u32 vcc, 0, v39
    s_nop 1
    v_cndmask_b32 v1, v41, v40, vcc
    s_getreg_b32 s24, hwreg(HW_REG_XCC_ID, 0, 4)
    s_and_b32 s24, s24, 7
    s_cmp_lg_u32 s19, 0
    s_cbranch_scc1 role_1
    s_mov_b64 exec, 1
    v_mov_b32 v44, 1
    s_lshl_b32 s25, s24, 2
    v_mov_b32 v45, s25
    global_atomic_add v46, v45, v44, s[16:17] sc0
    s_waitcnt vmcnt(0)
    v_readfirstlane_b32 s26, v46
    s_cmp_eq_u32 s24, 0
    s_cselect_b32 s27, s26, 1000
    s_cmp_lt_u32 s27, 32
    s_cbranch_scc1 L_isch
    v_mov_b32 v45, 48
    global_atomic_add v46, v45, v44, s[16:17] sc0
    s_waitcnt vmcnt(0)
    v_add_u32 v46, 32, v46
L_isch:
    v_mov_b32 v45, 0
    ds_write_b32 v45, v46
    s_waitcnt lgkmcnt(0)
    s_mov_b64 exec, -1
role_1:
    s_waitcnt vmcnt(0)
    s_barrier
    v_mov_b32 v45, 0
    ds_read_b32 v46, v45
    s_waitcnt lgkmcnt(0)
    v_readfirstlane_b32 s18, v46
    s_barrier
    s_mov_b32 s98, 0
    s_cmp_lt_u32 s18, 256
    s_cbranch_scc1 L_notx
    s_sub_u32 s18, 287, s18
    s_mov_b32 s98, 1
L_notx:
    s_cmp_ge_u32 s18, 32
    s_cbranch_scc1 L_worker
    s_mov_b32 s45, s98
    s_mov_b32 s46, s74
    s_mov_b32 s47, s75
    s_mov_b32 s48, s76
    s_mov_b32 s49, s77
    s_mov_b32 s50, s78
    s_mov_b32 s51, s79
    s_mov_b32 s52, s80
    s_mov_b32 s53, s81
    s_mov_b32 s54, s82
    s_mov_b32 s55, s83
    s_mov_b32 s8, s46
    s_and_b32 s9, s47, 0xffff
    s_mov_b32 s10, 9216
    s_mov_b32 s11, 0x20000
    s_lshl_b32 s43, s19, 10
    s_lshl_b32 s44, s19, 8
    s_lshl_b32 s28, s19, 11
    s_add_u32 s28, s28, 16384
    v_add_u32 v26, s28, v0
    v_mul_u32_u24 v27, 1152, v38
    v_lshl_add_u32 v27, v35, 5, v27
    v_lshl_add_u32 v27, v39, 4, v27
    s_lshl_b32 s28, s19, 7
    v_add_u32 v27, s28, v27
    v_lshlrev_b32 v30, 13, v35
    v_lshl_add_u32 v30, v37, 12, v30
    v_lshl_add_u32 v30, v36, 4, v30
    s_lshl_b32 s28, s19, 3
    s_add_u32 s28, s28, s18
    v_lshl_add_u32 v40, v35, 1, v37
    v_add_u32 v40, s28, v40
    v_and_b32 v40, 31, v40
    v_lshl_add_u32 v30, v40, 7, v30
    v_lshl_add_u32 v40, v35, 1, v39
    v_xor_b32 v40, v40, v38
    v_lshlrev_b32 v40, 4, v40
    v_lshl_add_u32 v40, v38, 8, v40
    v_add_u32 v31, 14336, v40
    v_lshlrev_b32 v40, 1, v35
    v_sub_u32 v40, v36, v40
    v_mov_b32 v41, 0
    v_mov_b32 v42, 0x3f80
    v_mov_b32 v43, 0x3f800000
    v_cmp_eq_u32 vcc, 0, v40
    s_nop 1
    v_cndmask_b32 v41, v41, v42, vcc
    v_cmp_eq_u32 vcc, 1, v40
    s_nop 1
    v_cndmask_b32 v2, v41, v43, vcc
    v_mov_b32 v3, 0
    v_mov_b32 v4, 0
    v_mov_b32 v5, v2
    v_lshlrev_b32 v40, 1, v35
    v_sub_u32 v40, v38, v40
    v_mov_b32 v41, 0
    v_mov_b32 v42, 0x3f80
    v_mov_b32 v43, 0x3f800000
    v_cmp_eq_u32 vcc, 0, v40
    s_nop 1
    v_cndmask_b32 v41, v41, v42, vcc
    v_cmp_eq_u32 vcc, 1, v40
    s_nop 1
    v_cndmask_b32 v6, v41, v43, vcc
    v_mov_b32 v7, 0
    v_mov_b32 v8, 0
    v_mov_b32 v9, v6
    s_mov_b32 s32, 0x00ff00ff
    s_mov_b32 s33, 0x00ff00ff
    s_mov_b32 s68, 0x3f803f80
    s_mov_b32 s69, 0x3f803f80
    s_lshl_b32 s70, s19, 2
    s_mov_b32 s31, 0x3e0293ee
    s_mov_b32 s62, 0x3e0293ee
    s_mov_b32 s63, 0x3e0293ee
    v_lshrrev_b32 v40, 4, v33
    v_lshlrev_b32 v41, 13, v40
    v_and_b32 v42, 1, v40
    v_lshlrev_b32 v42, 1, v42
    v_xor_b32 v42, v42, v34
    v_lshlrev_b32 v42, 4, v42
    v_xor_b32 v43, 0, v42
    v_add_u32 v43, v43, v41
    v_add_u32 v52, 0, v43
    v_xor_b32 v43, 64, v42
    v_add_u32 v43, v43, v41
    v_add_u32 v53, 32768, v43
    v_xor_b32 v43, 128, v42
    v_add_u32 v43, v43, v41
    v_add_u32 v54, 65536, v43
    v_xor_b32 v43, 192, v42
    v_add_u32 v43, v43, v41
    v_add_u32 v55, 98304, v43
    v_lshrrev_b32 v40, 3, v33
    v_and_b32 v41, 7, v33
    v_lshrrev_b32 v42, 5, v33
    v_add_u32 v43, 0, v40
    v_mul_u32_u24 v43, 1152, v43
    v_add_u32 v44, 0, v42
    v_lshlrev_b32 v44, 1, v44
    v_xor_b32 v44, v44, v41
    v_lshl_add_u32 v56, v44, 4, v43
    v_add_u32 v43, 8, v40
    v_mul_u32_u24 v43, 1152, v43
    v_add_u32 v44, 2, v42
    v_lshlrev_b32 v44, 1, v44
    v_xor_b32 v44, v44, v41
    v_lshl_add_u32 v57, v44, 4, v43
    v_add_u32 v43, 16, v40
    v_mul_u32_u24 v43, 1152, v43
    v_add_u32 v44, 0, v42
    v_lshlrev_b32 v44, 1, v44
    v_xor_b32 v44, v44, v41
    v_lshl_add_u32 v58, v44, 4, v43
    v_add_u32 v43, 24, v40
    v_mul_u32_u24 v43, 1152, v43
    v_add_u32 v44, 2, v42
    v_lshlrev_b32 v44, 1, v44
    v_xor_b32 v44, v44, v41
    v_lshl_add_u32 v59, v44, 4, v43
    v_lshrrev_b32 v40, 2, v34
    v_and_b32 v41, 3, v34
    v_lshrrev_b32 v42, 1, v35
    v_lshlrev_b32 v42, 4, v42
    v_and_b32 v43, 1, v35
    v_lshl_add_u32 v42, v43, 2, v42
    v_and_b32 v44, 1, v40
    v_add_u32 v42, v42, v44
    v_lshrrev_b32 v45, 1, v40
    v_lshl_add_u32 v42, v45, 3, v42
    v_lshl_add_u32 v46, v45, 1, v43
    v_lshl_or_b32 v47, v46, 1, v44
    s_lshl_b32 s28, s19, 1
    v_xor_b32 v47, s28, v47
    v_lshlrev_b32 v47, 5, v47
    v_lshl_add_u32 v47, v41, 3, v47
    v_lshl_add_u32 v60, v42, 8, v47
    v_xor_b32 v61, 32, v60
    v_xor_b32 v46, s19, v46
    v_lshlrev_b32 v46, 5, v46
    v_lshl_add_u32 v46, v41, 3, v46
    v_lshl_add_u32 v62, v42, 7, v46
    s_mov_b32 s12, s48
    s_and_b32 s13, s49, 0xffff
    s_mov_b32 s14, 4718592
    s_mov_b32 s15, 0x20000
    s_lshl_b32 s28, s19, 17
    s_lshl_b32 s29, s18, 8
    s_add_u32 s28, s28, s29
    s_add_u32 s28, s28, 0
    s_lshl_b32 s29, s19, 12
    s_add_u32 s29, s29, 65536
    s_add_u32 m0, s29, 0
    s_nop 0
    buffer_load_dwordx4 v52, s[12:15], s28 offen lds
    s_add_u32 m0, s29, 1024
    s_nop 0
    buffer_load_dwordx4 v53, s[12:15], s28 offen lds
    s_add_u32 m0, s29, 2048
    s_nop 0
    buffer_load_dwordx4 v54, s[12:15], s28 offen lds
    s_add_u32 m0, s29, 3072
    s_nop 0
    buffer_load_dwordx4 v55, s[12:15], s28 offen lds
    s_lshl_b32 s28, s19, 17
    s_lshl_b32 s29, s18, 8
    s_add_u32 s28, s28, s29
    s_add_u32 s28, s28, 524288
    s_lshl_b32 s29, s19, 12
    s_add_u32 s29, s29, 81920
    s_add_u32 m0, s29, 0
    s_nop 0
    buffer_load_dwordx4 v52, s[12:15], s28 offen lds
    s_add_u32 m0, s29, 1024
    s_nop 0
    buffer_load_dwordx4 v53, s[12:15], s28 offen lds
    s_add_u32 m0, s29, 2048
    s_nop 0
    buffer_load_dwordx4 v54, s[12:15], s28 offen lds
    s_add_u32 m0, s29, 3072
    s_nop 0
    buffer_load_dwordx4 v55, s[12:15], s28 offen lds
    s_lshl_b32 s28, s19, 17
    s_lshl_b32 s29, s18, 8
    s_add_u32 s28, s28, s29
    s_add_u32 s28, s28, 1048576
    s_lshl_b32 s29, s19, 12
    s_add_u32 s29, s29, 98304
    s_add_u32 m0, s29, 0
    s_nop 0
    buffer_load_dwordx4 v52, s[12:15], s28 offen lds
    s_add_u32 m0, s29, 1024
    s_nop 0
    buffer_load_dwordx4 v53, s[12:15], s28 offen lds
    s_add_u32 m0, s29, 2048
    s_nop 0
    buffer_load_dwordx4 v54, s[12:15], s28 offen lds
    s_add_u32 m0, s29, 3072
    s_nop 0
    buffer_load_dwordx4 v55, s[12:15], s28 offen lds
    s_lshl_b32 s28, s19, 17
    s_lshl_b32 s29, s18, 8
    s_add_u32 s28, s28, s29
    s_add_u32 s28, s28, 1572864
    s_lshl_b32 s29, s19, 12
    s_add_u32 s29, s29, 114688
    s_add_u32 m0, s29, 0
    s_nop 0
    buffer_load_dwordx4 v52, s[12:15], s28 offen lds
    s_add_u32 m0, s29, 1024
    s_nop 0
    buffer_load_dwordx4 v53, s[12:15], s28 offen lds
    s_add_u32 m0, s29, 2048
    s_nop 0
    buffer_load_dwordx4 v54, s[12:15], s28 offen lds
    s_add_u32 m0, s29, 3072
    s_nop 0
    buffer_load_dwordx4 v55, s[12:15], s28 offen lds
    s_lshl_b32 s28, s19, 17
    s_lshl_b32 s29, s18, 8
    s_add_u32 s28, s28, s29
    s_add_u32 s28, s28, 2097152
    s_lshl_b32 s29, s19, 12
    s_add_u32 s29, s29, 131072
    s_add_u32 m0, s29, 0
    s_nop 0
    buffer_load_dwordx4 v52, s[12:15], s28 offen lds
    s_add_u32 m0, s29, 1024
    s_nop 0
    buffer_load_dwordx4 v53, s[12:15], s28 offen lds
    s_add_u32 m0, s29, 2048
    s_nop 0
    buffer_load_dwordx4 v54, s[12:15], s28 offen lds
    s_add_u32 m0, s29, 3072
    s_nop 0
    buffer_load_dwordx4 v55, s[12:15], s28 offen lds
    s_lshl_b32 s28, s19, 17
    s_lshl_b32 s29, s18, 8
    s_add_u32 s28, s28, s29
    s_add_u32 s28, s28, 2621440
    s_lshl_b32 s29, s19, 12
    s_add_u32 s29, s29, 147456
    s_add_u32 m0, s29, 0
    s_nop 0
    buffer_load_dwordx4 v52, s[12:15], s28 offen lds
    s_add_u32 m0, s29, 1024
    s_nop 0
    buffer_load_dwordx4 v53, s[12:15], s28 offen lds
    s_add_u32 m0, s29, 2048
    s_nop 0
    buffer_load_dwordx4 v54, s[12:15], s28 offen lds
    s_add_u32 m0, s29, 3072
    s_nop 0
    buffer_load_dwordx4 v55, s[12:15], s28 offen lds
    s_lshl_b32 s28, s19, 17
    s_lshl_b32 s29, s18, 8
    s_add_u32 s28, s28, s29
    s_add_u32 s28, s28, 3145728
    s_lshl_b32 s29, s19, 12
    s_add_u32 s29, s29, 0
    s_add_u32 m0, s29, 0
    s_nop 0
    buffer_load_dwordx4 v52, s[12:15], s28 offen lds
    s_add_u32 m0, s29, 1024
    s_nop 0
    buffer_load_dwordx4 v53, s[12:15], s28 offen lds
    s_add_u32 m0, s29, 2048
    s_nop 0
    buffer_load_dwordx4 v54, s[12:15], s28 offen lds
    s_add_u32 m0, s29, 3072
    s_nop 0
    buffer_load_dwordx4 v55, s[12:15], s28 offen lds
    s_lshl_b32 s28, s19, 17
    s_lshl_b32 s29, s18, 8
    s_add_u32 s28, s28, s29
    s_add_u32 s28, s28, 3670016
    s_lshl_b32 s29, s19, 12
    s_add_u32 s29, s29, 16384
    s_add_u32 m0, s29, 0
    s_nop 0
    buffer_load_dwordx4 v52, s[12:15], s28 offen lds
    s_add_u32 m0, s29, 1024
    s_nop 0
    buffer_load_dwordx4 v53, s[12:15], s28 offen lds
    s_add_u32 m0, s29, 2048
    s_nop 0
    buffer_load_dwordx4 v54, s[12:15], s28 offen lds
    s_add_u32 m0, s29, 3072
    s_nop 0
    buffer_load_dwordx4 v55, s[12:15], s28 offen lds
    s_lshl_b32 s28, s19, 17
    s_lshl_b32 s29, s18, 8
    s_add_u32 s28, s28, s29
    s_add_u32 s28, s28, 4194304
    s_lshl_b32 s29, s19, 12
    s_add_u32 s29, s29, 32768
    s_add_u32 m0, s29, 0
    s_nop 0
    buffer_load_dwordx4 v52, s[12:15], s28 offen lds
    s_add_u32 m0, s29, 1024
    s_nop 0
    buffer_load_dwordx4 v53, s[12:15], s28 offen lds
    s_add_u32 m0, s29, 2048
    s_nop 0
    buffer_load_dwordx4 v54, s[12:15], s28 offen lds
    s_add_u32 m0, s29, 3072
    s_nop 0
    buffer_load_dwordx4 v55, s[12:15], s28 offen lds
    s_mov_b32 s12, s54
    s_and_b32 s13, s55, 0xffff
    s_mov_b32 s14, 4718592
    s_mov_b32 s15, 0x20000
    s_lshl_b32 s28, s18, 7
    s_lshl_b32 s29, s19, 5
    s_add_u32 s28, s28, s29
    s_mul_i32 s28, s28, 1152
    s_add_u32 s28, s28, 0
    s_lshl_b32 s29, s19, 12
    s_add_u32 s29, s29, 49152
    s_add_u32 m0, s29, 0
    s_nop 0
    buffer_load_dwordx4 v56, s[12:15], s28 offen lds
    s_add_u32 m0, s29, 1024
    s_nop 0
    buffer_load_dwordx4 v57, s[12:15], s28 offen lds
    s_add_u32 m0, s29, 2048
    s_nop 0
    buffer_load_dwordx4 v58, s[12:15], s28 offen lds
    s_add_u32 m0, s29, 3072
    s_nop 0
    buffer_load_dwordx4 v59, s[12:15], s28 offen lds
    s_mul_i32 s28, s18, 12288
    s_add_u32 s29, s28, s43
    s_add_u32 s29, s29, 63963136
    v_mov_b64 v[64:65], 0
    v_mov_b64 v[66:67], 0
    v_mov_b64 v[68:69], -1
    v_mov_b64 v[70:71], -1
    buffer_store_dwordx4 v[64:67], v0, s[4:7], s29 offen sc1
    s_add_u32 s29, s29, 4096
    buffer_store_dwordx4 v[64:67], v0, s[4:7], s29 offen sc1
    s_add_u32 s29, s29, 4096
    buffer_store_dwordx4 v[64:67], v0, s[4:7], s29 offen sc1
    s_lshl_b32 s28, s18, 2
    s_add_u32 s28, s28, s19
    s_sub_u32 s28, s28, 4
    s_cmp_ge_u32 s28, 27
    s_cbranch_scc1 fill_skip_2
    s_lshl_b32 s28, s28, 10
    s_add_u32 s30, s28, 63448064
    buffer_store_dwordx4 v[68:71], v0, s[4:7], s30 offen sc1
fill_skip_2:
    s_cmp_lg_u32 s18, 0
    s_cbranch_scc1 no_m0_3
    buffer_load_dwordx4 v[64:67], v27, s[8:11], 0 offen
    buffer_load_dwordx4 v[68:71], v27, s[8:11], 0 offen offset:512
    s_lshl_b32 s28, s19, 7
    v_subrev_u32 v72, s28, v27
    buffer_load_dwordx4 v[76:79], v72, s[8:11], 0 offen offset:1024
    s_add_u32 s28, s43, 63438848
    s_mov_b32 s29, 63447040
    s_waitcnt vmcnt(0)
    buffer_store_dwordx4 v[64:67], v0, s[4:7], s28 offen sc1
    s_add_u32 s28, s28, 4096
    buffer_store_dwordx4 v[68:71], v0, s[4:7], s28 offen sc1
    buffer_store_dwordx4 v[76:79], v0, s[4:7], s29 offen sc1
no_m0_3:
    s_waitcnt vmcnt(0)
    s_barrier
    s_cmp_lg_u32 s19, 0
    s_cbranch_scc1 init_arr_4
    s_mov_b64 exec, 1
    v_mov_b32 v64, 1
    v_mov_b32 v65, 40
    global_atomic_add v65, v64, s[16:17]
    s_mov_b64 exec, -1
init_arr_4:
    s_cmp_lg_u32 s45, 0
    s_cbranch_scc1 mode_d_6
    s_mov_b32 s30, 0
mode_5:
    v_mov_b32 v65, 0
    global_load_dword v64, v65, s[16:17] sc1
    v_mov_b32 v65, 48
    global_load_dword v66, v65, s[16:17] sc1
    s_waitcnt vmcnt(0)
    v_readfirstlane_b32 s28, v64
    v_readfirstlane_b32 s29, v66
    s_cmp_ge_u32 s28, 32
    s_cbranch_scc1 mode_d_6
    s_cmp_gt_u32 s29, 224
    s_cselect_b32 s45, 1, 0
    s_cbranch_scc1 mode_d_6
    s_sleep 4
    s_add_u32 s30, s30, 1
    s_cmp_lt_u32 s30, 0x100000
    s_cbranch_scc1 mode_5
mode_d_6:
    s_mov_b32 s30, 0
    v_mov_b32 v64, 52
iw_7:
    global_load_dword v65, v64, s[16:17] sc1
    s_waitcnt vmcnt(0)
    v_readfirstlane_b32 s28, v65
    s_nop 0
    s_cmp_lg_u32 s28, 0
    s_cbranch_scc1 id_8
    s_sleep 2
    s_add_u32 s30, s30, 1
    s_cmp_lt_u32 s30, 0x100000
    s_cbranch_scc1 iw_7
    s_mov_b32 s99, 1
id_8:
    s_waitcnt vmcnt(36)
    s_barrier
    v_add_u32 v40, 65536, v60
    v_add_u32 v41, 65536, v61
    v_add_u32 v42, 65536, v62
    ds_read_b64_tr_b16 a[0:1], v40 offset:0
    ds_read_b64_tr_b16 a[2:3], v40 offset:512
    ds_read_b64_tr_b16 a[4:5], v40 offset:8192
    ds_read_b64_tr_b16 a[6:7], v40 offset:8704
    ds_read_b64_tr_b16 a[72:73], v41 offset:0
    ds_read_b64_tr_b16 a[74:75], v41 offset:512
    ds_read_b64_tr_b16 a[76:77], v41 offset:8192
    ds_read_b64_tr_b16 a[78:79], v41 offset:8704
    s_waitcnt lgkmcnt(0)
    s_barrier
    s_lshl_b32 s28, s18, 7
    s_lshl_b32 s29, s19, 5
    s_add_u32 s28, s28, s29
    s_mul_i32 s28, s28, 1152
    s_add_u32 s28, s28, 128
    s_lshl_b32 s29, s19, 12
    s_add_u32 s29, s29, 65536
    s_add_u32 m0, s29, 0
    s_nop 0
    buffer_load_dwordx4 v56, s[12:15], s28 offen lds
    s_add_u32 m0, s29, 1024
    s_nop 0
    buffer_load_dwordx4 v57, s[12:15], s28 offen lds
    s_add_u32 m0, s29, 2048
    s_nop 0
    buffer_load_dwordx4 v58, s[12:15], s28 offen lds
    s_add_u32 m0, s29, 3072
    s_nop 0
    buffer_load_dwordx4 v59, s[12:15], s28 offen lds
    s_waitcnt vmcnt(36)
    s_barrier
    v_add_u32 v40, 81920, v60
    v_add_u32 v41, 81920, v61
    v_add_u32 v42, 81920, v62
    ds_read_b64_tr_b16 a[8:9], v40 offset:0
    ds_read_b64_tr_b16 a[10:11], v40 offset:512
    ds_read_b64_tr_b16 a[12:13], v40 offset:8192
    ds_read_b64_tr_b16 a[14:15], v40 offset:8704
    ds_read_b64_tr_b16 a[80:81], v41 offset:0
    ds_read_b64_tr_b16 a[82:83], v41 offset:512
    ds_read_b64_tr_b16 a[84:85], v41 offset:8192
    ds_read_b64_tr_b16 a[86:87], v41 offset:8704
    s_waitcnt lgkmcnt(0)
    s_barrier
    s_lshl_b32 s28, s18, 7
    s_lshl_b32 s29, s19, 5
    s_add_u32 s28, s28, s29
    s_mul_i32 s28, s28, 1152
    s_add_u32 s28, s28, 256
    s_lshl_b32 s29, s19, 12
    s_add_u32 s29, s29, 81920
    s_add_u32 m0, s29, 0
    s_nop 0
    buffer_load_dwordx4 v56, s[12:15], s28 offen lds
    s_add_u32 m0, s29, 1024
    s_nop 0
    buffer_load_dwordx4 v57, s[12:15], s28 offen lds
    s_add_u32 m0, s29, 2048
    s_nop 0
    buffer_load_dwordx4 v58, s[12:15], s28 offen lds
    s_add_u32 m0, s29, 3072
    s_nop 0
    buffer_load_dwordx4 v59, s[12:15], s28 offen lds
    s_waitcnt vmcnt(36)
    s_barrier
    v_add_u32 v40, 98304, v60
    v_add_u32 v41, 98304, v61
    v_add_u32 v42, 98304, v62
    ds_read_b64_tr_b16 a[16:17], v40 offset:0
    ds_read_b64_tr_b16 a[18:19], v40 offset:512
    ds_read_b64_tr_b16 a[20:21], v40 offset:8192
    ds_read_b64_tr_b16 a[22:23], v40 offset:8704
    ds_read_b64_tr_b16 a[88:89], v41 offset:0
    ds_read_b64_tr_b16 a[90:91], v41 offset:512
    ds_read_b64_tr_b16 a[92:93], v41 offset:8192
    ds_read_b64_tr_b16 a[94:95], v41 offset:8704
    s_waitcnt lgkmcnt(0)
    s_barrier
    s_lshl_b32 s28, s18, 7
    s_lshl_b32 s29, s19, 5
    s_add_u32 s28, s28, s29
    s_mul_i32 s28, s28, 1152
    s_add_u32 s28, s28, 384
    s_lshl_b32 s29, s19, 12
    s_add_u32 s29, s29, 98304
    s_add_u32 m0, s29, 0
    s_nop 0
    buffer_load_dwordx4 v56, s[12:15], s28 offen lds
    s_add_u32 m0, s29, 1024
    s_nop 0
    buffer_load_dwordx4 v57, s[12:15], s28 offen lds
    s_add_u32 m0, s29, 2048
    s_nop 0
    buffer_load_dwordx4 v58, s[12:15], s28 offen lds
    s_add_u32 m0, s29, 3072
    s_nop 0
    buffer_load_dwordx4 v59, s[12:15], s28 offen lds
    s_waitcnt vmcnt(36)
    s_barrier
    v_add_u32 v40, 114688, v60
    v_add_u32 v41, 114688, v61
    v_add_u32 v42, 114688, v62
    ds_read_b64_tr_b16 a[24:25], v40 offset:0
    ds_read_b64_tr_b16 a[26:27], v40 offset:512
    ds_read_b64_tr_b16 a[28:29], v40 offset:8192
    ds_read_b64_tr_b16 a[30:31], v40 offset:8704
    ds_read_b64_tr_b16 a[96:97], v41 offset:0
    ds_read_b64_tr_b16 a[98:99], v41 offset:512
    ds_read_b64_tr_b16 a[100:101], v41 offset:8192
    ds_read_b64_tr_b16 a[102:103], v41 offset:8704
    s_waitcnt lgkmcnt(0)
    s_barrier
    s_lshl_b32 s28, s18, 7
    s_lshl_b32 s29, s19, 5
    s_add_u32 s28, s28, s29
    s_mul_i32 s28, s28, 1152
    s_add_u32 s28, s28, 512
    s_lshl_b32 s29, s19, 12
    s_add_u32 s29, s29, 114688
    s_add_u32 m0, s29, 0
    s_nop 0
    buffer_load_dwordx4 v56, s[12:15], s28 offen lds
    s_add_u32 m0, s29, 1024
    s_nop 0
    buffer_load_dwordx4 v57, s[12:15], s28 offen lds
    s_add_u32 m0, s29, 2048
    s_nop 0
    buffer_load_dwordx4 v58, s[12:15], s28 offen lds
    s_add_u32 m0, s29, 3072
    s_nop 0
    buffer_load_dwordx4 v59, s[12:15], s28 offen lds
    s_waitcnt vmcnt(36)
    s_barrier
    v_add_u32 v40, 131072, v60
    v_add_u32 v41, 131072, v61
    v_add_u32 v42, 131072, v62
    ds_read_b64_tr_b16 a[32:33], v40 offset:0
    ds_read_b64_tr_b16 a[34:35], v40 offset:512
    ds_read_b64_tr_b16 a[36:37], v40 offset:8192
    ds_read_b64_tr_b16 a[38:39], v40 offset:8704
    ds_read_b64_tr_b16 a[104:105], v41 offset:0
    ds_read_b64_tr_b16 a[106:107], v41 offset:512
    ds_read_b64_tr_b16 a[108:109], v41 offset:8192
    ds_read_b64_tr_b16 a[110:111], v41 offset:8704
    s_waitcnt lgkmcnt(0)
    s_barrier
    s_lshl_b32 s28, s18, 7
    s_lshl_b32 s29, s19, 5
    s_add_u32 s28, s28, s29
    s_mul_i32 s28, s28, 1152
    s_add_u32 s28, s28, 640
    s_lshl_b32 s29, s19, 12
    s_add_u32 s29, s29, 131072
    s_add_u32 m0, s29, 0
    s_nop 0
    buffer_load_dwordx4 v56, s[12:15], s28 offen lds
    s_add_u32 m0, s29, 1024
    s_nop 0
    buffer_load_dwordx4 v57, s[12:15], s28 offen lds
    s_add_u32 m0, s29, 2048
    s_nop 0
    buffer_load_dwordx4 v58, s[12:15], s28 offen lds
    s_add_u32 m0, s29, 3072
    s_nop 0
    buffer_load_dwordx4 v59, s[12:15], s28 offen lds
    s_waitcnt vmcnt(36)
    s_barrier
    v_add_u32 v40, 147456, v60
    v_add_u32 v41, 147456, v61
    v_add_u32 v42, 147456, v62
    ds_read_b64_tr_b16 a[40:41], v40 offset:0
    ds_read_b64_tr_b16 a[42:43], v40 offset:512
    ds_read_b64_tr_b16 a[44:45], v40 offset:8192
    ds_read_b64_tr_b16 a[46:47], v40 offset:8704
    ds_read_b64_tr_b16 a[112:113], v41 offset:0
    ds_read_b64_tr_b16 a[114:115], v41 offset:512
    ds_read_b64_tr_b16 a[116:117], v41 offset:8192
    ds_read_b64_tr_b16 a[118:119], v41 offset:8704
    s_waitcnt lgkmcnt(0)
    s_barrier
    s_lshl_b32 s28, s18, 7
    s_lshl_b32 s29, s19, 5
    s_add_u32 s28, s28, s29
    s_mul_i32 s28, s28, 1152
    s_add_u32 s28, s28, 768
    s_lshl_b32 s29, s19, 12
    s_add_u32 s29, s29, 147456
    s_add_u32 m0, s29, 0
    s_nop 0
    buffer_load_dwordx4 v56, s[12:15], s28 offen lds
    s_add_u32 m0, s29, 1024
    s_nop 0
    buffer_load_dwordx4 v57, s[12:15], s28 offen lds
    s_add_u32 m0, s29, 2048
    s_nop 0
    buffer_load_dwordx4 v58, s[12:15], s28 offen lds
    s_add_u32 m0, s29, 3072
    s_nop 0
    buffer_load_dwordx4 v59, s[12:15], s28 offen lds
    s_waitcnt vmcnt(36)
    s_barrier
    v_add_u32 v40, 0, v60
    v_add_u32 v41, 0, v61
    v_add_u32 v42, 0, v62
    ds_read_b64_tr_b16 a[48:49], v40 offset:0
    ds_read_b64_tr_b16 a[50:51], v40 offset:512
    ds_read_b64_tr_b16 a[52:53], v40 offset:8192
    ds_read_b64_tr_b16 a[54:55], v40 offset:8704
    ds_read_b64_tr_b16 a[120:121], v41 offset:0
    ds_read_b64_tr_b16 a[122:123], v41 offset:512
    ds_read_b64_tr_b16 a[124:125], v41 offset:8192
    ds_read_b64_tr_b16 a[126:127], v41 offset:8704
    s_waitcnt lgkmcnt(0)
    s_barrier
    s_lshl_b32 s28, s18, 7
    s_lshl_b32 s29, s19, 5
    s_add_u32 s28, s28, s29
    s_mul_i32 s28, s28, 1152
    s_add_u32 s28, s28, 896
    s_lshl_b32 s29, s19, 12
    s_add_u32 s29, s29, 0
    s_add_u32 m0, s29, 0
    s_nop 0
    buffer_load_dwordx4 v56, s[12:15], s28 offen lds
    s_add_u32 m0, s29, 1024
    s_nop 0
    buffer_load_dwordx4 v57, s[12:15], s28 offen lds
    s_add_u32 m0, s29, 2048
    s_nop 0
    buffer_load_dwordx4 v58, s[12:15], s28 offen lds
    s_add_u32 m0, s29, 3072
    s_nop 0
    buffer_load_dwordx4 v59, s[12:15], s28 offen lds
    s_waitcnt vmcnt(36)
    s_barrier
    v_add_u32 v40, 16384, v60
    v_add_u32 v41, 16384, v61
    v_add_u32 v42, 16384, v62
    ds_read_b64_tr_b16 a[56:57], v40 offset:0
    ds_read_b64_tr_b16 a[58:59], v40 offset:512
    ds_read_b64_tr_b16 a[60:61], v40 offset:8192
    ds_read_b64_tr_b16 a[62:63], v40 offset:8704
    ds_read_b64_tr_b16 a[128:129], v41 offset:0
    ds_read_b64_tr_b16 a[130:131], v41 offset:512
    ds_read_b64_tr_b16 a[132:133], v41 offset:8192
    ds_read_b64_tr_b16 a[134:135], v41 offset:8704
    s_waitcnt lgkmcnt(0)
    s_barrier
    s_lshl_b32 s28, s18, 7
    s_lshl_b32 s29, s19, 5
    s_add_u32 s28, s28, s29
    s_mul_i32 s28, s28, 1152
    s_add_u32 s28, s28, 1024
    s_lshl_b32 s29, s19, 12
    s_add_u32 s29, s29, 16384
    s_add_u32 m0, s29, 0
    s_nop 0
    buffer_load_dwordx4 v56, s[12:15], s28 offen lds
    s_add_u32 m0, s29, 1024
    s_nop 0
    buffer_load_dwordx4 v57, s[12:15], s28 offen lds
    s_add_u32 m0, s29, 2048
    s_nop 0
    buffer_load_dwordx4 v58, s[12:15], s28 offen lds
    s_add_u32 m0, s29, 3072
    s_nop 0
    buffer_load_dwordx4 v59, s[12:15], s28 offen lds
    s_waitcnt vmcnt(36)
    s_barrier
    v_add_u32 v40, 32768, v60
    v_add_u32 v41, 32768, v61
    v_add_u32 v42, 32768, v62
    ds_read_b64_tr_b16 a[64:65], v40 offset:0
    ds_read_b64_tr_b16 a[66:67], v40 offset:512
    ds_read_b64_tr_b16 a[68:69], v40 offset:8192
    ds_read_b64_tr_b16 a[70:71], v40 offset:8704
    ds_read_b64_tr_b16 a[136:137], v41 offset:0
    ds_read_b64_tr_b16 a[138:139], v41 offset:512
    ds_read_b64_tr_b16 a[140:141], v41 offset:8192
    ds_read_b64_tr_b16 a[142:143], v41 offset:8704
    s_waitcnt lgkmcnt(0)
    s_barrier
    s_mov_b32 s12, s50
    s_and_b32 s13, s51, 0xffff
    s_mov_b32 s14, 4718592
    s_mov_b32 s15, 0x20000
    s_lshl_b32 s28, s19, 17
    s_lshl_b32 s29, s18, 8
    s_add_u32 s28, s28, s29
    s_add_u32 s28, s28, 0
    s_lshl_b32 s29, s19, 12
    s_add_u32 s29, s29, 32768
    s_add_u32 m0, s29, 0
    s_nop 0
    buffer_load_dwordx4 v52, s[12:15], s28 offen lds
    s_add_u32 m0, s29, 1024
    s_nop 0
    buffer_load_dwordx4 v53, s[12:15], s28 offen lds
    s_add_u32 m0, s29, 2048
    s_nop 0
    buffer_load_dwordx4 v54, s[12:15], s28 offen lds
    s_add_u32 m0, s29, 3072
    s_nop 0
    buffer_load_dwordx4 v55, s[12:15], s28 offen lds
    s_waitcnt vmcnt(36)
    s_barrier
    v_add_u32 v40, 49152, v60
    v_add_u32 v41, 49152, v61
    v_add_u32 v42, 49152, v62
    ds_read_b64_tr_b16 v[112:113], v42 offset:0
    ds_read_b64_tr_b16 v[114:115], v42 offset:256
    ds_read_b64_tr_b16 v[116:117], v42 offset:4096
    ds_read_b64_tr_b16 v[118:119], v42 offset:4352
    ds_read_b64_tr_b16 v[120:121], v42 offset:8192
    ds_read_b64_tr_b16 v[122:123], v42 offset:8448
    ds_read_b64_tr_b16 v[124:125], v42 offset:12288
    ds_read_b64_tr_b16 v[126:127], v42 offset:12544
    s_waitcnt lgkmcnt(0)
    s_barrier
    s_lshl_b32 s28, s19, 17
    s_lshl_b32 s29, s18, 8
    s_add_u32 s28, s28, s29
    s_add_u32 s28, s28, 524288
    s_lshl_b32 s29, s19, 12
    s_add_u32 s29, s29, 49152
    s_add_u32 m0, s29, 0
    s_nop 0
    buffer_load_dwordx4 v52, s[12:15], s28 offen lds
    s_add_u32 m0, s29, 1024
    s_nop 0
    buffer_load_dwordx4 v53, s[12:15], s28 offen lds
    s_add_u32 m0, s29, 2048
    s_nop 0
    buffer_load_dwordx4 v54, s[12:15], s28 offen lds
    s_add_u32 m0, s29, 3072
    s_nop 0
    buffer_load_dwordx4 v55, s[12:15], s28 offen lds
    s_waitcnt vmcnt(36)
    s_barrier
    v_add_u32 v40, 65536, v60
    v_add_u32 v41, 65536, v61
    v_add_u32 v42, 65536, v62
    ds_read_b64_tr_b16 v[128:129], v42 offset:0
    ds_read_b64_tr_b16 v[130:131], v42 offset:256
    ds_read_b64_tr_b16 v[132:133], v42 offset:4096
    ds_read_b64_tr_b16 v[134:135], v42 offset:4352
    ds_read_b64_tr_b16 v[136:137], v42 offset:8192
    ds_read_b64_tr_b16 v[138:139], v42 offset:8448
    ds_read_b64_tr_b16 v[140:141], v42 offset:12288
    ds_read_b64_tr_b16 v[142:143], v42 offset:12544
    s_waitcnt lgkmcnt(0)
    s_barrier
    s_lshl_b32 s28, s19, 17
    s_lshl_b32 s29, s18, 8
    s_add_u32 s28, s28, s29
    s_add_u32 s28, s28, 1048576
    s_lshl_b32 s29, s19, 12
    s_add_u32 s29, s29, 65536
    s_add_u32 m0, s29, 0
    s_nop 0
    buffer_load_dwordx4 v52, s[12:15], s28 offen lds
    s_add_u32 m0, s29, 1024
    s_nop 0
    buffer_load_dwordx4 v53, s[12:15], s28 offen lds
    s_add_u32 m0, s29, 2048
    s_nop 0
    buffer_load_dwordx4 v54, s[12:15], s28 offen lds
    s_add_u32 m0, s29, 3072
    s_nop 0
    buffer_load_dwordx4 v55, s[12:15], s28 offen lds
    s_waitcnt vmcnt(36)
    s_barrier
    v_add_u32 v40, 81920, v60
    v_add_u32 v41, 81920, v61
    v_add_u32 v42, 81920, v62
    ds_read_b64_tr_b16 v[144:145], v42 offset:0
    ds_read_b64_tr_b16 v[146:147], v42 offset:256
    ds_read_b64_tr_b16 v[148:149], v42 offset:4096
    ds_read_b64_tr_b16 v[150:151], v42 offset:4352
    ds_read_b64_tr_b16 v[152:153], v42 offset:8192
    ds_read_b64_tr_b16 v[154:155], v42 offset:8448
    ds_read_b64_tr_b16 v[156:157], v42 offset:12288
    ds_read_b64_tr_b16 v[158:159], v42 offset:12544
    s_waitcnt lgkmcnt(0)
    s_barrier
    s_lshl_b32 s28, s19, 17
    s_lshl_b32 s29, s18, 8
    s_add_u32 s28, s28, s29
    s_add_u32 s28, s28, 1572864
    s_lshl_b32 s29, s19, 12
    s_add_u32 s29, s29, 81920
    s_add_u32 m0, s29, 0
    s_nop 0
    buffer_load_dwordx4 v52, s[12:15], s28 offen lds
    s_add_u32 m0, s29, 1024
    s_nop 0
    buffer_load_dwordx4 v53, s[12:15], s28 offen lds
    s_add_u32 m0, s29, 2048
    s_nop 0
    buffer_load_dwordx4 v54, s[12:15], s28 offen lds
    s_add_u32 m0, s29, 3072
    s_nop 0
    buffer_load_dwordx4 v55, s[12:15], s28 offen lds
    s_waitcnt vmcnt(36)
    s_barrier
    v_add_u32 v40, 98304, v60
    v_add_u32 v41, 98304, v61
    v_add_u32 v42, 98304, v62
    ds_read_b64_tr_b16 v[160:161], v42 offset:0
    ds_read_b64_tr_b16 v[162:163], v42 offset:256
    ds_read_b64_tr_b16 v[164:165], v42 offset:4096
    ds_read_b64_tr_b16 v[166:167], v42 offset:4352
    ds_read_b64_tr_b16 v[168:169], v42 offset:8192
    ds_read_b64_tr_b16 v[170:171], v42 offset:8448
    ds_read_b64_tr_b16 v[172:173], v42 offset:12288
    ds_read_b64_tr_b16 v[174:175], v42 offset:12544
    s_waitcnt lgkmcnt(0)
    s_barrier
    s_lshl_b32 s28, s19, 17
    s_lshl_b32 s29, s18, 8
    s_add_u32 s28, s28, s29
    s_add_u32 s28, s28, 2097152
    s_lshl_b32 s29, s19, 12
    s_add_u32 s29, s29, 98304
    s_add_u32 m0, s29, 0
    s_nop 0
    buffer_load_dwordx4 v52, s[12:15], s28 offen lds
    s_add_u32 m0, s29, 1024
    s_nop 0
    buffer_load_dwordx4 v53, s[12:15], s28 offen lds
    s_add_u32 m0, s29, 2048
    s_nop 0
    buffer_load_dwordx4 v54, s[12:15], s28 offen lds
    s_add_u32 m0, s29, 3072
    s_nop 0
    buffer_load_dwordx4 v55, s[12:15], s28 offen lds
    s_waitcnt vmcnt(36)
    s_barrier
    v_add_u32 v40, 114688, v60
    v_add_u32 v41, 114688, v61
    v_add_u32 v42, 114688, v62
    ds_read_b64_tr_b16 v[176:177], v42 offset:0
    ds_read_b64_tr_b16 v[178:179], v42 offset:256
    ds_read_b64_tr_b16 v[180:181], v42 offset:4096
    ds_read_b64_tr_b16 v[182:183], v42 offset:4352
    ds_read_b64_tr_b16 v[184:185], v42 offset:8192
    ds_read_b64_tr_b16 v[186:187], v42 offset:8448
    ds_read_b64_tr_b16 v[188:189], v42 offset:12288
    ds_read_b64_tr_b16 v[190:191], v42 offset:12544
    s_waitcnt lgkmcnt(0)
    s_barrier
    s_lshl_b32 s28, s19, 17
    s_lshl_b32 s29, s18, 8
    s_add_u32 s28, s28, s29
    s_add_u32 s28, s28, 2621440
    s_lshl_b32 s29, s19, 12
    s_add_u32 s29, s29, 114688
    s_add_u32 m0, s29, 0
    s_nop 0
    buffer_load_dwordx4 v52, s[12:15], s28 offen lds
    s_add_u32 m0, s29, 1024
    s_nop 0
    buffer_load_dwordx4 v53, s[12:15], s28 offen lds
    s_add_u32 m0, s29, 2048
    s_nop 0
    buffer_load_dwordx4 v54, s[12:15], s28 offen lds
    s_add_u32 m0, s29, 3072
    s_nop 0
    buffer_load_dwordx4 v55, s[12:15], s28 offen lds
    s_waitcnt vmcnt(36)
    s_barrier
    v_add_u32 v40, 131072, v60
    v_add_u32 v41, 131072, v61
    v_add_u32 v42, 131072, v62
    ds_read_b64_tr_b16 v[192:193], v42 offset:0
    ds_read_b64_tr_b16 v[194:195], v42 offset:256
    ds_read_b64_tr_b16 v[196:197], v42 offset:4096
    ds_read_b64_tr_b16 v[198:199], v42 offset:4352
    ds_read_b64_tr_b16 v[200:201], v42 offset:8192
    ds_read_b64_tr_b16 v[202:203], v42 offset:8448
    ds_read_b64_tr_b16 v[204:205], v42 offset:12288
    ds_read_b64_tr_b16 v[206:207], v42 offset:12544
    s_waitcnt lgkmcnt(0)
    s_barrier
    s_lshl_b32 s28, s19, 17
    s_lshl_b32 s29, s18, 8
    s_add_u32 s28, s28, s29
    s_add_u32 s28, s28, 3145728
    s_lshl_b32 s29, s19, 12
    s_add_u32 s29, s29, 131072
    s_add_u32 m0, s29, 0
    s_nop 0
    buffer_load_dwordx4 v52, s[12:15], s28 offen lds
    s_add_u32 m0, s29, 1024
    s_nop 0
    buffer_load_dwordx4 v53, s[12:15], s28 offen lds
    s_add_u32 m0, s29, 2048
    s_nop 0
    buffer_load_dwordx4 v54, s[12:15], s28 offen lds
    s_add_u32 m0, s29, 3072
    s_nop 0
    buffer_load_dwordx4 v55, s[12:15], s28 offen lds
    s_waitcnt vmcnt(36)
    s_barrier
    v_add_u32 v40, 147456, v60
    v_add_u32 v41, 147456, v61
    v_add_u32 v42, 147456, v62
    ds_read_b64_tr_b16 v[208:209], v42 offset:0
    ds_read_b64_tr_b16 v[210:211], v42 offset:256
    ds_read_b64_tr_b16 v[212:213], v42 offset:4096
    ds_read_b64_tr_b16 v[214:215], v42 offset:4352
    ds_read_b64_tr_b16 v[216:217], v42 offset:8192
    ds_read_b64_tr_b16 v[218:219], v42 offset:8448
    ds_read_b64_tr_b16 v[220:221], v42 offset:12288
    ds_read_b64_tr_b16 v[222:223], v42 offset:12544
    s_waitcnt lgkmcnt(0)
    s_barrier
    s_lshl_b32 s28, s19, 17
    s_lshl_b32 s29, s18, 8
    s_add_u32 s28, s28, s29
    s_add_u32 s28, s28, 3670016
    s_lshl_b32 s29, s19, 12
    s_add_u32 s29, s29, 147456
    s_add_u32 m0, s29, 0
    s_nop 0
    buffer_load_dwordx4 v52, s[12:15], s28 offen lds
    s_add_u32 m0, s29, 1024
    s_nop 0
    buffer_load_dwordx4 v53, s[12:15], s28 offen lds
    s_add_u32 m0, s29, 2048
    s_nop 0
    buffer_load_dwordx4 v54, s[12:15], s28 offen lds
    s_add_u32 m0, s29, 3072
    s_nop 0
    buffer_load_dwordx4 v55, s[12:15], s28 offen lds
    s_waitcnt vmcnt(36)
    s_barrier
    v_add_u32 v40, 0, v60
    v_add_u32 v41, 0, v61
    v_add_u32 v42, 0, v62
    ds_read_b64_tr_b16 v[224:225], v42 offset:0
    ds_read_b64_tr_b16 v[226:227], v42 offset:256
    ds_read_b64_tr_b16 v[228:229], v42 offset:4096
    ds_read_b64_tr_b16 v[230:231], v42 offset:4352
    ds_read_b64_tr_b16 v[232:233], v42 offset:8192
    ds_read_b64_tr_b16 v[234:235], v42 offset:8448
    ds_read_b64_tr_b16 v[236:237], v42 offset:12288
    ds_read_b64_tr_b16 v[238:239], v42 offset:12544
    s_waitcnt lgkmcnt(0)
    s_barrier
    s_lshl_b32 s28, s19, 17
    s_lshl_b32 s29, s18, 8
    s_add_u32 s28, s28, s29
    s_add_u32 s28, s28, 4194304
    s_lshl_b32 s29, s19, 12
    s_add_u32 s29, s29, 0
    s_add_u32 m0, s29, 0
    s_nop 0
    buffer_load_dwordx4 v52, s[12:15], s28 offen lds
    s_add_u32 m0, s29, 1024
    s_nop 0
    buffer_load_dwordx4 v53, s[12:15], s28 offen lds
    s_add_u32 m0, s29, 2048
    s_nop 0
    buffer_load_dwordx4 v54, s[12:15], s28 offen lds
    s_add_u32 m0, s29, 3072
    s_nop 0
    buffer_load_dwordx4 v55, s[12:15], s28 offen lds
    s_waitcnt vmcnt(36)
    s_barrier
    v_add_u32 v40, 16384, v60
    v_add_u32 v41, 16384, v61
    v_add_u32 v42, 16384, v62
    ds_read_b64_tr_b16 v[240:241], v42 offset:0
    ds_read_b64_tr_b16 v[242:243], v42 offset:256
    ds_read_b64_tr_b16 v[244:245], v42 offset:4096
    ds_read_b64_tr_b16 v[246:247], v42 offset:4352
    ds_read_b64_tr_b16 v[248:249], v42 offset:8192
    ds_read_b64_tr_b16 v[250:251], v42 offset:8448
    ds_read_b64_tr_b16 v[252:253], v42 offset:12288
    ds_read_b64_tr_b16 v[254:255], v42 offset:12544
    s_waitcnt lgkmcnt(0)
    s_barrier
    s_mov_b32 s12, s52
    s_and_b32 s13, s53, 0xffff
    s_mov_b32 s14, 4718592
    s_mov_b32 s15, 0x20000
    s_lshl_b32 s28, s19, 17
    s_lshl_b32 s29, s18, 8
    s_add_u32 s28, s28, s29
    s_add_u32 s28, s28, 3145728
    s_lshl_b32 s29, s19, 12
    s_add_u32 s29, s29, 16384
    s_add_u32 m0, s29, 0
    s_nop 0
    buffer_load_dwordx4 v52, s[12:15], s28 offen lds
    s_add_u32 m0, s29, 1024
    s_nop 0
    buffer_load_dwordx4 v53, s[12:15], s28 offen lds
    s_add_u32 m0, s29, 2048
    s_nop 0
    buffer_load_dwordx4 v54, s[12:15], s28 offen lds
    s_add_u32 m0, s29, 3072
    s_nop 0
    buffer_load_dwordx4 v55, s[12:15], s28 offen lds
    s_waitcnt vmcnt(36)
    s_barrier
    v_add_u32 v40, 32768, v60
    v_add_u32 v41, 32768, v61
    v_add_u32 v42, 32768, v62
    ds_read_b64_tr_b16 a[144:145], v40 offset:0
    ds_read_b64_tr_b16 a[146:147], v40 offset:512
    ds_read_b64_tr_b16 a[148:149], v40 offset:8192
    ds_read_b64_tr_b16 a[150:151], v40 offset:8704
    ds_read_b64_tr_b16 a[216:217], v41 offset:0
    ds_read_b64_tr_b16 a[218:219], v41 offset:512
    ds_read_b64_tr_b16 a[220:221], v41 offset:8192
    ds_read_b64_tr_b16 a[222:223], v41 offset:8704
    s_waitcnt lgkmcnt(0)
    s_barrier
    s_lshl_b32 s28, s19, 17
    s_lshl_b32 s29, s18, 8
    s_add_u32 s28, s28, s29
    s_add_u32 s28, s28, 3670016
    s_lshl_b32 s29, s19, 12
    s_add_u32 s29, s29, 32768
    s_add_u32 m0, s29, 0
    s_nop 0
    buffer_load_dwordx4 v52, s[12:15], s28 offen lds
    s_add_u32 m0, s29, 1024
    s_nop 0
    buffer_load_dwordx4 v53, s[12:15], s28 offen lds
    s_add_u32 m0, s29, 2048
    s_nop 0
    buffer_load_dwordx4 v54, s[12:15], s28 offen lds
    s_add_u32 m0, s29, 3072
    s_nop 0
    buffer_load_dwordx4 v55, s[12:15], s28 offen lds
    s_waitcnt vmcnt(36)
    s_barrier
    v_add_u32 v40, 49152, v60
    v_add_u32 v41, 49152, v61
    v_add_u32 v42, 49152, v62
    ds_read_b64_tr_b16 a[152:153], v40 offset:0
    ds_read_b64_tr_b16 a[154:155], v40 offset:512
    ds_read_b64_tr_b16 a[156:157], v40 offset:8192
    ds_read_b64_tr_b16 a[158:159], v40 offset:8704
    ds_read_b64_tr_b16 a[224:225], v41 offset:0
    ds_read_b64_tr_b16 a[226:227], v41 offset:512
    ds_read_b64_tr_b16 a[228:229], v41 offset:8192
    ds_read_b64_tr_b16 a[230:231], v41 offset:8704
    s_waitcnt lgkmcnt(0)
    s_barrier
    s_lshl_b32 s28, s19, 17
    s_lshl_b32 s29, s18, 8
    s_add_u32 s28, s28, s29
    s_add_u32 s28, s28, 0
    s_lshl_b32 s29, s19, 12
    s_add_u32 s29, s29, 49152
    s_add_u32 m0, s29, 0
    s_nop 0
    buffer_load_dwordx4 v52, s[12:15], s28 offen lds
    s_add_u32 m0, s29, 1024
    s_nop 0
    buffer_load_dwordx4 v53, s[12:15], s28 offen lds
    s_add_u32 m0, s29, 2048
    s_nop 0
    buffer_load_dwordx4 v54, s[12:15], s28 offen lds
    s_add_u32 m0, s29, 3072
    s_nop 0
    buffer_load_dwordx4 v55, s[12:15], s28 offen lds
    s_waitcnt vmcnt(36)
    s_barrier
    v_add_u32 v40, 65536, v60
    v_add_u32 v41, 65536, v61
    v_add_u32 v42, 65536, v62
    ds_read_b64_tr_b16 a[160:161], v40 offset:0
    ds_read_b64_tr_b16 a[162:163], v40 offset:512
    ds_read_b64_tr_b16 a[164:165], v40 offset:8192
    ds_read_b64_tr_b16 a[166:167], v40 offset:8704
    ds_read_b64_tr_b16 a[232:233], v41 offset:0
    ds_read_b64_tr_b16 a[234:235], v41 offset:512
    ds_read_b64_tr_b16 a[236:237], v41 offset:8192
    ds_read_b64_tr_b16 a[238:239], v41 offset:8704
    s_waitcnt lgkmcnt(0)
    s_barrier
    s_lshl_b32 s28, s19, 17
    s_lshl_b32 s29, s18, 8
    s_add_u32 s28, s28, s29
    s_add_u32 s28, s28, 524288
    s_lshl_b32 s29, s19, 12
    s_add_u32 s29, s29, 65536
    s_add_u32 m0, s29, 0
    s_nop 0
    buffer_load_dwordx4 v52, s[12:15], s28 offen lds
    s_add_u32 m0, s29, 1024
    s_nop 0
    buffer_load_dwordx4 v53, s[12:15], s28 offen lds
    s_add_u32 m0, s29, 2048
    s_nop 0
    buffer_load_dwordx4 v54, s[12:15], s28 offen lds
    s_add_u32 m0, s29, 3072
    s_nop 0
    buffer_load_dwordx4 v55, s[12:15], s28 offen lds
    s_waitcnt vmcnt(36)
    s_barrier
    v_add_u32 v40, 81920, v60
    v_add_u32 v41, 81920, v61
    v_add_u32 v42, 81920, v62
    ds_read_b64_tr_b16 a[168:169], v40 offset:0
    ds_read_b64_tr_b16 a[170:171], v40 offset:512
    ds_read_b64_tr_b16 a[172:173], v40 offset:8192
    ds_read_b64_tr_b16 a[174:175], v40 offset:8704
    ds_read_b64_tr_b16 a[240:241], v41 offset:0
    ds_read_b64_tr_b16 a[242:243], v41 offset:512
    ds_read_b64_tr_b16 a[244:245], v41 offset:8192
    ds_read_b64_tr_b16 a[246:247], v41 offset:8704
    s_waitcnt lgkmcnt(0)
    s_barrier
    s_lshl_b32 s28, s19, 17
    s_lshl_b32 s29, s18, 8
    s_add_u32 s28, s28, s29
    s_add_u32 s28, s28, 1048576
    s_lshl_b32 s29, s19, 12
    s_add_u32 s29, s29, 81920
    s_add_u32 m0, s29, 0
    s_nop 0
    buffer_load_dwordx4 v52, s[12:15], s28 offen lds
    s_add_u32 m0, s29, 1024
    s_nop 0
    buffer_load_dwordx4 v53, s[12:15], s28 offen lds
    s_add_u32 m0, s29, 2048
    s_nop 0
    buffer_load_dwordx4 v54, s[12:15], s28 offen lds
    s_add_u32 m0, s29, 3072
    s_nop 0
    buffer_load_dwordx4 v55, s[12:15], s28 offen lds
    s_waitcnt vmcnt(36)
    s_barrier
    v_add_u32 v40, 98304, v60
    v_add_u32 v41, 98304, v61
    v_add_u32 v42, 98304, v62
    ds_read_b64_tr_b16 a[176:177], v40 offset:0
    ds_read_b64_tr_b16 a[178:179], v40 offset:512
    ds_read_b64_tr_b16 a[180:181], v40 offset:8192
    ds_read_b64_tr_b16 a[182:183], v40 offset:8704
    ds_read_b64_tr_b16 a[248:249], v41 offset:0
    ds_read_b64_tr_b16 a[250:251], v41 offset:512
    ds_read_b64_tr_b16 a[252:253], v41 offset:8192
    ds_read_b64_tr_b16 a[254:255], v41 offset:8704
    s_waitcnt lgkmcnt(0)
    s_barrier
    s_lshl_b32 s28, s19, 17
    s_lshl_b32 s29, s18, 8
    s_add_u32 s28, s28, s29
    s_add_u32 s28, s28, 1572864
    s_lshl_b32 s29, s19, 12
    s_add_u32 s29, s29, 98304
    s_add_u32 m0, s29, 0
    s_nop 0
    buffer_load_dwordx4 v52, s[12:15], s28 offen lds
    s_add_u32 m0, s29, 1024
    s_nop 0
    buffer_load_dwordx4 v53, s[12:15], s28 offen lds
    s_add_u32 m0, s29, 2048
    s_nop 0
    buffer_load_dwordx4 v54, s[12:15], s28 offen lds
    s_add_u32 m0, s29, 3072
    s_nop 0
    buffer_load_dwordx4 v55, s[12:15], s28 offen lds
    s_waitcnt vmcnt(36)
    s_barrier
    v_add_u32 v40, 114688, v60
    v_add_u32 v41, 114688, v61
    v_add_u32 v42, 114688, v62
    ds_read_b64_tr_b16 a[184:185], v40 offset:0
    ds_read_b64_tr_b16 a[186:187], v40 offset:512
    ds_read_b64_tr_b16 a[188:189], v40 offset:8192
    ds_read_b64_tr_b16 a[190:191], v40 offset:8704
    ds_read_b64_tr_b16 v[80:81], v41 offset:0
    ds_read_b64_tr_b16 v[82:83], v41 offset:512
    ds_read_b64_tr_b16 v[84:85], v41 offset:8192
    ds_read_b64_tr_b16 v[86:87], v41 offset:8704
    s_waitcnt lgkmcnt(0)
    s_barrier
    s_lshl_b32 s28, s19, 17
    s_lshl_b32 s29, s18, 8
    s_add_u32 s28, s28, s29
    s_add_u32 s28, s28, 2097152
    s_lshl_b32 s29, s19, 12
    s_add_u32 s29, s29, 114688
    s_add_u32 m0, s29, 0
    s_nop 0
    buffer_load_dwordx4 v52, s[12:15], s28 offen lds
    s_add_u32 m0, s29, 1024
    s_nop 0
    buffer_load_dwordx4 v53, s[12:15], s28 offen lds
    s_add_u32 m0, s29, 2048
    s_nop 0
    buffer_load_dwordx4 v54, s[12:15], s28 offen lds
    s_add_u32 m0, s29, 3072
    s_nop 0
    buffer_load_dwordx4 v55, s[12:15], s28 offen lds
    s_waitcnt vmcnt(36)
    s_barrier
    v_add_u32 v40, 131072, v60
    v_add_u32 v41, 131072, v61
    v_add_u32 v42, 131072, v62
    ds_read_b64_tr_b16 a[192:193], v40 offset:0
    ds_read_b64_tr_b16 a[194:195], v40 offset:512
    ds_read_b64_tr_b16 a[196:197], v40 offset:8192
    ds_read_b64_tr_b16 a[198:199], v40 offset:8704
    ds_read_b64_tr_b16 v[88:89], v41 offset:0
    ds_read_b64_tr_b16 v[90:91], v41 offset:512
    ds_read_b64_tr_b16 v[92:93], v41 offset:8192
    ds_read_b64_tr_b16 v[94:95], v41 offset:8704
    s_waitcnt lgkmcnt(0)
    s_barrier
    s_lshl_b32 s28, s19, 17
    s_lshl_b32 s29, s18, 8
    s_add_u32 s28, s28, s29
    s_add_u32 s28, s28, 2621440
    s_lshl_b32 s29, s19, 12
    s_add_u32 s29, s29, 131072
    s_add_u32 m0, s29, 0
    s_nop 0
    buffer_load_dwordx4 v52, s[12:15], s28 offen lds
    s_add_u32 m0, s29, 1024
    s_nop 0
    buffer_load_dwordx4 v53, s[12:15], s28 offen lds
    s_add_u32 m0, s29, 2048
    s_nop 0
    buffer_load_dwordx4 v54, s[12:15], s28 offen lds
    s_add_u32 m0, s29, 3072
    s_nop 0
    buffer_load_dwordx4 v55, s[12:15], s28 offen lds
    s_waitcnt vmcnt(36)
    s_barrier
    v_add_u32 v40, 147456, v60
    v_add_u32 v41, 147456, v61
    v_add_u32 v42, 147456, v62
    ds_read_b64_tr_b16 a[200:201], v40 offset:0
    ds_read_b64_tr_b16 a[202:203], v40 offset:512
    ds_read_b64_tr_b16 a[204:205], v40 offset:8192
    ds_read_b64_tr_b16 a[206:207], v40 offset:8704
    ds_read_b64_tr_b16 v[96:97], v41 offset:0
    ds_read_b64_tr_b16 v[98:99], v41 offset:512
    ds_read_b64_tr_b16 v[100:101], v41 offset:8192
    ds_read_b64_tr_b16 v[102:103], v41 offset:8704
    s_waitcnt lgkmcnt(0)
    s_barrier
    s_lshl_b32 s28, s19, 17
    s_lshl_b32 s29, s18, 8
    s_add_u32 s28, s28, s29
    s_add_u32 s28, s28, 4194304
    s_lshl_b32 s29, s19, 12
    s_add_u32 s29, s29, 147456
    s_add_u32 m0, s29, 0
    s_nop 0
    buffer_load_dwordx4 v52, s[12:15], s28 offen lds
    s_add_u32 m0, s29, 1024
    s_nop 0
    buffer_load_dwordx4 v53, s[12:15], s28 offen lds
    s_add_u32 m0, s29, 2048
    s_nop 0
    buffer_load_dwordx4 v54, s[12:15], s28 offen lds
    s_add_u32 m0, s29, 3072
    s_nop 0
    buffer_load_dwordx4 v55, s[12:15], s28 offen lds
    s_waitcnt vmcnt(36)
    s_barrier
    v_add_u32 v40, 0, v60
    v_add_u32 v41, 0, v61
    v_add_u32 v42, 0, v62
    ds_read_b64_tr_b16 a[208:209], v40 offset:0
    ds_read_b64_tr_b16 a[210:211], v40 offset:512
    ds_read_b64_tr_b16 a[212:213], v40 offset:8192
    ds_read_b64_tr_b16 a[214:215], v40 offset:8704
    ds_read_b64_tr_b16 v[104:105], v41 offset:0
    ds_read_b64_tr_b16 v[106:107], v41 offset:512
    ds_read_b64_tr_b16 v[108:109], v41 offset:8192
    ds_read_b64_tr_b16 v[110:111], v41 offset:8704
    s_waitcnt lgkmcnt(0)
    s_barrier
    v_lshrrev_b32 v45, 4, v0
    v_mul_u32_u24 v46, 12, v45
    v_add_u32 v46, 40, v46
    s_mov_b64 exec, 3
    global_load_dword v44, v46, s[16:17] sc1
    s_mov_b64 exec, -1
    v_lshlrev_b32 v47, 2, v45
    s_mov_b32 s28, 65011712
    buffer_load_dword v45, v47, s[4:7], s28 offen sc1
    s_waitcnt vmcnt(34)
    s_barrier
    v_add_u32 v40, 16384, v60
    v_add_u32 v41, 16384, v61
    v_add_u32 v42, 16384, v62
    ds_read_b64_tr_b16 v[64:65], v40 offset:0
    ds_read_b64_tr_b16 v[66:67], v40 offset:512
    ds_read_b64_tr_b16 v[68:69], v40 offset:8192
    ds_read_b64_tr_b16 v[70:71], v40 offset:8704
    ds_read_b64_tr_b16 v[72:73], v41 offset:0
    ds_read_b64_tr_b16 v[74:75], v41 offset:512
    ds_read_b64_tr_b16 v[76:77], v41 offset:8192
    ds_read_b64_tr_b16 v[78:79], v41 offset:8704
    s_waitcnt lgkmcnt(0)
    s_barrier
    s_lshl_b32 s28, s19, 11
    s_add_u32 s28, s28, 16384
    v_add_u32 v40, s28, v0
    ds_write_b128 v40, a[224:227] offset:0
    ds_write_b128 v40, a[228:231] offset:1024
    ds_write_b128 v40, a[232:235] offset:8192
    ds_write_b128 v40, a[236:239] offset:9216
    s_waitcnt lgkmcnt(0)
    v_accvgpr_write_b32 a224, v64
    v_accvgpr_write_b32 a225, v65
    v_accvgpr_write_b32 a226, v66
    v_accvgpr_write_b32 a227, v67
    v_accvgpr_write_b32 a228, v68
    v_accvgpr_write_b32 a229, v69
    v_accvgpr_write_b32 a230, v70
    v_accvgpr_write_b32 a231, v71
    v_accvgpr_write_b32 a232, v72
    v_accvgpr_write_b32 a233, v73
    v_accvgpr_write_b32 a234, v74
    v_accvgpr_write_b32 a235, v75
    v_accvgpr_write_b32 a236, v76
    v_accvgpr_write_b32 a237, v77
    v_accvgpr_write_b32 a238, v78
    v_accvgpr_write_b32 a239, v79
    s_waitcnt vmcnt(30)
    s_barrier
    v_add_u32 v40, 32768, v60
    v_add_u32 v41, 32768, v61
    v_add_u32 v42, 32768, v62
    ds_read_b64_tr_b16 v[64:65], v40 offset:0
    ds_read_b64_tr_b16 v[66:67], v40 offset:512
    ds_read_b64_tr_b16 v[68:69], v40 offset:8192
    ds_read_b64_tr_b16 v[70:71], v40 offset:8704
    ds_read_b64_tr_b16 v[72:73], v41 offset:0
    ds_read_b64_tr_b16 v[74:75], v41 offset:512
    ds_read_b64_tr_b16 v[76:77], v41 offset:8192
    ds_read_b64_tr_b16 v[78:79], v41 offset:8704
    s_waitcnt lgkmcnt(0)
    s_barrier
    s_lshl_b32 s28, s19, 11
    s_add_u32 s28, s28, 32768
    v_add_u32 v40, s28, v0
    ds_write_b128 v40, a[240:243] offset:0
    ds_write_b128 v40, a[244:247] offset:1024
    ds_write_b128 v40, a[248:251] offset:8192
    ds_write_b128 v40, a[252:255] offset:9216
    s_waitcnt lgkmcnt(0)
    v_accvgpr_write_b32 a240, v64
    v_accvgpr_write_b32 a241, v65
    v_accvgpr_write_b32 a242, v66
    v_accvgpr_write_b32 a243, v67
    v_accvgpr_write_b32 a244, v68
    v_accvgpr_write_b32 a245, v69
    v_accvgpr_write_b32 a246, v70
    v_accvgpr_write_b32 a247, v71
    v_accvgpr_write_b32 a248, v72
    v_accvgpr_write_b32 a249, v73
    v_accvgpr_write_b32 a250, v74
    v_accvgpr_write_b32 a251, v75
    v_accvgpr_write_b32 a252, v76
    v_accvgpr_write_b32 a253, v77
    v_accvgpr_write_b32 a254, v78
    v_accvgpr_write_b32 a255, v79
    s_waitcnt vmcnt(26)
    s_barrier
    v_add_u32 v40, 49152, v60
    v_add_u32 v41, 49152, v61
    v_add_u32 v42, 49152, v62
    ds_read_b64_tr_b16 v[64:65], v40 offset:0
    ds_read_b64_tr_b16 v[66:67], v40 offset:512
    ds_read_b64_tr_b16 v[68:69], v40 offset:8192
    ds_read_b64_tr_b16 v[70:71], v40 offset:8704
    ds_read_b64_tr_b16 v[72:73], v41 offset:0
    ds_read_b64_tr_b16 v[74:75], v41 offset:512
    ds_read_b64_tr_b16 v[76:77], v41 offset:8192
    ds_read_b64_tr_b16 v[78:79], v41 offset:8704
    s_waitcnt lgkmcnt(0)
    s_barrier
    s_lshl_b32 s28, s19, 11
    s_add_u32 s28, s28, 49152
    v_add_u32 v40, s28, v0
    ds_write_b128 v40, v[80:83] offset:0
    ds_write_b128 v40, v[84:87] offset:1024
    ds_write_b128 v40, v[88:91] offset:8192
    ds_write_b128 v40, v[92:95] offset:9216
    s_waitcnt lgkmcnt(0)
    v_mov_b32 v80, v64
    v_mov_b32 v81, v65
    v_mov_b32 v82, v66
    v_mov_b32 v83, v67
    v_mov_b32 v84, v68
    v_mov_b32 v85, v69
    v_mov_b32 v86, v70
    v_mov_b32 v87, v71
    v_mov_b32 v88, v72
    v_mov_b32 v89, v73
    v_mov_b32 v90, v74
    v_mov_b32 v91, v75
    v_mov_b32 v92, v76
    v_mov_b32 v93, v77
    v_mov_b32 v94, v78
    v_mov_b32 v95, v79
    s_waitcnt vmcnt(22)
    s_barrier
    v_add_u32 v40, 65536, v60
    v_add_u32 v41, 65536, v61
    v_add_u32 v42, 65536, v62
    ds_read_b64_tr_b16 v[64:65], v40 offset:0
    ds_read_b64_tr_b16 v[66:67], v40 offset:512
    ds_read_b64_tr_b16 v[68:69], v40 offset:8192
    ds_read_b64_tr_b16 v[70:71], v40 offset:8704
    ds_read_b64_tr_b16 v[72:73], v41 offset:0
    ds_read_b64_tr_b16 v[74:75], v41 offset:512
    ds_read_b64_tr_b16 v[76:77], v41 offset:8192
    ds_read_b64_tr_b16 v[78:79], v41 offset:8704
    s_waitcnt lgkmcnt(0)
    s_barrier
    s_lshl_b32 s28, s19, 11
    s_add_u32 s28, s28, 65536
    v_add_u32 v40, s28, v0
    ds_write_b128 v40, v[96:99] offset:0
    ds_write_b128 v40, v[100:103] offset:1024
    ds_write_b128 v40, v[104:107] offset:8192
    ds_write_b128 v40, v[108:111] offset:9216
    s_waitcnt lgkmcnt(0)
    v_mov_b32 v96, v64
    v_mov_b32 v97, v65
    v_mov_b32 v98, v66
    v_mov_b32 v99, v67
    v_mov_b32 v100, v68
    v_mov_b32 v101, v69
    v_mov_b32 v102, v70
    v_mov_b32 v103, v71
    v_mov_b32 v104, v72
    v_mov_b32 v105, v73
    v_mov_b32 v106, v74
    v_mov_b32 v107, v75
    v_mov_b32 v108, v76
    v_mov_b32 v109, v77
    v_mov_b32 v110, v78
    v_mov_b32 v111, v79
    s_waitcnt vmcnt(18)
    s_barrier
    v_add_u32 v40, 81920, v60
    v_add_u32 v41, 81920, v61
    v_add_u32 v42, 81920, v62
    ds_read_b64_tr_b16 v[64:65], v40 offset:0
    ds_read_b64_tr_b16 v[66:67], v40 offset:512
    ds_read_b64_tr_b16 v[68:69], v40 offset:8192
    ds_read_b64_tr_b16 v[70:71], v40 offset:8704
    ds_read_b64_tr_b16 v[72:73], v41 offset:0
    ds_read_b64_tr_b16 v[74:75], v41 offset:512
    ds_read_b64_tr_b16 v[76:77], v41 offset:8192
    ds_read_b64_tr_b16 v[78:79], v41 offset:8704
    s_waitcnt lgkmcnt(0)
    s_barrier
    s_lshl_b32 s28, s19, 11
    s_add_u32 s28, s28, 81920
    v_add_u32 v40, s28, v0
    ds_write_b128 v40, v[64:67] offset:0
    ds_write_b128 v40, v[68:71] offset:1024
    ds_write_b128 v40, v[72:75] offset:8192
    ds_write_b128 v40, v[76:79] offset:9216
    s_waitcnt lgkmcnt(0)
    s_waitcnt vmcnt(14)
    s_barrier
    v_add_u32 v40, 98304, v60
    v_add_u32 v41, 98304, v61
    v_add_u32 v42, 98304, v62
    ds_read_b64_tr_b16 v[64:65], v40 offset:0
    ds_read_b64_tr_b16 v[66:67], v40 offset:512
    ds_read_b64_tr_b16 v[68:69], v40 offset:8192
    ds_read_b64_tr_b16 v[70:71], v40 offset:8704
    ds_read_b64_tr_b16 v[72:73], v41 offset:0
    ds_read_b64_tr_b16 v[74:75], v41 offset:512
    ds_read_b64_tr_b16 v[76:77], v41 offset:8192
    ds_read_b64_tr_b16 v[78:79], v41 offset:8704
    s_waitcnt lgkmcnt(0)
    s_barrier
    s_lshl_b32 s28, s19, 11
    s_add_u32 s28, s28, 98304
    v_add_u32 v40, s28, v0
    ds_write_b128 v40, v[64:67] offset:0
    ds_write_b128 v40, v[68:71] offset:1024
    ds_write_b128 v40, v[72:75] offset:8192
    ds_write_b128 v40, v[76:79] offset:9216
    s_waitcnt lgkmcnt(0)
    s_waitcnt vmcnt(10)
    s_barrier
    v_add_u32 v40, 114688, v60
    v_add_u32 v41, 114688, v61
    v_add_u32 v42, 114688, v62
    ds_read_b64_tr_b16 v[64:65], v40 offset:0
    ds_read_b64_tr_b16 v[66:67], v40 offset:512
    ds_read_b64_tr_b16 v[68:69], v40 offset:8192
    ds_read_b64_tr_b16 v[70:71], v40 offset:8704
    ds_read_b64_tr_b16 v[72:73], v41 offset:0
    ds_read_b64_tr_b16 v[74:75], v41 offset:512
    ds_read_b64_tr_b16 v[76:77], v41 offset:8192
    ds_read_b64_tr_b16 v[78:79], v41 offset:8704
    s_waitcnt lgkmcnt(0)
    s_barrier
    s_lshl_b32 s28, s19, 11
    s_add_u32 s28, s28, 114688
    v_add_u32 v40, s28, v0
    ds_write_b128 v40, v[64:67] offset:0
    ds_write_b128 v40, v[68:71] offset:1024
    ds_write_b128 v40, v[72:75] offset:8192
    ds_write_b128 v40, v[76:79] offset:9216
    s_waitcnt lgkmcnt(0)
    s_waitcnt vmcnt(6)
    s_barrier
    v_add_u32 v40, 131072, v60
    v_add_u32 v41, 131072, v61
    v_add_u32 v42, 131072, v62
    ds_read_b64_tr_b16 v[64:65], v40 offset:0
    ds_read_b64_tr_b16 v[66:67], v40 offset:512
    ds_read_b64_tr_b16 v[68:69], v40 offset:8192
    ds_read_b64_tr_b16 v[70:71], v40 offset:8704
    ds_read_b64_tr_b16 v[72:73], v41 offset:0
    ds_read_b64_tr_b16 v[74:75], v41 offset:512
    ds_read_b64_tr_b16 v[76:77], v41 offset:8192
    ds_read_b64_tr_b16 v[78:79], v41 offset:8704
    s_waitcnt lgkmcnt(0)
    s_barrier
    s_lshl_b32 s28, s19, 11
    s_add_u32 s28, s28, 131072
    v_add_u32 v40, s28, v0
    ds_write_b128 v40, v[64:67] offset:0
    ds_write_b128 v40, v[68:71] offset:1024
    ds_write_b128 v40, v[72:75] offset:8192
    ds_write_b128 v40, v[76:79] offset:9216
    s_waitcnt lgkmcnt(0)
    s_waitcnt vmcnt(2)
    s_barrier
    v_add_u32 v40, 147456, v60
    v_add_u32 v41, 147456, v61
    v_add_u32 v42, 147456, v62
    ds_read_b64_tr_b16 v[64:65], v40 offset:0
    ds_read_b64_tr_b16 v[66:67], v40 offset:512
    ds_read_b64_tr_b16 v[68:69], v40 offset:8192
    ds_read_b64_tr_b16 v[70:71], v40 offset:8704
    ds_read_b64_tr_b16 v[72:73], v41 offset:0
    ds_read_b64_tr_b16 v[74:75], v41 offset:512
    ds_read_b64_tr_b16 v[76:77], v41 offset:8192
    ds_read_b64_tr_b16 v[78:79], v41 offset:8704
    s_waitcnt lgkmcnt(0)
    s_barrier
    s_lshl_b32 s28, s19, 11
    s_add_u32 s28, s28, 147456
    v_add_u32 v40, s28, v0
    ds_write_b128 v40, v[64:67] offset:0
    ds_write_b128 v40, v[68:71] offset:1024
    ds_write_b128 v40, v[72:75] offset:8192
    ds_write_b128 v40, v[76:79] offset:9216
    s_waitcnt lgkmcnt(0)
    s_barrier
    s_mov_b32 s12, s45
    s_waitcnt vmcnt(0)
    v_readlane_b32 s28, v44, 0
    v_readlane_b32 s29, v44, 1
    v_cmp_ne_u32 vcc, 32, v45
    s_nop 0
    s_ff1_i32_b64 s10, vcc
    s_cmp_eq_u32 s10, -1
    s_cselect_b32 s10, 64, s10
    s_mov_b32 s14, 1
    s_cmp_lt_u32 s28, 32
    s_cselect_b32 s14, 0, s14
    s_cmp_eq_u32 s29, 0
    s_cselect_b32 s14, 0, s14
    s_cmp_lt_u32 s10, 3
    s_cselect_b32 s14, 0, s14
    s_cmp_lg_u32 s14, 0
    s_cbranch_scc1 initd_10
    s_mov_b32 s27, 0
    v_lshrrev_b32 v45, 4, v0
    v_mul_u32_u24 v45, 12, v45
    v_add_u32 v45, 40, v45
    s_mov_b64 exec, 3
initw_9:
    global_load_dword v44, v45, s[16:17] sc1
    s_waitcnt vmcnt(0)
    v_readlane_b32 s28, v44, 0
    v_readlane_b32 s29, v44, 1
    s_add_u32 s27, s27, 1
    s_cmp_eq_u32 s29, 0
    s_cselect_b32 s28, 0, s28
    s_cmp_ge_u32 s28, 32
    s_cbranch_scc1 initd_10
    s_cmp_lt_u32 s27, 0x40000
    s_cbranch_scc1 initw_9
initd_10:
    s_mov_b64 exec, -1
    s_mov_b32 s20, 0
    s_mov_b32 s27, 0
    s_mov_b32 s71, 0
    s_mov_b32 s61, 0
    s_lshl_b32 s28, s19, 1
    s_cmp_eq_u32 s19, 2
    s_cselect_b32 s28, 6, s28
    s_cmp_eq_u32 s19, 3
    s_cselect_b32 s28, 4, s28
    s_lshl_b32 s57, s28, 10
    s_add_u32 s21, s57, 63438848
    s_add_u32 s60, s21, 36864
    s_lshl_b32 s28, s19, 5
    s_add_u32 s28, s28, s18
    s_cmp_lt_u32 s19, 3
    s_cselect_b32 s45, 1, 0
    s_lshl_b32 s41, s28, 12
    s_add_u32 s41, s41, 63963136
    s_mul_i32 s22, s19, 3072
    s_lshr_b32 s29, s18, 3
    s_lshl_b32 s29, s29, 8
    s_add_u32 s22, s22, s29
    s_bfe_u32 s29, s18, 0x20001
    s_lshl_b32 s29, s29, 6
    s_add_u32 s22, s22, s29
    s_and_b32 s29, s18, 1
    s_lshl_b32 s29, s29, 5
    s_add_u32 s22, s22, s29
    s_add_u32 s22, s22, 63448064
    s_mov_b32 s59, 0x00000055
    s_mov_b32 s58, 0x00550055
    s_cmp_eq_u32 s19, 2
    s_cselect_b32 s42, 1, 0
    s_mul_i32 s65, s19, 768
    s_add_u32 s65, s65, 6144
    s_sub_u32 s64, s65, s57
    s_mov_b32 s34, -1
    s_mov_b32 s35, 0xffff
    s_cmp_eq_u32 s19, 3
    s_cselect_b32 s46, -1, 0
    s_mov_b32 s47, s46
    s_lshl_b32 s48, s19, 11
    s_add_u32 s39, s22, 18432
    s_add_u32 s40, s22, 27648
    s_lshl_b32 s28, s18, 13
    s_lshl_b32 s29, s19, 11
    s_add_u32 s28, s28, s29
    s_add_u32 s23, s28, 0
    s_add_u32 s24, s28, 16777216
    s_lshr_b32 s29, s28, 1
    s_add_u32 s25, s29, 50331648
    s_lshr_b32 s29, s28, 2
    s_add_u32 s26, s29, 58720256
    s_lshl_b32 s28, s19, 15
    s_mov_b32 s29, 0
    s_add_u32 s28, s28, s29
    s_add_u32 s36, s28, 63963136
    s_add_u32 s37, s36, 131072
    s_add_u32 s38, s36, 262144
    s_add_u32 s66, s21, s64
    s_lshl_b32 s11, s18, 8
    s_add_u32 s11, s11, 65015808
    s_cmp_eq_u32 s19, 0
    s_cselect_b32 s8, 1, 0
    s_mov_b32 s9, 0
    s_cmp_lg_u32 s14, 0
    s_cbranch_scc1 have_rdy_12
    s_mov_b32 s10, 0
    s_add_u32 s29, s20, 2
    s_min_u32 s29, s29, 63
    s_cmp_lt_u32 s29, s10
    s_cbranch_scc1 rdy_ok_14
    s_add_u32 s29, s20, 2
    s_min_u32 s29, s29, 63
    s_mov_b32 s30, 0
    v_lshrrev_b32 v52, 2, v0
    s_mov_b32 s28, 65011712
rdy_13:
    buffer_load_dword v53, v52, s[4:7], s28 offen sc1
    s_waitcnt vmcnt(0)
    v_cmp_ne_u32 vcc, 32, v53
    s_nop 0
    s_ff1_i32_b64 s10, vcc
    s_cmp_eq_u32 s10, -1
    s_cselect_b32 s10, 64, s10
    s_cmp_lt_u32 s29, s10
    s_cbranch_scc1 rdy_ok_14
    s_sleep 8
    s_add_u32 s30, s30, 1
    s_cmp_lt_u32 s30, 0x80000
    s_cbranch_scc1 rdy_13
    s_mov_b32 s10, 64
rdy_ok_14:
have_rdy_12:
    v_lshlrev_b32 v52, 3, v0
    s_lshl_b32 s28, s18, 13
    s_and_b32 s29, s19, 1
    s_lshr_b32 s30, s19, 1
    s_add_u32 s29, s29, s30
    s_lshl_b32 s29, s29, 18
    s_add_u32 s28, s28, s29
    s_cmp_ge_u32 s19, 2
    s_cselect_b32 s30, 0, 16777216
    s_add_u32 s28, s28, s30
    buffer_load_dword v27, v52, s[4:7], s28 offen
    buffer_load_dwordx4 v[10:13], v0, s[4:7], s23 offen offset:0 sc1
    buffer_load_dwordx4 v[14:17], v0, s[4:7], s23 offen offset:1024 sc1
    s_add_u32 s23, s23, 262144
    s_cmp_lg_u32 s12, 0
    s_cbranch_scc1 L_chain_global
chain_loop_15:
    s_cmp_lg_u32 s19, 3
    s_cbranch_scc1 nochk_16
    s_add_u32 s29, s20, 2
    s_min_u32 s29, s29, 63
    s_cmp_lt_u32 s29, s10
    s_cbranch_scc1 rdy_ok_18
    s_add_u32 s29, s20, 1
    s_min_u32 s29, s29, 63
    s_mov_b32 s30, 0
    v_lshrrev_b32 v52, 2, v0
    s_mov_b32 s28, 65011712
rdy_17:
    buffer_load_dword v53, v52, s[4:7], s28 offen sc1
    s_waitcnt vmcnt(0)
    v_cmp_ne_u32 vcc, 32, v53
    s_nop 0
    s_ff1_i32_b64 s10, vcc
    s_cmp_eq_u32 s10, -1
    s_cselect_b32 s10, 64, s10
    s_cmp_lt_u32 s29, s10
    s_cbranch_scc1 rdy_ok_18
    s_sleep 8
    s_add_u32 s30, s30, 1
    s_cmp_lt_u32 s30, 0x80000
    s_cbranch_scc1 rdy_17
    s_mov_b32 s10, 64
rdy_ok_18:
nochk_16:
    ds_read_b128 v[64:67], v26 offset:0
    ds_read_b128 v[68:71], v26 offset:1024
    ds_read_b128 v[72:75], v26 offset:8192
    ds_read_b128 v[76:79], v26 offset:9216
    v_mov_b64 v[32:33], 0
    v_mov_b64 v[34:35], 0
    v_mov_b64 v[36:37], 0
    v_mov_b64 v[38:39], 0
    v_mov_b64 v[40:41], 0
    v_mov_b64 v[42:43], 0
    v_mov_b64 v[44:45], 0
    v_mov_b64 v[46:47], 0
    v_add_u32 v55, s57, v0
    s_cmp_eq_u32 s19, 2
    s_cbranch_scc1 acq_w2_22
    s_cmp_lg_u32 s19, 3
    s_cbranch_scc1 nd3_23
    s_nop 15
    s_nop 15
    s_nop 15
    s_nop 15
    s_nop 15
    s_nop 15
    s_nop 15
    s_nop 15
    s_nop 15
    s_nop 15
nd3_23:
    s_nop 15
mem_poll_19:
    buffer_load_dwordx4 v[56:59], v0, s[4:7], s21 offen sc1
    buffer_load_dwordx4 v[60:63], v0, s[4:7], s21 offen offset:1024 sc1
    s_add_u32 s27, s27, 1
    s_waitcnt vmcnt(1)
    ds_write_b128 v55, v[56:59] offset:0
    v_max3_u32 v52, v56, v57, v58
    s_waitcnt vmcnt(0)
    ds_write_b128 v55, v[60:63] offset:1024
    v_max3_u32 v52, v52, v59, v60
    v_max3_u32 v52, v52, v61, v62
    v_max_u32 v52, v52, v63
    v_cmp_eq_u32 vcc, -1, v52
    s_cbranch_vccz mem_done_20
    s_cmp_lt_u32 s27, 0x200000
    s_cbranch_scc1 mem_poll_19
    s_branch mem_done_20
acq_w2_22:
    s_nop 15
    s_nop 15
mem_poll2_21:
    buffer_load_dwordx4 v[56:59], v0, s[4:7], s21 offen sc1
    buffer_load_dwordx4 v[60:63], v0, s[4:7], s21 offen offset:1024 sc1
    buffer_load_dwordx4 v[48:51], v0, s[4:7], s21 offen offset:2048 sc1
    s_add_u32 s61, s61, 1
    s_waitcnt vmcnt(2)
    ds_write_b128 v55, v[56:59] offset:0
    v_max3_u32 v52, v56, v57, v58
    s_waitcnt vmcnt(1)
    ds_write_b128 v55, v[60:63] offset:1024
    v_max3_u32 v52, v52, v59, v60
    v_max3_u32 v52, v52, v61, v62
    s_waitcnt vmcnt(0)
    ds_write_b128 v55, v[48:51] offset:2048
    v_max3_u32 v52, v52, v63, v48
    v_max3_u32 v52, v52, v49, v50
    v_max_u32 v52, v52, v51
    v_cmp_eq_u32 vcc, -1, v52
    s_cbranch_vccz mem_done_20
    s_cmp_lt_u32 s61, 0x200000
    s_cbranch_scc1 mem_poll2_21
mem_done_20:
    s_waitcnt lgkmcnt(0)
    s_barrier
    ds_read_b128 v[56:59], v0 offset:0
    ds_read_b128 v[60:63], v0 offset:1024
    s_add_u32 s67, s20, 1
    s_max_u32 s13, s20, 1
    s_sub_u32 s13, s13, 1
    s_waitcnt lgkmcnt(1)
    v_smfmac_f32_16x16x64_bf16 v[32:35], v[56:59], a[0:7], v1
    ds_read_b128 v[48:51], v0 offset:2048
    v_smfmac_f32_16x16x64_bf16 v[36:39], v[56:59], a[72:79], v1
    buffer_load_dwordx4 v[18:21], v0, s[4:7], s24 offen offset:0 sc1
    v_smfmac_f32_16x16x64_bf16 v[40:43], v[56:59], a[144:151], v1
    s_add_u32 s21, s21, 9216
    s_cmp_ge_u32 s21, s60
    v_smfmac_f32_16x16x64_bf16 v[44:47], v[56:59], a[216:223], v1
    buffer_load_dwordx4 v[22:25], v0, s[4:7], s24 offen offset:1024 sc1
    s_waitcnt lgkmcnt(1)
    v_smfmac_f32_16x16x64_bf16 v[32:35], v[60:63], a[8:15], v1
    ds_read_b128 v[56:59], v0 offset:3072
    v_smfmac_f32_16x16x64_bf16 v[36:39], v[60:63], a[80:87], v1
    s_cselect_b32 s28, 36864, 0
    s_sub_u32 s21, s21, s28
    v_smfmac_f32_16x16x64_bf16 v[40:43], v[60:63], a[152:159], v1
    v_lshrrev_b32 v52, 1, v0
    v_smfmac_f32_16x16x64_bf16 v[44:47], v[60:63], v[64:71], v1
    buffer_store_dwordx2 v[28:29], v52, s[4:7], s26 offen sc1
    s_waitcnt lgkmcnt(1)
    v_smfmac_f32_16x16x64_bf16 v[32:35], v[48:51], a[16:23], v1
    ds_read_b128 v[60:63], v0 offset:4096
    v_smfmac_f32_16x16x64_bf16 v[36:39], v[48:51], a[88:95], v1
    ds_read_b128 v[64:67], v26 offset:16384
    v_smfmac_f32_16x16x64_bf16 v[40:43], v[48:51], a[160:167], v1
    ds_read_b128 v[68:71], v26 offset:17408
    v_smfmac_f32_16x16x64_bf16 v[44:47], v[48:51], v[72:79], v1
    v_mov_b32 v53, s13
    s_waitcnt lgkmcnt(3)
    v_smfmac_f32_16x16x64_bf16 v[32:35], v[56:59], a[24:31], v1
    ds_read_b128 v[48:51], v0 offset:5120
    v_smfmac_f32_16x16x64_bf16 v[36:39], v[56:59], a[96:103], v1
    ds_read_b128 v[72:75], v26 offset:24576
    v_smfmac_f32_16x16x64_bf16 v[40:43], v[56:59], a[168:175], v1
    ds_read_b128 v[76:79], v26 offset:25600
    s_waitcnt lgkmcnt(3)
    v_smfmac_f32_16x16x64_bf16 v[44:47], v[56:59], v[64:71], v1
    s_mov_b64 exec, s[8:9]
    buffer_store_dword v53, v3, s[4:7], s11 offen sc1
    s_mov_b64 exec, -1
    v_smfmac_f32_16x16x64_bf16 v[32:35], v[60:63], a[32:39], v1
    ds_read_b128 v[56:59], v0 offset:6144
    v_smfmac_f32_16x16x64_bf16 v[36:39], v[60:63], a[104:111], v1
    ds_read_b128 v[64:67], v26 offset:32768
    v_smfmac_f32_16x16x64_bf16 v[40:43], v[60:63], a[176:183], v1
    ds_read_b128 v[68:71], v26 offset:33792
    s_waitcnt lgkmcnt(3)
    v_smfmac_f32_16x16x64_bf16 v[44:47], v[60:63], v[72:79], v1
    s_sub_u32 s28, s24, s48
    s_add_u32 s28, s28, 262144
    v_lshlrev_b32 v27, 3, v0
    v_smfmac_f32_16x16x64_bf16 v[32:35], v[48:51], a[40:47], v1
    ds_read_b128 v[60:63], v0 offset:7168
    v_smfmac_f32_16x16x64_bf16 v[36:39], v[48:51], a[112:119], v1
    ds_read_b128 v[72:75], v26 offset:40960
    v_smfmac_f32_16x16x64_bf16 v[40:43], v[48:51], a[184:191], v1
    ds_read_b128 v[76:79], v26 offset:41984
    s_waitcnt lgkmcnt(3)
    v_smfmac_f32_16x16x64_bf16 v[44:47], v[48:51], v[64:71], v1
    s_sub_u32 s29, s23, s48
    s_add_u32 s29, s29, 262144
    s_add_u32 s30, s20, 2
    s_cmp_lt_u32 s30, s10
    s_cselect_b32 s29, s29, s28
    v_smfmac_f32_16x16x64_bf16 v[32:35], v[56:59], a[48:55], v1
    ds_read_b128 v[48:51], v0 offset:8192
    v_smfmac_f32_16x16x64_bf16 v[36:39], v[56:59], a[120:127], v1
    ds_read_b128 v[64:67], v26 offset:49152
    v_smfmac_f32_16x16x64_bf16 v[40:43], v[56:59], a[192:199], v1
    ds_read_b128 v[68:71], v26 offset:50176
    s_waitcnt lgkmcnt(3)
    v_smfmac_f32_16x16x64_bf16 v[44:47], v[56:59], v[72:79], v1
    s_mov_b64 exec, s[46:47]
    buffer_load_dword v27, v27, s[4:7], s28 offen
    buffer_load_dword v27, v27, s[4:7], s29 offen
    s_mov_b64 exec, -1
    v_smfmac_f32_16x16x64_bf16 v[32:35], v[60:63], a[56:63], v1
    ds_read_b128 v[72:75], v26 offset:57344
    v_smfmac_f32_16x16x64_bf16 v[36:39], v[60:63], a[128:135], v1
    ds_read_b128 v[76:79], v26 offset:58368
    v_smfmac_f32_16x16x64_bf16 v[40:43], v[60:63], a[200:207], v1
    s_waitcnt lgkmcnt(2)
    v_smfmac_f32_16x16x64_bf16 v[44:47], v[60:63], v[64:71], v1
    v_smfmac_f32_16x16x64_bf16 v[32:35], v[48:51], a[64:71], v1
    v_add_u32 v26, 0x10000, v26
    ds_read_b128 v[64:67], v26 offset:0
    v_smfmac_f32_16x16x64_bf16 v[36:39], v[48:51], a[136:143], v1
    ds_read_b128 v[68:71], v26 offset:1024
    v_smfmac_f32_16x16x64_bf16 v[40:43], v[48:51], a[208:215], v1
    s_waitcnt lgkmcnt(2)
    v_smfmac_f32_16x16x64_bf16 v[44:47], v[48:51], v[72:79], v1
    v_add_f32 v32, v32, v34
    v_add_f32 v33, v33, v35
    v_add_f32 v36, v36, v38
    v_add_f32 v37, v37, v39
    v_cvt_pk_bf16_f32 v34, v32, v33
    v_cvt_pk_bf16_f32 v35, v36, v37
    v_add_f32 v40, v40, v42
    v_add_f32 v41, v41, v43
    v_mov_b64 v[52:53], 0
    v_mov_b64 v[54:55], 0
    v_add_f32 v44, v44, v46
    v_add_f32 v45, v45, v47
    v_cvt_pk_bf16_f32 v42, v40, v41
    v_cvt_pk_bf16_f32 v43, v44, v45
    v_mfma_f32_16x16x16_bf16 v[36:39], v[34:35], v[2:3], 0
    v_mov_b64 v[48:49], 0
    v_mov_b64 v[50:51], 0
    v_mfma_f32_16x16x16_bf16 v[32:35], v[34:35], v[4:5], 0
    v_mfma_f32_16x16x16_bf16 v[44:47], v[42:43], v[6:7], 0
    v_mfma_f32_16x16x16_bf16 v[40:43], v[42:43], v[8:9], 0
    v_cvt_pk_bf16_f32 v36, v36, v37
    v_cvt_pk_bf16_f32 v37, v38, v39
    v_cvt_pk_bf16_f32 v38, v32, v33
    v_cvt_pk_bf16_f32 v39, v34, v35
    s_nop 1
    v_mfma_f32_16x16x32_bf16 v[32:35], v[10:13], v[36:39], 0
    v_cvt_pk_bf16_f32 v44, v44, v45
    v_cvt_pk_bf16_f32 v45, v46, v47
    v_cvt_pk_bf16_f32 v46, v40, v41
    v_cvt_pk_bf16_f32 v47, v42, v43
    v_mfma_f32_16x16x32_bf16 v[40:43], v[14:17], v[36:39], 0
    s_nop 0
    v_mfma_f32_16x16x32_bf16 v[36:39], v[44:47], v[36:39], 0
    v_and_b32 v16, 0x70, v0
    v_lshrrev_b32 v17, 1, v0
    v_and_b32 v17, 0x180, v17
    v_or_b32 v16, v16, v17
    v_lshrrev_b32 v17, 1, v16
    v_and_b32 v10, 0x80, v0
    v_lshl_add_u32 v16, v10, 2, v16
    v_smfmac_f32_16x16x64_bf16 v[48:51], v[56:59], a[224:231], v1
    ds_read_b128 v[72:75], v26 offset:8192
    v_smfmac_f32_16x16x64_bf16 v[52:55], v[56:59], a[232:239], v1
    ds_read_b128 v[76:79], v26 offset:9216
    ds_read_b128 v[56:59], v0 offset:0
    v_add_u32 v16, 10240, v16
    v_add_u32 v17, 9216, v17
    v_add_u32 v10, s43, v16
    v_add_u32 v11, s44, v17
    v_cndmask_b32_e64 v32, v40, v32, s[32:33]
    v_cndmask_b32_e64 v33, v41, v33, s[32:33]
    v_cndmask_b32_e64 v34, v42, v34, s[32:33]
    v_cndmask_b32_e64 v35, v43, v35, s[32:33]
    ds_write_b128 v10, v[32:35]
    ds_write_b64 v11, v[36:37]
    v_smfmac_f32_16x16x64_bf16 v[48:51], v[60:63], a[240:247], v1
    v_smfmac_f32_16x16x64_bf16 v[52:55], v[60:63], a[248:255], v1
    ds_read_b128 v[60:63], v0 offset:1024
    s_waitcnt lgkmcnt(3)
    v_smfmac_f32_16x16x64_bf16 v[48:51], v[56:59], v[80:87], v1
    v_smfmac_f32_16x16x64_bf16 v[52:55], v[56:59], v[88:95], v1
    ds_read_b128 v[56:59], v0 offset:2048
    buffer_store_dwordx4 v[44:47], v0, s[4:7], s25 offen sc1
    s_waitcnt lgkmcnt(2)
    s_barrier
    ds_read_b128 v[32:35], v16 offset:0
    ds_read_b128 v[36:39], v16 offset:1024
    ds_read_b128 v[40:43], v16 offset:2048
    ds_read_b128 v[44:47], v16 offset:3072
    ds_read2_b64 v[10:13], v17 offset0:0 offset1:32
    ds_read2_b64 v[14:17], v17 offset0:64 offset1:96
    s_waitcnt lgkmcnt(7)
    v_smfmac_f32_16x16x64_bf16 v[48:51], v[60:63], v[96:103], v1
    v_smfmac_f32_16x16x64_bf16 v[52:55], v[60:63], v[104:111], v1
    ds_read_b128 v[60:63], v0 offset:3072
    s_waitcnt lgkmcnt(7)
    v_smfmac_f32_16x16x64_bf16 v[48:51], v[56:59], v[64:71], v1
    ds_read_b128 v[64:67], v26 offset:16384
    ds_read_b128 v[68:71], v26 offset:17408
    s_waitcnt lgkmcnt(7)
    v_pk_add_f32 v[32:33], v[32:33], v[36:37]
    v_pk_add_f32 v[34:35], v[34:35], v[38:39]
    s_waitcnt lgkmcnt(5)
    v_pk_add_f32 v[40:41], v[40:41], v[44:45]
    v_pk_add_f32 v[42:43], v[42:43], v[46:47]
    v_pk_add_f32 v[32:33], v[32:33], v[40:41]
    v_pk_add_f32 v[34:35], v[34:35], v[42:43]
    v_max3_f32 v38, v32, v33, v34
    s_waitcnt lgkmcnt(4)
    v_pk_add_f32 v[10:11], v[10:11], v[12:13]
    s_waitcnt lgkmcnt(3)
    v_pk_add_f32 v[14:15], v[14:15], v[16:17]
    v_pk_add_f32 v[36:37], v[10:11], v[14:15]
    v_smfmac_f32_16x16x64_bf16 v[52:55], v[56:59], v[72:79], v1
    ds_read_b128 v[72:75], v26 offset:24576
    ds_read_b128 v[76:79], v26 offset:25600
    ds_read_b128 v[56:59], v0 offset:4096
    s_waitcnt lgkmcnt(3)
    v_smfmac_f32_16x16x64_bf16 v[48:51], v[60:63], v[64:71], v1
    ds_read_b128 v[64:67], v26 offset:32768
    ds_read_b128 v[68:71], v26 offset:33792
    buffer_load_dwordx4 v[10:13], v0, s[4:7], s23 offen offset:0 sc1
    buffer_load_dwordx4 v[14:17], v0, s[4:7], s23 offen offset:1024 sc1
    v_max3_f32 v38, v38, v35, v36
    v_max_f32 v38, v38, v37
    s_waitcnt lgkmcnt(3)
    v_smfmac_f32_16x16x64_bf16 v[52:55], v[60:63], v[72:79], v1
    ds_read_b128 v[72:75], v26 offset:40960
    ds_read_b128 v[76:79], v26 offset:41984
    ds_read_b128 v[60:63], v0 offset:5120
    s_waitcnt lgkmcnt(3)
    v_smfmac_f32_16x16x64_bf16 v[48:51], v[56:59], v[64:71], v1
    ds_read_b128 v[64:67], v26 offset:49152
    ds_read_b128 v[68:71], v26 offset:50176
    v_max_f32_dpp v38, v38, v38 row_ror:8 row_mask:0xf bank_mask:0xf
    v_mov_b32 v39, v38
    v_mov_b32 v45, 0
    v_mov_b32 v46, 0
    v_permlane16_swap_b32 v38, v39
    v_max_f32 v38, v38, v39
    v_mov_b32 v39, v38
    s_waitcnt lgkmcnt(3)
    v_smfmac_f32_16x16x64_bf16 v[52:55], v[56:59], v[72:79], v1
    ds_read_b128 v[72:75], v26 offset:57344
    ds_read_b128 v[76:79], v26 offset:58368
    ds_read_b128 v[56:59], v0 offset:8192
    s_waitcnt lgkmcnt(3)
    v_smfmac_f32_16x16x64_bf16 v[48:51], v[60:63], v[64:71], v1
    v_add_u32 v26, 0x10000, v26
    ds_read_b128 v[64:67], v26 offset:0
    ds_read_b128 v[68:71], v26 offset:1024
    v_permlane32_swap_b32 v38, v39
    v_max_f32 v38, v38, v39
    v_mul_f32 v38, s31, v38
    v_fma_f32 v32, v32, s31, -v38
    v_fma_f32 v33, v33, s31, -v38
    v_fma_f32 v34, v34, s31, -v38
    v_fma_f32 v35, v35, s31, -v38
    v_fma_f32 v36, v36, s31, -v38
    v_fma_f32 v37, v37, s31, -v38
    s_waitcnt lgkmcnt(3)
    v_smfmac_f32_16x16x64_bf16 v[52:55], v[60:63], v[72:79], v1
    ds_read_b128 v[72:75], v26 offset:8192
    ds_read_b128 v[76:79], v26 offset:9216
    s_waitcnt lgkmcnt(2)
    v_smfmac_f32_16x16x64_bf16 v[48:51], v[56:59], v[64:71], v1
    s_waitcnt lgkmcnt(0)
    v_smfmac_f32_16x16x64_bf16 v[52:55], v[56:59], v[72:79], v1
    v_exp_f32 v32, v32
    v_exp_f32 v33, v33
    v_exp_f32 v34, v34
    v_exp_f32 v35, v35
    v_exp_f32 v36, v36
    v_exp_f32 v37, v37
    v_cvt_pk_bf16_f32 v40, v32, v33
    v_cvt_pk_bf16_f32 v41, v34, v35
    v_cvt_pk_bf16_f32 v44, v36, v37
    v_mov_b64 v[36:37], s[68:69]
    v_mov_b64 v[38:39], s[68:69]
    v_mov_b32_dpp v42, v40 row_ror:8 row_mask:0xf bank_mask:0xf
    v_mov_b32_dpp v43, v41 row_ror:8 row_mask:0xf bank_mask:0xf
    v_mov_b32 v47, v44
    s_waitcnt vmcnt(8)
    v_mfma_f32_16x16x32_bf16 v[32:35], v[18:21], v[40:43], 0
    v_subrev_u32 v26, 0x20000, v26
    v_add_f32 v48, v48, v50
    v_add_f32 v49, v49, v51
    v_add_f32 v52, v52, v54
    v_add_f32 v53, v53, v55
    v_cvt_pk_bf16_f32 v50, v48, v49
    v_cvt_pk_bf16_f32 v51, v52, v53
    v_mfma_f32_16x16x32_bf16 v[56:59], v[36:39], v[40:43], 0
    v_mov_b64 v[28:29], v[50:51]
    v_bfe_u32 v61, v0, 4, 3
    s_waitcnt vmcnt(7)
    v_mfma_f32_16x16x32_bf16 v[52:55], v[22:25], v[40:43], 0
    v_bfe_u32 v62, v0, 9, 1
    v_add_u32 v62, s70, v62
    v_mfma_f32_16x16x16_bf16 v[32:35], v[50:51], v[44:45], v[32:35]
    v_xor_b32 v62, v62, v61
    v_lshlrev_b32 v62, 4, v62
    v_mfma_f32_16x16x16_bf16 v[56:59], v[36:37], v[44:45], v[56:59]
    v_lshl_add_u32 v62, v61, 8, v62
    v_bfe_u32 v61, v0, 8, 1
    v_mfma_f32_16x16x16_bf16 v[52:55], v[50:51], v[46:47], v[52:55]
    v_lshl_add_u32 v62, v61, 3, v62
    v_add_u32 v62, 14336, v62
    v_xor_b32 v63, 32, v62
    s_nop 0
    v_rcp_f32 v56, v56
    s_nop 0
    v_mul_f32 v32, v32, v56
    v_mul_f32 v33, v33, v56
    v_mul_f32 v34, v34, v56
    v_mul_f32 v35, v35, v56
    v_mul_f32 v52, v52, v56
    v_mul_f32 v53, v53, v56
    v_mul_f32 v54, v54, v56
    v_mul_f32 v55, v55, v56
    v_cvt_pk_bf16_f32 v32, v32, v33
    v_cvt_pk_bf16_f32 v33, v34, v35
    v_cvt_pk_bf16_f32 v52, v52, v53
    v_cvt_pk_bf16_f32 v53, v54, v55
    s_mov_b64 exec, s[32:33]
    ds_write_b64 v62, v[32:33]
    ds_write_b64 v63, v[52:53]
    s_mov_b64 exec, -1
    v_mov_b32 v71, s67
    v_mov_b64 v[34:35], 0
    v_mov_b64 v[36:37], 0
    v_mov_b64 v[38:39], 0
    v_mov_b64 v[40:41], 0
    v_mov_b64 v[42:43], 0
    v_mov_b64 v[44:45], 0
    v_mov_b64 v[46:47], 0
    v_mov_b64 v[48:49], 0
    v_mov_b64 v[50:51], 0
    v_mov_b64 v[54:55], 0
    v_mov_b64 v[56:57], 0
    v_mov_b64 v[58:59], 0
    v_mov_b64 v[60:61], 0
    v_mov_b64 v[64:65], 0
    v_mov_b64 v[66:67], 0
    s_waitcnt lgkmcnt(0)
    s_barrier
    ds_read_b128 v[72:75], v31
    ds_read_b128 v[76:79], v31 offset:128
    v_mov_b64 v[32:33], 0
    v_mov_b64 v[52:53], 0
    v_mov_b64 v[62:63], 0
    s_waitcnt lgkmcnt(1)
    v_smfmac_f32_16x16x64_bf16 v[32:35], v[72:75], v[112:119], v1
    v_smfmac_f32_16x16x64_bf16 v[36:39], v[72:75], v[128:135], v1
    s_waitcnt lgkmcnt(0)
    v_smfmac_f32_16x16x64_bf16 v[32:35], v[76:79], v[120:127], v1
    v_smfmac_f32_16x16x64_bf16 v[36:39], v[76:79], v[136:143], v1
    v_smfmac_f32_16x16x64_bf16 v[40:43], v[72:75], v[144:151], v1
    v_add_f32 v32, v32, v34
    v_add_f32 v33, v33, v35
    v_smfmac_f32_16x16x64_bf16 v[40:43], v[76:79], v[152:159], v1
    v_cvt_pk_bf16_f32 v68, v32, v33
    v_add_f32 v36, v36, v38
    v_smfmac_f32_16x16x64_bf16 v[44:47], v[72:75], v[160:167], v1
    v_add_f32 v37, v37, v39
    v_smfmac_f32_16x16x64_bf16 v[44:47], v[76:79], v[168:175], v1
    v_cvt_pk_bf16_f32 v69, v36, v37
    v_add_f32 v40, v40, v42
    v_smfmac_f32_16x16x64_bf16 v[48:51], v[72:75], v[176:183], v1
    v_add_f32 v41, v41, v43
    v_cvt_pk_bf16_f32 v70, v40, v41
    v_smfmac_f32_16x16x64_bf16 v[48:51], v[76:79], v[184:191], v1
    buffer_store_dwordx4 v[68:71], v30, s[4:7], s36 offen
    v_add_f32 v44, v44, v46
    v_smfmac_f32_16x16x64_bf16 v[52:55], v[72:75], v[192:199], v1
    v_add_f32 v45, v45, v47
    v_smfmac_f32_16x16x64_bf16 v[52:55], v[76:79], v[200:207], v1
    v_cvt_pk_bf16_f32 v68, v44, v45
    v_add_f32 v48, v48, v50
    v_smfmac_f32_16x16x64_bf16 v[56:59], v[72:75], v[208:215], v1
    v_add_f32 v49, v49, v51
    v_smfmac_f32_16x16x64_bf16 v[56:59], v[76:79], v[216:223], v1
    v_cvt_pk_bf16_f32 v69, v48, v49
    v_add_f32 v52, v52, v54
    v_smfmac_f32_16x16x64_bf16 v[60:63], v[72:75], v[224:231], v1
    v_add_f32 v53, v53, v55
    v_cvt_pk_bf16_f32 v70, v52, v53
    v_smfmac_f32_16x16x64_bf16 v[60:63], v[76:79], v[232:239], v1
    buffer_store_dwordx4 v[68:71], v30, s[4:7], s37 offen
    v_add_f32 v56, v56, v58
    v_smfmac_f32_16x16x64_bf16 v[64:67], v[72:75], v[240:247], v1
    v_add_f32 v57, v57, v59
    v_smfmac_f32_16x16x64_bf16 v[64:67], v[76:79], v[248:255], v1
    v_cvt_pk_bf16_f32 v68, v56, v57
    v_add_f32 v60, v60, v62
    v_add_f32 v61, v61, v63
    v_cvt_pk_bf16_f32 v69, v60, v61
    s_nop 3
    v_add_f32 v64, v64, v66
    v_add_f32 v65, v65, v67
    v_cvt_pk_bf16_f32 v70, v64, v65
    buffer_store_dwordx4 v[68:71], v30, s[4:7], s38 offen
    s_cmp_eq_u32 s45, 0
    s_cbranch_scc1 notask_24
    s_cmp_eq_u32 s42, 0
    s_cbranch_scc1 nodelay_25
    s_nop 15
    s_nop 15
    s_nop 15
    s_nop 15
nodelay_25:
    s_cmp_lg_u32 s19, 1
    s_cbranch_scc1 nodelay1_26
    s_nop 15
    s_nop 15
nodelay1_26:
    s_nop 15
    s_nop 15
    s_nop 15
p_retry_27:
    buffer_load_dwordx4 v[32:35], v0, s[4:7], s41 offen offset:0 sc1
    buffer_load_dwordx4 v[36:39], v0, s[4:7], s41 offen offset:1024 sc1
    buffer_load_dwordx4 v[40:43], v0, s[4:7], s41 offen offset:2048 sc1
    buffer_load_dwordx4 v[44:47], v0, s[4:7], s41 offen offset:3072 sc1
    s_add_u32 s71, s71, 1
    v_bfe_u32 v69, v0, 4, 2
    v_bfe_u32 v70, v0, 6, 2
    v_lshlrev_b32 v71, 4, v69
    v_mov_b32 v68, 0x3f80
    v_lshlrev_b32 v68, v71, v68
    v_cmp_gt_u32 vcc, 2, v69
    s_nop 1
    v_cndmask_b32 v71, 0, v68, vcc
    v_cmp_eq_u32 vcc, 0, v70
    s_nop 1
    v_cndmask_b32 v64, 0, v71, vcc
    v_cmp_eq_u32 vcc, 1, v70
    s_nop 1
    v_cndmask_b32 v65, 0, v71, vcc
    v_cmp_eq_u32 vcc, 2, v70
    s_nop 1
    v_cndmask_b32 v66, 0, v71, vcc
    v_mov_b32 v67, 0
    v_bfe_u32 v68, v0, 8, 2
    v_lshlrev_b32 v68, 10, v68
    v_bfe_u32 v69, v0, 4, 3
    v_lshl_add_u32 v68, v69, 1, v68
    s_waitcnt vmcnt(3)
    v_mfma_f32_16x16x32_bf16 v[72:75], v[64:67], v[32:35], 0
    s_waitcnt vmcnt(2)
    v_mfma_f32_16x16x32_bf16 v[72:75], v[64:67], v[36:39], v[72:75]
    s_waitcnt vmcnt(1)
    v_mfma_f32_16x16x32_bf16 v[72:75], v[64:67], v[40:43], v[72:75]
    v_min3_u32 v76, v35, v39, v43
    s_waitcnt vmcnt(0)
    v_mfma_f32_16x16x32_bf16 v[72:75], v[64:67], v[44:47], v[72:75]
    v_min_u32 v76, v76, v47
    v_cmp_ne_u32 vcc, s67, v76
    s_cbranch_vccz p_ok_28
    s_cmp_lt_u32 s71, 0x200000
    s_cbranch_scc1 p_retry_27
p_ok_28:
    s_nop 1
    s_nop 0
    v_add_f32_dpp v72, v72, v72 row_ror:8 row_mask:0xf bank_mask:0xf
    v_add_f32_dpp v73, v73, v73 row_ror:8 row_mask:0xf bank_mask:0xf
    s_nop 0
    v_mov_b32_dpp v76, v72 quad_perm:[1,0,3,2] row_mask:0xf bank_mask:0xf
    v_mov_b32_dpp v77, v73 quad_perm:[1,0,3,2] row_mask:0xf bank_mask:0xf
    v_cvt_pk_bf16_f32 v76, v72, v76
    v_cvt_pk_bf16_f32 v77, v73, v77
    v_mov_b32 v78, -1
    s_mov_b64 exec, s[58:59]
    buffer_store_dword v76, v68, s[4:7], s22 offen
    buffer_store_dword v77, v68, s[4:7], s22 offen offset:16
    buffer_store_dword v78, v68, s[4:7], s39 offen
    buffer_store_dword v78, v68, s[4:7], s39 offen offset:16
    s_mov_b64 exec, -1
notask_24:
    s_add_u32 s22, s22, 9216
    s_cmp_ge_u32 s22, s40
    s_cselect_b32 s28, 36864, 0
    s_sub_u32 s22, s22, s28
    s_add_u32 s39, s39, 9216
    s_cmp_ge_u32 s39, s40
    s_cselect_b32 s28, 36864, 0
    s_sub_u32 s39, s39, s28
    s_add_u32 s24, s24, 262144
    s_add_u32 s25, s25, 131072
    s_add_u32 s26, s26, 65536
    s_add_u32 s23, s23, 262144
    s_add_u32 s20, s20, 1
    s_cmp_lt_u32 s20, 63
    s_cbranch_scc1 chain_loop_15
    s_cmp_lg_u32 s19, 3
    s_cbranch_scc1 nochk_29
    s_add_u32 s29, s20, 2
    s_min_u32 s29, s29, 63
    s_cmp_lt_u32 s29, s10
    s_cbranch_scc1 rdy_ok_31
    s_add_u32 s29, s20, 1
    s_min_u32 s29, s29, 63
    s_mov_b32 s30, 0
    v_lshrrev_b32 v52, 2, v0
    s_mov_b32 s28, 65011712
rdy_30:
    buffer_load_dword v53, v52, s[4:7], s28 offen sc1
    s_waitcnt vmcnt(0)
    v_cmp_ne_u32 vcc, 32, v53
    s_nop 0
    s_ff1_i32_b64 s10, vcc
    s_cmp_eq_u32 s10, -1
    s_cselect_b32 s10, 64, s10
    s_cmp_lt_u32 s29, s10
    s_cbranch_scc1 rdy_ok_31
    s_sleep 8
    s_add_u32 s30, s30, 1
    s_cmp_lt_u32 s30, 0x80000
    s_cbranch_scc1 rdy_30
    s_mov_b32 s10, 64
rdy_ok_31:
nochk_29:
    ds_read_b128 v[64:67], v26 offset:0
    ds_read_b128 v[68:71], v26 offset:1024
    ds_read_b128 v[72:75], v26 offset:8192
    ds_read_b128 v[76:79], v26 offset:9216
    v_mov_b64 v[32:33], 0
    v_mov_b64 v[34:35], 0
    v_mov_b64 v[36:37], 0
    v_mov_b64 v[38:39], 0
    v_mov_b64 v[40:41], 0
    v_mov_b64 v[42:43], 0
    v_mov_b64 v[44:45], 0
    v_mov_b64 v[46:47], 0
    v_add_u32 v55, s57, v0
    s_cmp_eq_u32 s19, 2
    s_cbranch_scc1 acq_w2_35
    s_cmp_lg_u32 s19, 3
    s_cbranch_scc1 nd3_36
    s_nop 15
    s_nop 15
    s_nop 15
    s_nop 15
    s_nop 15
    s_nop 15
    s_nop 15
    s_nop 15
    s_nop 15
    s_nop 15
nd3_36:
    s_nop 15
mem_poll_32:
    buffer_load_dwordx4 v[56:59], v0, s[4:7], s21 offen sc1
    buffer_load_dwordx4 v[60:63], v0, s[4:7], s21 offen offset:1024 sc1
    s_add_u32 s27, s27, 1
    s_waitcnt vmcnt(1)
    ds_write_b128 v55, v[56:59] offset:0
    v_max3_u32 v52, v56, v57, v58
    s_waitcnt vmcnt(0)
    ds_write_b128 v55, v[60:63] offset:1024
    v_max3_u32 v52, v52, v59, v60
    v_max3_u32 v52, v52, v61, v62
    v_max_u32 v52, v52, v63
    v_cmp_eq_u32 vcc, -1, v52
    s_cbranch_vccz mem_done_33
    s_cmp_lt_u32 s27, 0x200000
    s_cbranch_scc1 mem_poll_32
    s_branch mem_done_33
acq_w2_35:
    s_nop 15
    s_nop 15
mem_poll2_34:
    buffer_load_dwordx4 v[56:59], v0, s[4:7], s21 offen sc1
    buffer_load_dwordx4 v[60:63], v0, s[4:7], s21 offen offset:1024 sc1
    buffer_load_dwordx4 v[48:51], v0, s[4:7], s21 offen offset:2048 sc1
    s_add_u32 s61, s61, 1
    s_waitcnt vmcnt(2)
    ds_write_b128 v55, v[56:59] offset:0
    v_max3_u32 v52, v56, v57, v58
    s_waitcnt vmcnt(1)
    ds_write_b128 v55, v[60:63] offset:1024
    v_max3_u32 v52, v52, v59, v60
    v_max3_u32 v52, v52, v61, v62
    s_waitcnt vmcnt(0)
    ds_write_b128 v55, v[48:51] offset:2048
    v_max3_u32 v52, v52, v63, v48
    v_max3_u32 v52, v52, v49, v50
    v_max_u32 v52, v52, v51
    v_cmp_eq_u32 vcc, -1, v52
    s_cbranch_vccz mem_done_33
    s_cmp_lt_u32 s61, 0x200000
    s_cbranch_scc1 mem_poll2_34
mem_done_33:
    s_waitcnt lgkmcnt(0)
    s_barrier
    ds_read_b128 v[56:59], v0 offset:0
    ds_read_b128 v[60:63], v0 offset:1024
    s_add_u32 s67, s20, 1
    s_max_u32 s13, s20, 1
    s_sub_u32 s13, s13, 1
    ds_read_b128 v[48:51], v0 offset:2048
    buffer_load_dwordx4 v[18:21], v0, s[4:7], s24 offen offset:0 sc1
    s_waitcnt lgkmcnt(2)
    v_smfmac_f32_16x16x64_bf16 v[40:43], v[56:59], a[144:151], v1
    s_add_u32 s21, s21, 9216
    s_cmp_ge_u32 s21, s60
    v_smfmac_f32_16x16x64_bf16 v[44:47], v[56:59], a[216:223], v1
    buffer_load_dwordx4 v[22:25], v0, s[4:7], s24 offen offset:1024 sc1
    ds_read_b128 v[56:59], v0 offset:3072
    s_cselect_b32 s28, 36864, 0
    s_sub_u32 s21, s21, s28
    s_waitcnt lgkmcnt(2)
    v_smfmac_f32_16x16x64_bf16 v[40:43], v[60:63], a[152:159], v1
    v_lshrrev_b32 v52, 1, v0
    v_smfmac_f32_16x16x64_bf16 v[44:47], v[60:63], v[64:71], v1
    buffer_store_dwordx2 v[28:29], v52, s[4:7], s26 offen sc1
    ds_read_b128 v[60:63], v0 offset:4096
    ds_read_b128 v[64:67], v26 offset:16384
    s_waitcnt lgkmcnt(3)
    v_smfmac_f32_16x16x64_bf16 v[40:43], v[48:51], a[160:167], v1
    ds_read_b128 v[68:71], v26 offset:17408
    v_smfmac_f32_16x16x64_bf16 v[44:47], v[48:51], v[72:79], v1
    v_mov_b32 v53, s13
    ds_read_b128 v[48:51], v0 offset:5120
    ds_read_b128 v[72:75], v26 offset:24576
    s_waitcnt lgkmcnt(5)
    v_smfmac_f32_16x16x64_bf16 v[40:43], v[56:59], a[168:175], v1
    ds_read_b128 v[76:79], v26 offset:25600
    s_waitcnt lgkmcnt(3)
    v_smfmac_f32_16x16x64_bf16 v[44:47], v[56:59], v[64:71], v1
    s_mov_b64 exec, s[8:9]
    buffer_store_dword v53, v3, s[4:7], s11 offen sc1
    s_mov_b64 exec, -1
    ds_read_b128 v[56:59], v0 offset:6144
    ds_read_b128 v[64:67], v26 offset:32768
    v_smfmac_f32_16x16x64_bf16 v[40:43], v[60:63], a[176:183], v1
    ds_read_b128 v[68:71], v26 offset:33792
    s_waitcnt lgkmcnt(3)
    v_smfmac_f32_16x16x64_bf16 v[44:47], v[60:63], v[72:79], v1
    s_sub_u32 s28, s24, s48
    s_add_u32 s28, s28, 262144
    v_lshlrev_b32 v27, 3, v0
    ds_read_b128 v[60:63], v0 offset:7168
    ds_read_b128 v[72:75], v26 offset:40960
    v_smfmac_f32_16x16x64_bf16 v[40:43], v[48:51], a[184:191], v1
    ds_read_b128 v[76:79], v26 offset:41984
    s_waitcnt lgkmcnt(3)
    v_smfmac_f32_16x16x64_bf16 v[44:47], v[48:51], v[64:71], v1
    s_sub_u32 s29, s23, s48
    s_add_u32 s29, s29, 262144
    s_add_u32 s30, s20, 2
    s_cmp_lt_u32 s30, s10
    s_cselect_b32 s29, s29, s28
    ds_read_b128 v[48:51], v0 offset:8192
    ds_read_b128 v[64:67], v26 offset:49152
    v_smfmac_f32_16x16x64_bf16 v[40:43], v[56:59], a[192:199], v1
    ds_read_b128 v[68:71], v26 offset:50176
    s_waitcnt lgkmcnt(3)
    v_smfmac_f32_16x16x64_bf16 v[44:47], v[56:59], v[72:79], v1
    s_mov_b64 exec, s[46:47]
    buffer_load_dword v27, v27, s[4:7], s28 offen
    buffer_load_dword v27, v27, s[4:7], s29 offen
    s_mov_b64 exec, -1
    ds_read_b128 v[72:75], v26 offset:57344
    ds_read_b128 v[76:79], v26 offset:58368
    v_smfmac_f32_16x16x64_bf16 v[40:43], v[60:63], a[200:207], v1
    s_waitcnt lgkmcnt(2)
    v_smfmac_f32_16x16x64_bf16 v[44:47], v[60:63], v[64:71], v1
    v_add_u32 v26, 0x10000, v26
    ds_read_b128 v[64:67], v26 offset:0
    ds_read_b128 v[68:71], v26 offset:1024
    v_smfmac_f32_16x16x64_bf16 v[40:43], v[48:51], a[208:215], v1
    s_waitcnt lgkmcnt(2)
    v_smfmac_f32_16x16x64_bf16 v[44:47], v[48:51], v[72:79], v1
    s_nop 4
    v_add_f32 v40, v40, v42
    v_add_f32 v41, v41, v43
    v_mov_b64 v[52:53], 0
    v_mov_b64 v[54:55], 0
    v_add_f32 v44, v44, v46
    v_add_f32 v45, v45, v47
    v_cvt_pk_bf16_f32 v42, v40, v41
    v_cvt_pk_bf16_f32 v43, v44, v45
    v_mov_b64 v[48:49], 0
    v_mov_b64 v[50:51], 0
    v_mfma_f32_16x16x16_bf16 v[44:47], v[42:43], v[6:7], 0
    v_mfma_f32_16x16x16_bf16 v[40:43], v[42:43], v[8:9], 0
    s_nop 4
    v_cvt_pk_bf16_f32 v44, v44, v45
    v_cvt_pk_bf16_f32 v45, v46, v47
    s_nop 0
    v_cvt_pk_bf16_f32 v46, v40, v41
    v_cvt_pk_bf16_f32 v47, v42, v43
    buffer_store_dwordx4 v[44:47], v0, s[4:7], s25 offen sc1
    v_smfmac_f32_16x16x64_bf16 v[48:51], v[56:59], a[224:231], v1
    ds_read_b128 v[72:75], v26 offset:8192
    v_smfmac_f32_16x16x64_bf16 v[52:55], v[56:59], a[232:239], v1
    ds_read_b128 v[76:79], v26 offset:9216
    ds_read_b128 v[56:59], v0 offset:0
    v_smfmac_f32_16x16x64_bf16 v[48:51], v[60:63], a[240:247], v1
    v_smfmac_f32_16x16x64_bf16 v[52:55], v[60:63], a[248:255], v1
    ds_read_b128 v[60:63], v0 offset:1024
    s_waitcnt lgkmcnt(1)
    v_smfmac_f32_16x16x64_bf16 v[48:51], v[56:59], v[80:87], v1
    v_smfmac_f32_16x16x64_bf16 v[52:55], v[56:59], v[88:95], v1
    ds_read_b128 v[56:59], v0 offset:2048
    s_waitcnt lgkmcnt(1)
    v_smfmac_f32_16x16x64_bf16 v[48:51], v[60:63], v[96:103], v1
    v_smfmac_f32_16x16x64_bf16 v[52:55], v[60:63], v[104:111], v1
    ds_read_b128 v[60:63], v0 offset:3072
    s_waitcnt lgkmcnt(1)
    v_smfmac_f32_16x16x64_bf16 v[48:51], v[56:59], v[64:71], v1
    ds_read_b128 v[64:67], v26 offset:16384
    ds_read_b128 v[68:71], v26 offset:17408
    v_smfmac_f32_16x16x64_bf16 v[52:55], v[56:59], v[72:79], v1
    ds_read_b128 v[72:75], v26 offset:24576
    ds_read_b128 v[76:79], v26 offset:25600
    ds_read_b128 v[56:59], v0 offset:4096
    s_waitcnt lgkmcnt(3)
    v_smfmac_f32_16x16x64_bf16 v[48:51], v[60:63], v[64:71], v1
    ds_read_b128 v[64:67], v26 offset:32768
    ds_read_b128 v[68:71], v26 offset:33792
    s_waitcnt lgkmcnt(3)
    v_smfmac_f32_16x16x64_bf16 v[52:55], v[60:63], v[72:79], v1
    ds_read_b128 v[72:75], v26 offset:40960
    ds_read_b128 v[76:79], v26 offset:41984
    ds_read_b128 v[60:63], v0 offset:5120
    s_waitcnt lgkmcnt(3)
    v_smfmac_f32_16x16x64_bf16 v[48:51], v[56:59], v[64:71], v1
    ds_read_b128 v[64:67], v26 offset:49152
    ds_read_b128 v[68:71], v26 offset:50176
    s_waitcnt lgkmcnt(3)
    v_smfmac_f32_16x16x64_bf16 v[52:55], v[56:59], v[72:79], v1
    ds_read_b128 v[72:75], v26 offset:57344
    ds_read_b128 v[76:79], v26 offset:58368
    ds_read_b128 v[56:59], v0 offset:8192
    s_waitcnt lgkmcnt(3)
    v_smfmac_f32_16x16x64_bf16 v[48:51], v[60:63], v[64:71], v1
    v_add_u32 v26, 0x10000, v26
    ds_read_b128 v[64:67], v26 offset:0
    ds_read_b128 v[68:71], v26 offset:1024
    s_waitcnt lgkmcnt(3)
    v_smfmac_f32_16x16x64_bf16 v[52:55], v[60:63], v[72:79], v1
    ds_read_b128 v[72:75], v26 offset:8192
    ds_read_b128 v[76:79], v26 offset:9216
    s_waitcnt lgkmcnt(2)
    v_smfmac_f32_16x16x64_bf16 v[48:51], v[56:59], v[64:71], v1
    s_waitcnt lgkmcnt(0)
    v_smfmac_f32_16x16x64_bf16 v[52:55], v[56:59], v[72:79], v1
    v_subrev_u32 v26, 0x20000, v26
    s_nop 2
    v_add_f32 v48, v48, v50
    v_add_f32 v49, v49, v51
    s_nop 1
    v_add_f32 v52, v52, v54
    v_add_f32 v53, v53, v55
    v_cvt_pk_bf16_f32 v50, v48, v49
    v_cvt_pk_bf16_f32 v51, v52, v53
    s_add_u32 s26, s26, 65536
    v_lshrrev_b32 v60, 1, v0
    buffer_store_dwordx2 v[50:51], v60, s[4:7], s26 offen sc1
    s_nop 3
    s_waitcnt vmcnt(0)
    s_barrier
    v_mov_b32 v52, 64
    v_mov_b32 v53, 0
    s_mov_b64 exec, s[8:9]
    buffer_store_dword v52, v53, s[4:7], s11 offen sc1
    s_mov_b64 exec, -1
    s_branch over_slow_37
over_slow_37:
    s_branch L_end
L_chain_global:
chain_loop_38:
    s_cmp_lg_u32 s19, 3
    s_cbranch_scc1 nochk_39
    s_add_u32 s29, s20, 2
    s_min_u32 s29, s29, 63
    s_cmp_lt_u32 s29, s10
    s_cbranch_scc1 rdy_ok_41
    s_add_u32 s29, s20, 1
    s_min_u32 s29, s29, 63
    s_mov_b32 s30, 0
    v_lshrrev_b32 v52, 2, v0
    s_mov_b32 s28, 65011712
rdy_40:
    buffer_load_dword v53, v52, s[4:7], s28 offen sc1
    s_waitcnt vmcnt(0)
    v_cmp_ne_u32 vcc, 32, v53
    s_nop 0
    s_ff1_i32_b64 s10, vcc
    s_cmp_eq_u32 s10, -1
    s_cselect_b32 s10, 64, s10
    s_cmp_lt_u32 s29, s10
    s_cbranch_scc1 rdy_ok_41
    s_sleep 8
    s_add_u32 s30, s30, 1
    s_cmp_lt_u32 s30, 0x80000
    s_cbranch_scc1 rdy_40
    s_mov_b32 s10, 64
rdy_ok_41:
nochk_39:
    ds_read_b128 v[64:67], v26 offset:0
    ds_read_b128 v[68:71], v26 offset:1024
    ds_read_b128 v[72:75], v26 offset:8192
    ds_read_b128 v[76:79], v26 offset:9216
    v_mov_b64 v[32:33], 0
    v_mov_b64 v[34:35], 0
    v_mov_b64 v[36:37], 0
    v_mov_b64 v[38:39], 0
    v_mov_b64 v[40:41], 0
    v_mov_b64 v[42:43], 0
    v_mov_b64 v[44:45], 0
    v_mov_b64 v[46:47], 0
    v_add_u32 v55, s57, v0
    s_cmp_eq_u32 s19, 2
    s_cbranch_scc1 acq_w2_45
    s_cmp_lg_u32 s19, 3
    s_cbranch_scc1 nd3_46
    s_nop 15
    s_nop 15
    s_nop 15
    s_nop 15
    s_nop 15
    s_nop 15
    s_nop 15
    s_nop 15
    s_nop 15
    s_nop 15
nd3_46:
    s_nop 15
mem_poll_42:
    buffer_load_dwordx4 v[56:59], v0, s[4:7], s21 offen sc1
    buffer_load_dwordx4 v[60:63], v0, s[4:7], s21 offen offset:1024 sc1
    s_add_u32 s27, s27, 1
    s_waitcnt vmcnt(1)
    ds_write_b128 v55, v[56:59] offset:0
    v_max3_u32 v52, v56, v57, v58
    s_waitcnt vmcnt(0)
    ds_write_b128 v55, v[60:63] offset:1024
    v_max3_u32 v52, v52, v59, v60
    v_max3_u32 v52, v52, v61, v62
    v_max_u32 v52, v52, v63
    v_cmp_eq_u32 vcc, -1, v52
    s_cbranch_vccz mem_done_43
    s_cmp_lt_u32 s27, 0x200000
    s_cbranch_scc1 mem_poll_42
    s_branch mem_done_43
acq_w2_45:
    s_nop 15
    s_nop 15
mem_poll2_44:
    buffer_load_dwordx4 v[56:59], v0, s[4:7], s21 offen sc1
    buffer_load_dwordx4 v[60:63], v0, s[4:7], s21 offen offset:1024 sc1
    buffer_load_dwordx4 v[48:51], v0, s[4:7], s21 offen offset:2048 sc1
    s_add_u32 s61, s61, 1
    s_waitcnt vmcnt(2)
    ds_write_b128 v55, v[56:59] offset:0
    v_max3_u32 v52, v56, v57, v58
    s_waitcnt vmcnt(1)
    ds_write_b128 v55, v[60:63] offset:1024
    v_max3_u32 v52, v52, v59, v60
    v_max3_u32 v52, v52, v61, v62
    s_waitcnt vmcnt(0)
    ds_write_b128 v55, v[48:51] offset:2048
    v_max3_u32 v52, v52, v63, v48
    v_max3_u32 v52, v52, v49, v50
    v_max_u32 v52, v52, v51
    v_cmp_eq_u32 vcc, -1, v52
    s_cbranch_vccz mem_done_43
    s_cmp_lt_u32 s61, 0x200000
    s_cbranch_scc1 mem_poll2_44
mem_done_43:
    s_waitcnt lgkmcnt(0)
    s_barrier
    ds_read_b128 v[56:59], v0 offset:0
    ds_read_b128 v[60:63], v0 offset:1024
    s_add_u32 s67, s20, 1
    s_max_u32 s13, s20, 1
    s_sub_u32 s13, s13, 1
    s_waitcnt lgkmcnt(1)
    v_smfmac_f32_16x16x64_bf16 v[32:35], v[56:59], a[0:7], v1
    ds_read_b128 v[48:51], v0 offset:2048
    v_smfmac_f32_16x16x64_bf16 v[36:39], v[56:59], a[72:79], v1
    buffer_load_dwordx4 v[18:21], v0, s[4:7], s24 offen offset:0 sc1
    v_smfmac_f32_16x16x64_bf16 v[40:43], v[56:59], a[144:151], v1
    s_add_u32 s21, s21, 9216
    s_cmp_ge_u32 s21, s60
    v_smfmac_f32_16x16x64_bf16 v[44:47], v[56:59], a[216:223], v1
    buffer_load_dwordx4 v[22:25], v0, s[4:7], s24 offen offset:1024 sc1
    s_waitcnt lgkmcnt(1)
    v_smfmac_f32_16x16x64_bf16 v[32:35], v[60:63], a[8:15], v1
    ds_read_b128 v[56:59], v0 offset:3072
    v_smfmac_f32_16x16x64_bf16 v[36:39], v[60:63], a[80:87], v1
    s_cselect_b32 s28, 36864, 0
    s_sub_u32 s21, s21, s28
    v_smfmac_f32_16x16x64_bf16 v[40:43], v[60:63], a[152:159], v1
    v_lshrrev_b32 v52, 1, v0
    v_smfmac_f32_16x16x64_bf16 v[44:47], v[60:63], v[64:71], v1
    buffer_store_dwordx2 v[28:29], v52, s[4:7], s26 offen sc1
    s_waitcnt lgkmcnt(1)
    v_smfmac_f32_16x16x64_bf16 v[32:35], v[48:51], a[16:23], v1
    ds_read_b128 v[60:63], v0 offset:4096
    v_smfmac_f32_16x16x64_bf16 v[36:39], v[48:51], a[88:95], v1
    ds_read_b128 v[64:67], v26 offset:16384
    v_smfmac_f32_16x16x64_bf16 v[40:43], v[48:51], a[160:167], v1
    ds_read_b128 v[68:71], v26 offset:17408
    v_smfmac_f32_16x16x64_bf16 v[44:47], v[48:51], v[72:79], v1
    v_mov_b32 v53, s13
    s_waitcnt lgkmcnt(3)
    v_smfmac_f32_16x16x64_bf16 v[32:35], v[56:59], a[24:31], v1
    ds_read_b128 v[48:51], v0 offset:5120
    v_smfmac_f32_16x16x64_bf16 v[36:39], v[56:59], a[96:103], v1
    ds_read_b128 v[72:75], v26 offset:24576
    v_smfmac_f32_16x16x64_bf16 v[40:43], v[56:59], a[168:175], v1
    ds_read_b128 v[76:79], v26 offset:25600
    s_waitcnt lgkmcnt(3)
    v_smfmac_f32_16x16x64_bf16 v[44:47], v[56:59], v[64:71], v1
    s_mov_b64 exec, s[8:9]
    buffer_store_dword v53, v3, s[4:7], s11 offen sc1
    s_mov_b64 exec, -1
    v_smfmac_f32_16x16x64_bf16 v[32:35], v[60:63], a[32:39], v1
    ds_read_b128 v[56:59], v0 offset:6144
    v_smfmac_f32_16x16x64_bf16 v[36:39], v[60:63], a[104:111], v1
    ds_read_b128 v[64:67], v26 offset:32768
    v_smfmac_f32_16x16x64_bf16 v[40:43], v[60:63], a[176:183], v1
    ds_read_b128 v[68:71], v26 offset:33792
    s_waitcnt lgkmcnt(3)
    v_smfmac_f32_16x16x64_bf16 v[44:47], v[60:63], v[72:79], v1
    s_sub_u32 s28, s24, s48
    s_add_u32 s28, s28, 262144
    v_lshlrev_b32 v27, 3, v0
    v_smfmac_f32_16x16x64_bf16 v[32:35], v[48:51], a[40:47], v1
    ds_read_b128 v[60:63], v0 offset:7168
    v_smfmac_f32_16x16x64_bf16 v[36:39], v[48:51], a[112:119], v1
    ds_read_b128 v[72:75], v26 offset:40960
    v_smfmac_f32_16x16x64_bf16 v[40:43], v[48:51], a[184:191], v1
    ds_read_b128 v[76:79], v26 offset:41984
    s_waitcnt lgkmcnt(3)
    v_smfmac_f32_16x16x64_bf16 v[44:47], v[48:51], v[64:71], v1
    s_sub_u32 s29, s23, s48
    s_add_u32 s29, s29, 262144
    s_add_u32 s30, s20, 2
    s_cmp_lt_u32 s30, s10
    s_cselect_b32 s29, s29, s28
    v_smfmac_f32_16x16x64_bf16 v[32:35], v[56:59], a[48:55], v1
    ds_read_b128 v[48:51], v0 offset:8192
    v_smfmac_f32_16x16x64_bf16 v[36:39], v[56:59], a[120:127], v1
    ds_read_b128 v[64:67], v26 offset:49152
    v_smfmac_f32_16x16x64_bf16 v[40:43], v[56:59], a[192:199], v1
    ds_read_b128 v[68:71], v26 offset:50176
    s_waitcnt lgkmcnt(3)
    v_smfmac_f32_16x16x64_bf16 v[44:47], v[56:59], v[72:79], v1
    s_mov_b64 exec, s[46:47]
    buffer_load_dword v27, v27, s[4:7], s28 offen
    buffer_load_dword v27, v27, s[4:7], s29 offen
    s_mov_b64 exec, -1
    v_smfmac_f32_16x16x64_bf16 v[32:35], v[60:63], a[56:63], v1
    ds_read_b128 v[72:75], v26 offset:57344
    v_smfmac_f32_16x16x64_bf16 v[36:39], v[60:63], a[128:135], v1
    ds_read_b128 v[76:79], v26 offset:58368
    v_smfmac_f32_16x16x64_bf16 v[40:43], v[60:63], a[200:207], v1
    s_waitcnt lgkmcnt(2)
    v_smfmac_f32_16x16x64_bf16 v[44:47], v[60:63], v[64:71], v1
    v_smfmac_f32_16x16x64_bf16 v[32:35], v[48:51], a[64:71], v1
    v_add_u32 v26, 0x10000, v26
    ds_read_b128 v[64:67], v26 offset:0
    v_smfmac_f32_16x16x64_bf16 v[36:39], v[48:51], a[136:143], v1
    ds_read_b128 v[68:71], v26 offset:1024
    v_smfmac_f32_16x16x64_bf16 v[40:43], v[48:51], a[208:215], v1
    s_waitcnt lgkmcnt(2)
    v_smfmac_f32_16x16x64_bf16 v[44:47], v[48:51], v[72:79], v1
    v_add_f32 v32, v32, v34
    v_add_f32 v33, v33, v35
    v_add_f32 v36, v36, v38
    v_add_f32 v37, v37, v39
    v_cvt_pk_bf16_f32 v34, v32, v33
    v_cvt_pk_bf16_f32 v35, v36, v37
    v_add_f32 v40, v40, v42
    v_add_f32 v41, v41, v43
    v_mov_b64 v[52:53], 0
    v_mov_b64 v[54:55], 0
    v_add_f32 v44, v44, v46
    v_add_f32 v45, v45, v47
    v_cvt_pk_bf16_f32 v42, v40, v41
    v_cvt_pk_bf16_f32 v43, v44, v45
    v_mfma_f32_16x16x16_bf16 v[36:39], v[34:35], v[2:3], 0
    v_mov_b64 v[48:49], 0
    v_mov_b64 v[50:51], 0
    v_mfma_f32_16x16x16_bf16 v[32:35], v[34:35], v[4:5], 0
    v_mfma_f32_16x16x16_bf16 v[44:47], v[42:43], v[6:7], 0
    v_mfma_f32_16x16x16_bf16 v[40:43], v[42:43], v[8:9], 0
    v_cvt_pk_bf16_f32 v36, v36, v37
    v_cvt_pk_bf16_f32 v37, v38, v39
    v_cvt_pk_bf16_f32 v38, v32, v33
    v_cvt_pk_bf16_f32 v39, v34, v35
    s_nop 1
    v_mfma_f32_16x16x32_bf16 v[32:35], v[10:13], v[36:39], 0
    v_cvt_pk_bf16_f32 v44, v44, v45
    v_cvt_pk_bf16_f32 v45, v46, v47
    v_cvt_pk_bf16_f32 v46, v40, v41
    v_cvt_pk_bf16_f32 v47, v42, v43
    v_mfma_f32_16x16x32_bf16 v[40:43], v[14:17], v[36:39], 0
    s_nop 0
    v_mfma_f32_16x16x32_bf16 v[36:39], v[44:47], v[36:39], 0
    v_and_b32 v16, 0x70, v0
    v_lshrrev_b32 v17, 1, v0
    v_and_b32 v17, 0x180, v17
    v_or_b32 v16, v16, v17
    v_lshrrev_b32 v17, 1, v16
    v_and_b32 v10, 0x80, v0
    v_lshl_add_u32 v16, v10, 2, v16
    v_smfmac_f32_16x16x64_bf16 v[48:51], v[56:59], a[224:231], v1
    ds_read_b128 v[72:75], v26 offset:8192
    v_smfmac_f32_16x16x64_bf16 v[52:55], v[56:59], a[232:239], v1
    ds_read_b128 v[76:79], v26 offset:9216
    ds_read_b128 v[56:59], v0 offset:0
    v_add_u32 v16, 10240, v16
    v_add_u32 v17, 9216, v17
    v_add_u32 v10, s43, v16
    v_add_u32 v11, s44, v17
    v_cndmask_b32_e64 v32, v40, v32, s[32:33]
    v_cndmask_b32_e64 v33, v41, v33, s[32:33]
    v_cndmask_b32_e64 v34, v42, v34, s[32:33]
    v_cndmask_b32_e64 v35, v43, v35, s[32:33]
    ds_write_b128 v10, v[32:35]
    ds_write_b64 v11, v[36:37]
    v_smfmac_f32_16x16x64_bf16 v[48:51], v[60:63], a[240:247], v1
    v_smfmac_f32_16x16x64_bf16 v[52:55], v[60:63], a[248:255], v1
    ds_read_b128 v[60:63], v0 offset:1024
    s_waitcnt lgkmcnt(3)
    v_smfmac_f32_16x16x64_bf16 v[48:51], v[56:59], v[80:87], v1
    v_smfmac_f32_16x16x64_bf16 v[52:55], v[56:59], v[88:95], v1
    ds_read_b128 v[56:59], v0 offset:2048
    buffer_store_dwordx4 v[44:47], v0, s[4:7], s25 offen sc1
    s_waitcnt lgkmcnt(2)
    s_barrier
    ds_read_b128 v[32:35], v16 offset:0
    ds_read_b128 v[36:39], v16 offset:1024
    ds_read_b128 v[40:43], v16 offset:2048
    ds_read_b128 v[44:47], v16 offset:3072
    ds_read2_b64 v[10:13], v17 offset0:0 offset1:32
    ds_read2_b64 v[14:17], v17 offset0:64 offset1:96
    s_waitcnt lgkmcnt(7)
    v_smfmac_f32_16x16x64_bf16 v[48:51], v[60:63], v[96:103], v1
    v_smfmac_f32_16x16x64_bf16 v[52:55], v[60:63], v[104:111], v1
    ds_read_b128 v[60:63], v0 offset:3072
    s_waitcnt lgkmcnt(7)
    v_smfmac_f32_16x16x64_bf16 v[48:51], v[56:59], v[64:71], v1
    ds_read_b128 v[64:67], v26 offset:16384
    ds_read_b128 v[68:71], v26 offset:17408
    s_waitcnt lgkmcnt(7)
    v_pk_add_f32 v[32:33], v[32:33], v[36:37]
    v_pk_add_f32 v[34:35], v[34:35], v[38:39]
    s_waitcnt lgkmcnt(5)
    v_pk_add_f32 v[40:41], v[40:41], v[44:45]
    v_pk_add_f32 v[42:43], v[42:43], v[46:47]
    v_pk_add_f32 v[32:33], v[32:33], v[40:41]
    v_pk_add_f32 v[34:35], v[34:35], v[42:43]
    v_max3_f32 v38, v32, v33, v34
    s_waitcnt lgkmcnt(4)
    v_pk_add_f32 v[10:11], v[10:11], v[12:13]
    s_waitcnt lgkmcnt(3)
    v_pk_add_f32 v[14:15], v[14:15], v[16:17]
    v_pk_add_f32 v[36:37], v[10:11], v[14:15]
    v_smfmac_f32_16x16x64_bf16 v[52:55], v[56:59], v[72:79], v1
    ds_read_b128 v[72:75], v26 offset:24576
    ds_read_b128 v[76:79], v26 offset:25600
    ds_read_b128 v[56:59], v0 offset:4096
    s_waitcnt lgkmcnt(3)
    v_smfmac_f32_16x16x64_bf16 v[48:51], v[60:63], v[64:71], v1
    ds_read_b128 v[64:67], v26 offset:32768
    ds_read_b128 v[68:71], v26 offset:33792
    buffer_load_dwordx4 v[10:13], v0, s[4:7], s23 offen offset:0 sc1
    buffer_load_dwordx4 v[14:17], v0, s[4:7], s23 offen offset:1024 sc1
    v_max3_f32 v38, v38, v35, v36
    v_max_f32 v38, v38, v37
    s_waitcnt lgkmcnt(3)
    v_smfmac_f32_16x16x64_bf16 v[52:55], v[60:63], v[72:79], v1
    ds_read_b128 v[72:75], v26 offset:40960
    ds_read_b128 v[76:79], v26 offset:41984
    ds_read_b128 v[60:63], v0 offset:5120
    s_waitcnt lgkmcnt(3)
    v_smfmac_f32_16x16x64_bf16 v[48:51], v[56:59], v[64:71], v1
    ds_read_b128 v[64:67], v26 offset:49152
    ds_read_b128 v[68:71], v26 offset:50176
    v_max_f32_dpp v38, v38, v38 row_ror:8 row_mask:0xf bank_mask:0xf
    v_mov_b32 v39, v38
    v_mov_b32 v45, 0
    v_mov_b32 v46, 0
    v_permlane16_swap_b32 v38, v39
    v_max_f32 v38, v38, v39
    v_mov_b32 v39, v38
    s_waitcnt lgkmcnt(3)
    v_smfmac_f32_16x16x64_bf16 v[52:55], v[56:59], v[72:79], v1
    ds_read_b128 v[72:75], v26 offset:57344
    ds_read_b128 v[76:79], v26 offset:58368
    ds_read_b128 v[56:59], v0 offset:8192
    s_waitcnt lgkmcnt(3)
    v_smfmac_f32_16x16x64_bf16 v[48:51], v[60:63], v[64:71], v1
    v_add_u32 v26, 0x10000, v26
    ds_read_b128 v[64:67], v26 offset:0
    ds_read_b128 v[68:71], v26 offset:1024
    v_permlane32_swap_b32 v38, v39
    v_max_f32 v38, v38, v39
    v_mul_f32 v38, s31, v38
    v_fma_f32 v32, v32, s31, -v38
    v_fma_f32 v33, v33, s31, -v38
    v_fma_f32 v34, v34, s31, -v38
    v_fma_f32 v35, v35, s31, -v38
    v_fma_f32 v36, v36, s31, -v38
    v_fma_f32 v37, v37, s31, -v38
    s_waitcnt lgkmcnt(3)
    v_smfmac_f32_16x16x64_bf16 v[52:55], v[60:63], v[72:79], v1
    ds_read_b128 v[72:75], v26 offset:8192
    ds_read_b128 v[76:79], v26 offset:9216
    s_waitcnt lgkmcnt(2)
    v_smfmac_f32_16x16x64_bf16 v[48:51], v[56:59], v[64:71], v1
    s_waitcnt lgkmcnt(0)
    v_smfmac_f32_16x16x64_bf16 v[52:55], v[56:59], v[72:79], v1
    v_exp_f32 v32, v32
    v_exp_f32 v33, v33
    v_exp_f32 v34, v34
    v_exp_f32 v35, v35
    v_exp_f32 v36, v36
    v_exp_f32 v37, v37
    v_cvt_pk_bf16_f32 v40, v32, v33
    v_cvt_pk_bf16_f32 v41, v34, v35
    v_cvt_pk_bf16_f32 v44, v36, v37
    v_mov_b64 v[36:37], s[68:69]
    v_mov_b64 v[38:39], s[68:69]
    v_mov_b32_dpp v42, v40 row_ror:8 row_mask:0xf bank_mask:0xf
    v_mov_b32_dpp v43, v41 row_ror:8 row_mask:0xf bank_mask:0xf
    v_mov_b32 v47, v44
    s_waitcnt vmcnt(8)
    v_mfma_f32_16x16x32_bf16 v[32:35], v[18:21], v[40:43], 0
    v_subrev_u32 v26, 0x20000, v26
    v_add_f32 v48, v48, v50
    v_add_f32 v49, v49, v51
    v_add_f32 v52, v52, v54
    v_add_f32 v53, v53, v55
    v_cvt_pk_bf16_f32 v50, v48, v49
    v_cvt_pk_bf16_f32 v51, v52, v53
    v_mfma_f32_16x16x32_bf16 v[56:59], v[36:39], v[40:43], 0
    v_mov_b64 v[28:29], v[50:51]
    v_bfe_u32 v61, v0, 4, 3
    s_waitcnt vmcnt(7)
    v_mfma_f32_16x16x32_bf16 v[52:55], v[22:25], v[40:43], 0
    v_bfe_u32 v62, v0, 9, 1
    v_add_u32 v62, s70, v62
    v_mfma_f32_16x16x16_bf16 v[32:35], v[50:51], v[44:45], v[32:35]
    v_xor_b32 v62, v62, v61
    v_lshlrev_b32 v62, 4, v62
    v_mfma_f32_16x16x16_bf16 v[56:59], v[36:37], v[44:45], v[56:59]
    v_lshl_add_u32 v62, v61, 8, v62
    v_bfe_u32 v61, v0, 8, 1
    v_mfma_f32_16x16x16_bf16 v[52:55], v[50:51], v[46:47], v[52:55]
    v_lshl_add_u32 v62, v61, 3, v62
    v_add_u32 v62, 14336, v62
    v_xor_b32 v63, 32, v62
    s_nop 0
    v_rcp_f32 v56, v56
    s_nop 0
    v_mul_f32 v32, v32, v56
    v_mul_f32 v33, v33, v56
    v_mul_f32 v34, v34, v56
    v_mul_f32 v35, v35, v56
    v_mul_f32 v52, v52, v56
    v_mul_f32 v53, v53, v56
    v_mul_f32 v54, v54, v56
    v_mul_f32 v55, v55, v56
    v_cvt_pk_bf16_f32 v32, v32, v33
    v_cvt_pk_bf16_f32 v33, v34, v35
    v_cvt_pk_bf16_f32 v52, v52, v53
    v_cvt_pk_bf16_f32 v53, v54, v55
    s_mov_b64 exec, s[32:33]
    ds_write_b64 v62, v[32:33]
    ds_write_b64 v63, v[52:53]
    s_mov_b64 exec, -1
    v_mov_b32 v71, s67
    v_mov_b64 v[34:35], 0
    v_mov_b64 v[36:37], 0
    v_mov_b64 v[38:39], 0
    v_mov_b64 v[40:41], 0
    v_mov_b64 v[42:43], 0
    v_mov_b64 v[44:45], 0
    v_mov_b64 v[46:47], 0
    v_mov_b64 v[48:49], 0
    v_mov_b64 v[50:51], 0
    v_mov_b64 v[54:55], 0
    v_mov_b64 v[56:57], 0
    v_mov_b64 v[58:59], 0
    v_mov_b64 v[60:61], 0
    v_mov_b64 v[64:65], 0
    v_mov_b64 v[66:67], 0
    s_waitcnt lgkmcnt(0)
    s_barrier
    ds_read_b128 v[72:75], v31
    ds_read_b128 v[76:79], v31 offset:128
    v_mov_b64 v[32:33], 0
    v_mov_b64 v[52:53], 0
    v_mov_b64 v[62:63], 0
    s_waitcnt lgkmcnt(1)
    v_smfmac_f32_16x16x64_bf16 v[32:35], v[72:75], v[112:119], v1
    v_smfmac_f32_16x16x64_bf16 v[36:39], v[72:75], v[128:135], v1
    s_waitcnt lgkmcnt(0)
    v_smfmac_f32_16x16x64_bf16 v[32:35], v[76:79], v[120:127], v1
    v_smfmac_f32_16x16x64_bf16 v[36:39], v[76:79], v[136:143], v1
    v_smfmac_f32_16x16x64_bf16 v[40:43], v[72:75], v[144:151], v1
    v_add_f32 v32, v32, v34
    v_add_f32 v33, v33, v35
    v_smfmac_f32_16x16x64_bf16 v[40:43], v[76:79], v[152:159], v1
    v_cvt_pk_bf16_f32 v68, v32, v33
    v_add_f32 v36, v36, v38
    v_smfmac_f32_16x16x64_bf16 v[44:47], v[72:75], v[160:167], v1
    v_add_f32 v37, v37, v39
    v_smfmac_f32_16x16x64_bf16 v[44:47], v[76:79], v[168:175], v1
    v_cvt_pk_bf16_f32 v69, v36, v37
    v_add_f32 v40, v40, v42
    v_smfmac_f32_16x16x64_bf16 v[48:51], v[72:75], v[176:183], v1
    v_add_f32 v41, v41, v43
    v_cvt_pk_bf16_f32 v70, v40, v41
    v_smfmac_f32_16x16x64_bf16 v[48:51], v[76:79], v[184:191], v1
    buffer_store_dwordx4 v[68:71], v30, s[4:7], s36 offen sc1
    v_add_f32 v44, v44, v46
    v_smfmac_f32_16x16x64_bf16 v[52:55], v[72:75], v[192:199], v1
    v_add_f32 v45, v45, v47
    v_smfmac_f32_16x16x64_bf16 v[52:55], v[76:79], v[200:207], v1
    v_cvt_pk_bf16_f32 v68, v44, v45
    v_add_f32 v48, v48, v50
    v_smfmac_f32_16x16x64_bf16 v[56:59], v[72:75], v[208:215], v1
    v_add_f32 v49, v49, v51
    v_smfmac_f32_16x16x64_bf16 v[56:59], v[76:79], v[216:223], v1
    v_cvt_pk_bf16_f32 v69, v48, v49
    v_add_f32 v52, v52, v54
    v_smfmac_f32_16x16x64_bf16 v[60:63], v[72:75], v[224:231], v1
    v_add_f32 v53, v53, v55
    v_cvt_pk_bf16_f32 v70, v52, v53
    v_smfmac_f32_16x16x64_bf16 v[60:63], v[76:79], v[232:239], v1
    buffer_store_dwordx4 v[68:71], v30, s[4:7], s37 offen sc1
    v_add_f32 v56, v56, v58
    v_smfmac_f32_16x16x64_bf16 v[64:67], v[72:75], v[240:247], v1
    v_add_f32 v57, v57, v59
    v_smfmac_f32_16x16x64_bf16 v[64:67], v[76:79], v[248:255], v1
    v_cvt_pk_bf16_f32 v68, v56, v57
    v_add_f32 v60, v60, v62
    v_add_f32 v61, v61, v63
    v_cvt_pk_bf16_f32 v69, v60, v61
    s_nop 3
    v_add_f32 v64, v64, v66
    v_add_f32 v65, v65, v67
    v_cvt_pk_bf16_f32 v70, v64, v65
    buffer_store_dwordx4 v[68:71], v30, s[4:7], s38 offen sc1
    s_cmp_eq_u32 s45, 0
    s_cbranch_scc1 notask_47
    s_cmp_eq_u32 s42, 0
    s_cbranch_scc1 nodelay_48
    s_nop 15
    s_nop 15
    s_nop 15
    s_nop 15
nodelay_48:
    s_cmp_lg_u32 s19, 1
    s_cbranch_scc1 nodelay1_49
    s_nop 15
    s_nop 15
nodelay1_49:
    s_nop 15
    s_nop 15
    s_nop 15
p_retry_50:
    buffer_load_dwordx4 v[32:35], v0, s[4:7], s41 offen offset:0 sc1
    buffer_load_dwordx4 v[36:39], v0, s[4:7], s41 offen offset:1024 sc1
    buffer_load_dwordx4 v[40:43], v0, s[4:7], s41 offen offset:2048 sc1
    buffer_load_dwordx4 v[44:47], v0, s[4:7], s41 offen offset:3072 sc1
    s_add_u32 s71, s71, 1
    v_bfe_u32 v69, v0, 4, 2
    v_bfe_u32 v70, v0, 6, 2
    v_lshlrev_b32 v71, 4, v69
    v_mov_b32 v68, 0x3f80
    v_lshlrev_b32 v68, v71, v68
    v_cmp_gt_u32 vcc, 2, v69
    s_nop 1
    v_cndmask_b32 v71, 0, v68, vcc
    v_cmp_eq_u32 vcc, 0, v70
    s_nop 1
    v_cndmask_b32 v64, 0, v71, vcc
    v_cmp_eq_u32 vcc, 1, v70
    s_nop 1
    v_cndmask_b32 v65, 0, v71, vcc
    v_cmp_eq_u32 vcc, 2, v70
    s_nop 1
    v_cndmask_b32 v66, 0, v71, vcc
    v_mov_b32 v67, 0
    v_bfe_u32 v68, v0, 8, 2
    v_lshlrev_b32 v68, 10, v68
    v_bfe_u32 v69, v0, 4, 3
    v_lshl_add_u32 v68, v69, 1, v68
    s_waitcnt vmcnt(3)
    v_mfma_f32_16x16x32_bf16 v[72:75], v[64:67], v[32:35], 0
    s_waitcnt vmcnt(2)
    v_mfma_f32_16x16x32_bf16 v[72:75], v[64:67], v[36:39], v[72:75]
    s_waitcnt vmcnt(1)
    v_mfma_f32_16x16x32_bf16 v[72:75], v[64:67], v[40:43], v[72:75]
    v_min3_u32 v76, v35, v39, v43
    s_waitcnt vmcnt(0)
    v_mfma_f32_16x16x32_bf16 v[72:75], v[64:67], v[44:47], v[72:75]
    v_min_u32 v76, v76, v47
    v_cmp_ne_u32 vcc, s67, v76
    s_cbranch_vccz p_ok_51
    s_cmp_lt_u32 s71, 0x200000
    s_cbranch_scc1 p_retry_50
p_ok_51:
    s_nop 1
    s_nop 0
    v_add_f32_dpp v72, v72, v72 row_ror:8 row_mask:0xf bank_mask:0xf
    v_add_f32_dpp v73, v73, v73 row_ror:8 row_mask:0xf bank_mask:0xf
    s_nop 0
    v_mov_b32_dpp v76, v72 quad_perm:[1,0,3,2] row_mask:0xf bank_mask:0xf
    v_mov_b32_dpp v77, v73 quad_perm:[1,0,3,2] row_mask:0xf bank_mask:0xf
    v_cvt_pk_bf16_f32 v76, v72, v76
    v_cvt_pk_bf16_f32 v77, v73, v77
    v_mov_b32 v78, -1
    s_mov_b64 exec, s[58:59]
    buffer_store_dword v76, v68, s[4:7], s22 offen sc1
    buffer_store_dword v77, v68, s[4:7], s22 offen offset:16 sc1
    buffer_store_dword v78, v68, s[4:7], s39 offen sc1
    buffer_store_dword v78, v68, s[4:7], s39 offen offset:16 sc1
    s_mov_b64 exec, -1
notask_47:
    s_add_u32 s22, s22, 9216
    s_cmp_ge_u32 s22, s40
    s_cselect_b32 s28, 36864, 0
    s_sub_u32 s22, s22, s28
    s_add_u32 s39, s39, 9216
    s_cmp_ge_u32 s39, s40
    s_cselect_b32 s28, 36864, 0
    s_sub_u32 s39, s39, s28
    s_add_u32 s24, s24, 262144
    s_add_u32 s25, s25, 131072
    s_add_u32 s26, s26, 65536
    s_add_u32 s23, s23, 262144
    s_add_u32 s20, s20, 1
    s_cmp_lt_u32 s20, 63
    s_cbranch_scc1 chain_loop_38
    s_cmp_lg_u32 s19, 3
    s_cbranch_scc1 nochk_52
    s_add_u32 s29, s20, 2
    s_min_u32 s29, s29, 63
    s_cmp_lt_u32 s29, s10
    s_cbranch_scc1 rdy_ok_54
    s_add_u32 s29, s20, 1
    s_min_u32 s29, s29, 63
    s_mov_b32 s30, 0
    v_lshrrev_b32 v52, 2, v0
    s_mov_b32 s28, 65011712
rdy_53:
    buffer_load_dword v53, v52, s[4:7], s28 offen sc1
    s_waitcnt vmcnt(0)
    v_cmp_ne_u32 vcc, 32, v53
    s_nop 0
    s_ff1_i32_b64 s10, vcc
    s_cmp_eq_u32 s10, -1
    s_cselect_b32 s10, 64, s10
    s_cmp_lt_u32 s29, s10
    s_cbranch_scc1 rdy_ok_54
    s_sleep 8
    s_add_u32 s30, s30, 1
    s_cmp_lt_u32 s30, 0x80000
    s_cbranch_scc1 rdy_53
    s_mov_b32 s10, 64
rdy_ok_54:
nochk_52:
    ds_read_b128 v[64:67], v26 offset:0
    ds_read_b128 v[68:71], v26 offset:1024
    ds_read_b128 v[72:75], v26 offset:8192
    ds_read_b128 v[76:79], v26 offset:9216
    v_mov_b64 v[32:33], 0
    v_mov_b64 v[34:35], 0
    v_mov_b64 v[36:37], 0
    v_mov_b64 v[38:39], 0
    v_mov_b64 v[40:41], 0
    v_mov_b64 v[42:43], 0
    v_mov_b64 v[44:45], 0
    v_mov_b64 v[46:47], 0
    v_add_u32 v55, s57, v0
    s_cmp_eq_u32 s19, 2
    s_cbranch_scc1 acq_w2_58
    s_cmp_lg_u32 s19, 3
    s_cbranch_scc1 nd3_59
    s_nop 15
    s_nop 15
    s_nop 15
    s_nop 15
    s_nop 15
    s_nop 15
    s_nop 15
    s_nop 15
    s_nop 15
    s_nop 15
nd3_59:
    s_nop 15
mem_poll_55:
    buffer_load_dwordx4 v[56:59], v0, s[4:7], s21 offen sc1
    buffer_load_dwordx4 v[60:63], v0, s[4:7], s21 offen offset:1024 sc1
    s_add_u32 s27, s27, 1
    s_waitcnt vmcnt(1)
    ds_write_b128 v55, v[56:59] offset:0
    v_max3_u32 v52, v56, v57, v58
    s_waitcnt vmcnt(0)
    ds_write_b128 v55, v[60:63] offset:1024
    v_max3_u32 v52, v52, v59, v60
    v_max3_u32 v52, v52, v61, v62
    v_max_u32 v52, v52, v63
    v_cmp_eq_u32 vcc, -1, v52
    s_cbranch_vccz mem_done_56
    s_cmp_lt_u32 s27, 0x200000
    s_cbranch_scc1 mem_poll_55
    s_branch mem_done_56
acq_w2_58:
    s_nop 15
    s_nop 15
mem_poll2_57:
    buffer_load_dwordx4 v[56:59], v0, s[4:7], s21 offen sc1
    buffer_load_dwordx4 v[60:63], v0, s[4:7], s21 offen offset:1024 sc1
    buffer_load_dwordx4 v[48:51], v0, s[4:7], s21 offen offset:2048 sc1
    s_add_u32 s61, s61, 1
    s_waitcnt vmcnt(2)
    ds_write_b128 v55, v[56:59] offset:0
    v_max3_u32 v52, v56, v57, v58
    s_waitcnt vmcnt(1)
    ds_write_b128 v55, v[60:63] offset:1024
    v_max3_u32 v52, v52, v59, v60
    v_max3_u32 v52, v52, v61, v62
    s_waitcnt vmcnt(0)
    ds_write_b128 v55, v[48:51] offset:2048
    v_max3_u32 v52, v52, v63, v48
    v_max3_u32 v52, v52, v49, v50
    v_max_u32 v52, v52, v51
    v_cmp_eq_u32 vcc, -1, v52
    s_cbranch_vccz mem_done_56
    s_cmp_lt_u32 s61, 0x200000
    s_cbranch_scc1 mem_poll2_57
mem_done_56:
    s_waitcnt lgkmcnt(0)
    s_barrier
    ds_read_b128 v[56:59], v0 offset:0
    ds_read_b128 v[60:63], v0 offset:1024
    s_add_u32 s67, s20, 1
    s_max_u32 s13, s20, 1
    s_sub_u32 s13, s13, 1
    ds_read_b128 v[48:51], v0 offset:2048
    buffer_load_dwordx4 v[18:21], v0, s[4:7], s24 offen offset:0 sc1
    s_waitcnt lgkmcnt(2)
    v_smfmac_f32_16x16x64_bf16 v[40:43], v[56:59], a[144:151], v1
    s_add_u32 s21, s21, 9216
    s_cmp_ge_u32 s21, s60
    v_smfmac_f32_16x16x64_bf16 v[44:47], v[56:59], a[216:223], v1
    buffer_load_dwordx4 v[22:25], v0, s[4:7], s24 offen offset:1024 sc1
    ds_read_b128 v[56:59], v0 offset:3072
    s_cselect_b32 s28, 36864, 0
    s_sub_u32 s21, s21, s28
    s_waitcnt lgkmcnt(2)
    v_smfmac_f32_16x16x64_bf16 v[40:43], v[60:63], a[152:159], v1
    v_lshrrev_b32 v52, 1, v0
    v_smfmac_f32_16x16x64_bf16 v[44:47], v[60:63], v[64:71], v1
    buffer_store_dwordx2 v[28:29], v52, s[4:7], s26 offen sc1
    ds_read_b128 v[60:63], v0 offset:4096
    ds_read_b128 v[64:67], v26 offset:16384
    s_waitcnt lgkmcnt(3)
    v_smfmac_f32_16x16x64_bf16 v[40:43], v[48:51], a[160:167], v1
    ds_read_b128 v[68:71], v26 offset:17408
    v_smfmac_f32_16x16x64_bf16 v[44:47], v[48:51], v[72:79], v1
    v_mov_b32 v53, s13
    ds_read_b128 v[48:51], v0 offset:5120
    ds_read_b128 v[72:75], v26 offset:24576
    s_waitcnt lgkmcnt(5)
    v_smfmac_f32_16x16x64_bf16 v[40:43], v[56:59], a[168:175], v1
    ds_read_b128 v[76:79], v26 offset:25600
    s_waitcnt lgkmcnt(3)
    v_smfmac_f32_16x16x64_bf16 v[44:47], v[56:59], v[64:71], v1
    s_mov_b64 exec, s[8:9]
    buffer_store_dword v53, v3, s[4:7], s11 offen sc1
    s_mov_b64 exec, -1
    ds_read_b128 v[56:59], v0 offset:6144
    ds_read_b128 v[64:67], v26 offset:32768
    v_smfmac_f32_16x16x64_bf16 v[40:43], v[60:63], a[176:183], v1
    ds_read_b128 v[68:71], v26 offset:33792
    s_waitcnt lgkmcnt(3)
    v_smfmac_f32_16x16x64_bf16 v[44:47], v[60:63], v[72:79], v1
    s_sub_u32 s28, s24, s48
    s_add_u32 s28, s28, 262144
    v_lshlrev_b32 v27, 3, v0
    ds_read_b128 v[60:63], v0 offset:7168
    ds_read_b128 v[72:75], v26 offset:40960
    v_smfmac_f32_16x16x64_bf16 v[40:43], v[48:51], a[184:191], v1
    ds_read_b128 v[76:79], v26 offset:41984
    s_waitcnt lgkmcnt(3)
    v_smfmac_f32_16x16x64_bf16 v[44:47], v[48:51], v[64:71], v1
    s_sub_u32 s29, s23, s48
    s_add_u32 s29, s29, 262144
    s_add_u32 s30, s20, 2
    s_cmp_lt_u32 s30, s10
    s_cselect_b32 s29, s29, s28
    ds_read_b128 v[48:51], v0 offset:8192
    ds_read_b128 v[64:67], v26 offset:49152
    v_smfmac_f32_16x16x64_bf16 v[40:43], v[56:59], a[192:199], v1
    ds_read_b128 v[68:71], v26 offset:50176
    s_waitcnt lgkmcnt(3)
    v_smfmac_f32_16x16x64_bf16 v[44:47], v[56:59], v[72:79], v1
    s_mov_b64 exec, s[46:47]
    buffer_load_dword v27, v27, s[4:7], s28 offen
    buffer_load_dword v27, v27, s[4:7], s29 offen
    s_mov_b64 exec, -1
    ds_read_b128 v[72:75], v26 offset:57344
    ds_read_b128 v[76:79], v26 offset:58368
    v_smfmac_f32_16x16x64_bf16 v[40:43], v[60:63], a[200:207], v1
    s_waitcnt lgkmcnt(2)
    v_smfmac_f32_16x16x64_bf16 v[44:47], v[60:63], v[64:71], v1
    v_add_u32 v26, 0x10000, v26
    ds_read_b128 v[64:67], v26 offset:0
    ds_read_b128 v[68:71], v26 offset:1024
    v_smfmac_f32_16x16x64_bf16 v[40:43], v[48:51], a[208:215], v1
    s_waitcnt lgkmcnt(2)
    v_smfmac_f32_16x16x64_bf16 v[44:47], v[48:51], v[72:79], v1
    s_nop 4
    v_add_f32 v40, v40, v42
    v_add_f32 v41, v41, v43
    v_mov_b64 v[52:53], 0
    v_mov_b64 v[54:55], 0
    v_add_f32 v44, v44, v46
    v_add_f32 v45, v45, v47
    v_cvt_pk_bf16_f32 v42, v40, v41
    v_cvt_pk_bf16_f32 v43, v44, v45
    v_mov_b64 v[48:49], 0
    v_mov_b64 v[50:51], 0
    v_mfma_f32_16x16x16_bf16 v[44:47], v[42:43], v[6:7], 0
    v_mfma_f32_16x16x16_bf16 v[40:43], v[42:43], v[8:9], 0
    s_nop 4
    v_cvt_pk_bf16_f32 v44, v44, v45
    v_cvt_pk_bf16_f32 v45, v46, v47
    s_nop 0
    v_cvt_pk_bf16_f32 v46, v40, v41
    v_cvt_pk_bf16_f32 v47, v42, v43
    buffer_store_dwordx4 v[44:47], v0, s[4:7], s25 offen sc1
    v_smfmac_f32_16x16x64_bf16 v[48:51], v[56:59], a[224:231], v1
    ds_read_b128 v[72:75], v26 offset:8192
    v_smfmac_f32_16x16x64_bf16 v[52:55], v[56:59], a[232:239], v1
    ds_read_b128 v[76:79], v26 offset:9216
    ds_read_b128 v[56:59], v0 offset:0
    v_smfmac_f32_16x16x64_bf16 v[48:51], v[60:63], a[240:247], v1
    v_smfmac_f32_16x16x64_bf16 v[52:55], v[60:63], a[248:255], v1
    ds_read_b128 v[60:63], v0 offset:1024
    s_waitcnt lgkmcnt(1)
    v_smfmac_f32_16x16x64_bf16 v[48:51], v[56:59], v[80:87], v1
    v_smfmac_f32_16x16x64_bf16 v[52:55], v[56:59], v[88:95], v1
    ds_read_b128 v[56:59], v0 offset:2048
    s_waitcnt lgkmcnt(1)
    v_smfmac_f32_16x16x64_bf16 v[48:51], v[60:63], v[96:103], v1
    v_smfmac_f32_16x16x64_bf16 v[52:55], v[60:63], v[104:111], v1
    ds_read_b128 v[60:63], v0 offset:3072
    s_waitcnt lgkmcnt(1)
    v_smfmac_f32_16x16x64_bf16 v[48:51], v[56:59], v[64:71], v1
    ds_read_b128 v[64:67], v26 offset:16384
    ds_read_b128 v[68:71], v26 offset:17408
    v_smfmac_f32_16x16x64_bf16 v[52:55], v[56:59], v[72:79], v1
    ds_read_b128 v[72:75], v26 offset:24576
    ds_read_b128 v[76:79], v26 offset:25600
    ds_read_b128 v[56:59], v0 offset:4096
    s_waitcnt lgkmcnt(3)
    v_smfmac_f32_16x16x64_bf16 v[48:51], v[60:63], v[64:71], v1
    ds_read_b128 v[64:67], v26 offset:32768
    ds_read_b128 v[68:71], v26 offset:33792
    s_waitcnt lgkmcnt(3)
    v_smfmac_f32_16x16x64_bf16 v[52:55], v[60:63], v[72:79], v1
    ds_read_b128 v[72:75], v26 offset:40960
    ds_read_b128 v[76:79], v26 offset:41984
    ds_read_b128 v[60:63], v0 offset:5120
    s_waitcnt lgkmcnt(3)
    v_smfmac_f32_16x16x64_bf16 v[48:51], v[56:59], v[64:71], v1
    ds_read_b128 v[64:67], v26 offset:49152
    ds_read_b128 v[68:71], v26 offset:50176
    s_waitcnt lgkmcnt(3)
    v_smfmac_f32_16x16x64_bf16 v[52:55], v[56:59], v[72:79], v1
    ds_read_b128 v[72:75], v26 offset:57344
    ds_read_b128 v[76:79], v26 offset:58368
    ds_read_b128 v[56:59], v0 offset:8192
    s_waitcnt lgkmcnt(3)
    v_smfmac_f32_16x16x64_bf16 v[48:51], v[60:63], v[64:71], v1
    v_add_u32 v26, 0x10000, v26
    ds_read_b128 v[64:67], v26 offset:0
    ds_read_b128 v[68:71], v26 offset:1024
    s_waitcnt lgkmcnt(3)
    v_smfmac_f32_16x16x64_bf16 v[52:55], v[60:63], v[72:79], v1
    ds_read_b128 v[72:75], v26 offset:8192
    ds_read_b128 v[76:79], v26 offset:9216
    s_waitcnt lgkmcnt(2)
    v_smfmac_f32_16x16x64_bf16 v[48:51], v[56:59], v[64:71], v1
    s_waitcnt lgkmcnt(0)
    v_smfmac_f32_16x16x64_bf16 v[52:55], v[56:59], v[72:79], v1
    v_subrev_u32 v26, 0x20000, v26
    s_nop 2
    v_add_f32 v48, v48, v50
    v_add_f32 v49, v49, v51
    s_nop 1
    v_add_f32 v52, v52, v54
    v_add_f32 v53, v53, v55
    v_cvt_pk_bf16_f32 v50, v48, v49
    v_cvt_pk_bf16_f32 v51, v52, v53
    s_add_u32 s26, s26, 65536
    v_lshrrev_b32 v60, 1, v0
    buffer_store_dwordx2 v[50:51], v60, s[4:7], s26 offen sc1
    s_nop 3
    s_waitcnt vmcnt(0)
    s_barrier
    v_mov_b32 v52, 64
    v_mov_b32 v53, 0
    s_mov_b64 exec, s[8:9]
    buffer_store_dword v52, v53, s[4:7], s11 offen sc1
    s_mov_b64 exec, -1
    s_branch over_slow_60
over_slow_60:
    s_branch L_end
L_worker:
    s_sub_u32 s44, s18, 32
    s_cmp_lg_u32 s44, 0
    s_cbranch_scc1 noinit_61
    v_mov_b64 v[44:45], 0
    v_mov_b64 v[46:47], 0
    s_lshl_b32 s28, s19, 10
    s_add_u32 s28, s28, 65011712
    buffer_store_dwordx4 v[44:47], v0, s[4:7], s28 offen sc1
    s_add_u32 s28, s28, 4096
    buffer_store_dwordx4 v[44:47], v0, s[4:7], s28 offen sc1
    s_add_u32 s28, s28, 4096
    buffer_store_dwordx4 v[44:47], v0, s[4:7], s28 offen sc1
    s_add_u32 s28, s28, 4096
    buffer_store_dwordx4 v[44:47], v0, s[4:7], s28 offen sc1
    s_add_u32 s28, s28, 4096
    s_waitcnt vmcnt(0)
    s_barrier
    s_cmp_lg_u32 s19, 0
    s_cbranch_scc1 ini2_62
    s_mov_b64 exec, 1
    v_mov_b32 v44, 1
    v_mov_b32 v45, 52
    global_store_dword v45, v44, s[16:17] sc1
    s_mov_b64 exec, -1
ini2_62:
noinit_61:
    s_cmp_ge_u32 s44, 192
    s_cbranch_scc1 L_p1b
    s_mul_hi_u32 s36, s44, 89478486
    s_mul_i32 s36, s36, 48
    s_sub_u32 s36, s44, s36
    s_cmp_lt_u32 s36, 32
    s_cbranch_scc1 noqd_63
    s_sleep 127
    s_sleep 127
noqd_63:
    s_mul_hi_u32 s20, s44, 89478486
    s_mul_i32 s28, s20, 48
    s_sub_u32 s36, s44, s28
    s_lshr_b32 s37, s36, 4
    s_and_b32 s38, s36, 15
    s_mov_b32 s8, s72
    s_and_b32 s9, s73, 0xffff
    s_mov_b32 s10, 2359296
    s_mov_b32 s11, 0x20000
    s_cmp_eq_u32 s37, 0
    s_cselect_b32 s28, s78, s80
    s_cselect_b32 s29, s79, s81
    s_cmp_eq_u32 s37, 2
    s_cselect_b32 s28, s76, s28
    s_cselect_b32 s29, s77, s29
    s_mov_b32 s12, s28
    s_and_b32 s13, s29, 0xffff
    s_mov_b32 s14, 4718592
    s_mov_b32 s15, 0x20000
    s_lshl_b32 s24, s38, 9
    s_mov_b32 s25, 8192
    s_mov_b32 s21, 4
    s_mov_b32 s22, 16
    s_lshr_b32 s28, s19, 1
    s_lshl_b32 s29, s38, 1
    s_add_u32 s28, s28, s29
    s_lshl_b32 s26, s28, 13
    s_and_b32 s28, s19, 1
    s_lshl_b32 s28, s28, 12
    s_add_u32 s26, s26, s28
    s_mov_b32 s29, 16777216
    s_cmp_eq_u32 s37, 0
    s_cselect_b32 s28, 0, s29
    s_cmp_eq_u32 s37, 2
    s_cselect_b32 s28, 33554432, s28
    s_add_u32 s26, s26, s28
    s_mov_b32 s29, 65011712
    s_cmp_eq_u32 s37, 2
    s_cselect_b32 s27, 65011968, s29
    v_lshrrev_b32 v40, 5, v33
    v_and_b32 v41, 31, v33
    s_and_b32 s28, s19, 1
    s_lshl_b32 s28, s28, 2
    v_add_u32 v42, 0, v40
    v_and_b32 v43, 3, v42
    v_or_b32 v43, s28, v43
    v_lshlrev_b32 v43, 1, v43
    v_xor_b32 v43, v43, v41
    v_lshlrev_b32 v43, 4, v43
    v_mul_lo_u32 v42, v42, s25
    v_add_u32 v52, v42, v43
    v_add_u32 v42, 2, v40
    v_and_b32 v43, 3, v42
    v_or_b32 v43, s28, v43
    v_lshlrev_b32 v43, 1, v43
    v_xor_b32 v43, v43, v41
    v_lshlrev_b32 v43, 4, v43
    v_mul_lo_u32 v42, v42, s25
    v_add_u32 v53, v42, v43
    v_add_u32 v42, 4, v40
    v_and_b32 v43, 3, v42
    v_or_b32 v43, s28, v43
    v_lshlrev_b32 v43, 1, v43
    v_xor_b32 v43, v43, v41
    v_lshlrev_b32 v43, 4, v43
    v_mul_lo_u32 v42, v42, s25
    v_add_u32 v54, v42, v43
    v_add_u32 v42, 6, v40
    v_and_b32 v43, 3, v42
    v_or_b32 v43, s28, v43
    v_lshlrev_b32 v43, 1, v43
    v_xor_b32 v43, v43, v41
    v_lshlrev_b32 v43, 4, v43
    v_mul_lo_u32 v42, v42, s25
    v_add_u32 v55, v42, v43
    v_lshrrev_b32 v40, 2, v34
    v_and_b32 v41, 3, v34
    v_and_b32 v42, 1, v35
    v_lshl_or_b32 v42, v42, 2, v40
    v_lshl_add_u32 v43, v35, 3, v40
    v_lshlrev_b32 v43, 9, v43
    v_lshl_add_u32 v43, v41, 3, v43
    s_mul_i32 s28, s19, 4
    s_add_u32 s29, s28, 0
    v_xor_b32 v44, s29, v42
    v_lshl_add_u32 v56, v44, 5, v43
    s_add_u32 s29, s28, 1
    v_xor_b32 v44, s29, v42
    v_lshl_add_u32 v57, v44, 5, v43
    s_add_u32 s29, s28, 2
    v_xor_b32 v44, s29, v42
    v_lshl_add_u32 v58, v44, 5, v43
    s_add_u32 s29, s28, 3
    v_xor_b32 v44, s29, v42
    v_lshl_add_u32 v59, v44, 5, v43
    s_lshl_b32 s28, s19, 3
    s_add_u32 s28, s28, 0
    s_mul_i32 s28, s28, s25
    s_add_u32 s28, s28, s24
    s_lshl_b32 s29, s19, 12
    s_add_u32 s29, s29, 0
    s_add_u32 m0, s29, 0
    s_nop 0
    buffer_load_dwordx4 v52, s[12:15], s28 offen lds
    s_add_u32 m0, s29, 1024
    s_nop 0
    buffer_load_dwordx4 v53, s[12:15], s28 offen lds
    s_add_u32 m0, s29, 2048
    s_nop 0
    buffer_load_dwordx4 v54, s[12:15], s28 offen lds
    s_add_u32 m0, s29, 3072
    s_nop 0
    buffer_load_dwordx4 v55, s[12:15], s28 offen lds
    s_lshl_b32 s28, s19, 3
    s_add_u32 s28, s28, 32
    s_mul_i32 s28, s28, s25
    s_add_u32 s28, s28, s24
    s_lshl_b32 s29, s19, 12
    s_add_u32 s29, s29, 16384
    s_add_u32 m0, s29, 0
    s_nop 0
    buffer_load_dwordx4 v52, s[12:15], s28 offen lds
    s_add_u32 m0, s29, 1024
    s_nop 0
    buffer_load_dwordx4 v53, s[12:15], s28 offen lds
    s_add_u32 m0, s29, 2048
    s_nop 0
    buffer_load_dwordx4 v54, s[12:15], s28 offen lds
    s_add_u32 m0, s29, 3072
    s_nop 0
    buffer_load_dwordx4 v55, s[12:15], s28 offen lds
    s_lshl_b32 s28, s19, 3
    s_add_u32 s28, s28, 64
    s_mul_i32 s28, s28, s25
    s_add_u32 s28, s28, s24
    s_lshl_b32 s29, s19, 12
    s_add_u32 s29, s29, 32768
    s_add_u32 m0, s29, 0
    s_nop 0
    buffer_load_dwordx4 v52, s[12:15], s28 offen lds
    s_add_u32 m0, s29, 1024
    s_nop 0
    buffer_load_dwordx4 v53, s[12:15], s28 offen lds
    s_add_u32 m0, s29, 2048
    s_nop 0
    buffer_load_dwordx4 v54, s[12:15], s28 offen lds
    s_add_u32 m0, s29, 3072
    s_nop 0
    buffer_load_dwordx4 v55, s[12:15], s28 offen lds
    s_lshl_b32 s28, s19, 3
    s_add_u32 s28, s28, 96
    s_mul_i32 s28, s28, s25
    s_add_u32 s28, s28, s24
    s_lshl_b32 s29, s19, 12
    s_add_u32 s29, s29, 49152
    s_add_u32 m0, s29, 0
    s_nop 0
    buffer_load_dwordx4 v52, s[12:15], s28 offen lds
    s_add_u32 m0, s29, 1024
    s_nop 0
    buffer_load_dwordx4 v53, s[12:15], s28 offen lds
    s_add_u32 m0, s29, 2048
    s_nop 0
    buffer_load_dwordx4 v54, s[12:15], s28 offen lds
    s_add_u32 m0, s29, 3072
    s_nop 0
    buffer_load_dwordx4 v55, s[12:15], s28 offen lds
    s_lshl_b32 s28, s19, 3
    s_add_u32 s28, s28, 128
    s_mul_i32 s28, s28, s25
    s_add_u32 s28, s28, s24
    s_lshl_b32 s29, s19, 12
    s_add_u32 s29, s29, 65536
    s_add_u32 m0, s29, 0
    s_nop 0
    buffer_load_dwordx4 v52, s[12:15], s28 offen lds
    s_add_u32 m0, s29, 1024
    s_nop 0
    buffer_load_dwordx4 v53, s[12:15], s28 offen lds
    s_add_u32 m0, s29, 2048
    s_nop 0
    buffer_load_dwordx4 v54, s[12:15], s28 offen lds
    s_add_u32 m0, s29, 3072
    s_nop 0
    buffer_load_dwordx4 v55, s[12:15], s28 offen lds
    s_lshl_b32 s28, s19, 3
    s_add_u32 s28, s28, 160
    s_mul_i32 s28, s28, s25
    s_add_u32 s28, s28, s24
    s_lshl_b32 s29, s19, 12
    s_add_u32 s29, s29, 81920
    s_add_u32 m0, s29, 0
    s_nop 0
    buffer_load_dwordx4 v52, s[12:15], s28 offen lds
    s_add_u32 m0, s29, 1024
    s_nop 0
    buffer_load_dwordx4 v53, s[12:15], s28 offen lds
    s_add_u32 m0, s29, 2048
    s_nop 0
    buffer_load_dwordx4 v54, s[12:15], s28 offen lds
    s_add_u32 m0, s29, 3072
    s_nop 0
    buffer_load_dwordx4 v55, s[12:15], s28 offen lds
    s_lshl_b32 s28, s19, 3
    s_add_u32 s28, s28, 192
    s_mul_i32 s28, s28, s25
    s_add_u32 s28, s28, s24
    s_lshl_b32 s29, s19, 12
    s_add_u32 s29, s29, 98304
    s_add_u32 m0, s29, 0
    s_nop 0
    buffer_load_dwordx4 v52, s[12:15], s28 offen lds
    s_add_u32 m0, s29, 1024
    s_nop 0
    buffer_load_dwordx4 v53, s[12:15], s28 offen lds
    s_add_u32 m0, s29, 2048
    s_nop 0
    buffer_load_dwordx4 v54, s[12:15], s28 offen lds
    s_add_u32 m0, s29, 3072
    s_nop 0
    buffer_load_dwordx4 v55, s[12:15], s28 offen lds
    s_lshl_b32 s28, s19, 3
    s_add_u32 s28, s28, 224
    s_mul_i32 s28, s28, s25
    s_add_u32 s28, s28, s24
    s_lshl_b32 s29, s19, 12
    s_add_u32 s29, s29, 114688
    s_add_u32 m0, s29, 0
    s_nop 0
    buffer_load_dwordx4 v52, s[12:15], s28 offen lds
    s_add_u32 m0, s29, 1024
    s_nop 0
    buffer_load_dwordx4 v53, s[12:15], s28 offen lds
    s_add_u32 m0, s29, 2048
    s_nop 0
    buffer_load_dwordx4 v54, s[12:15], s28 offen lds
    s_add_u32 m0, s29, 3072
    s_nop 0
    buffer_load_dwordx4 v55, s[12:15], s28 offen lds
    s_lshl_b32 s28, s19, 3
    s_add_u32 s28, s28, 256
    s_mul_i32 s28, s28, s25
    s_add_u32 s28, s28, s24
    s_lshl_b32 s29, s19, 12
    s_add_u32 s29, s29, 131072
    s_add_u32 m0, s29, 0
    s_nop 0
    buffer_load_dwordx4 v52, s[12:15], s28 offen lds
    s_add_u32 m0, s29, 1024
    s_nop 0
    buffer_load_dwordx4 v53, s[12:15], s28 offen lds
    s_add_u32 m0, s29, 2048
    s_nop 0
    buffer_load_dwordx4 v54, s[12:15], s28 offen lds
    s_add_u32 m0, s29, 3072
    s_nop 0
    buffer_load_dwordx4 v55, s[12:15], s28 offen lds
    s_lshl_b32 s28, s19, 3
    s_add_u32 s28, s28, 288
    s_mul_i32 s28, s28, s25
    s_add_u32 s28, s28, s24
    s_lshl_b32 s29, s19, 12
    s_add_u32 s29, s29, 147456
    s_add_u32 m0, s29, 0
    s_nop 0
    buffer_load_dwordx4 v52, s[12:15], s28 offen lds
    s_add_u32 m0, s29, 1024
    s_nop 0
    buffer_load_dwordx4 v53, s[12:15], s28 offen lds
    s_add_u32 m0, s29, 2048
    s_nop 0
    buffer_load_dwordx4 v54, s[12:15], s28 offen lds
    s_add_u32 m0, s29, 3072
    s_nop 0
    buffer_load_dwordx4 v55, s[12:15], s28 offen lds
    s_waitcnt vmcnt(36)
    s_barrier
    v_add_u32 v44, 0, v56
    ds_read_b64_tr_b16 a[0:1], v44
    ds_read_b64_tr_b16 a[2:3], v44 offset:2048
    v_add_u32 v44, 0, v57
    ds_read_b64_tr_b16 a[72:73], v44
    ds_read_b64_tr_b16 a[74:75], v44 offset:2048
    v_add_u32 v44, 0, v58
    ds_read_b64_tr_b16 a[144:145], v44
    ds_read_b64_tr_b16 a[146:147], v44 offset:2048
    v_add_u32 v44, 0, v59
    ds_read_b64_tr_b16 a[216:217], v44
    ds_read_b64_tr_b16 a[218:219], v44 offset:2048
    s_waitcnt lgkmcnt(0)
    s_barrier
    s_lshl_b32 s28, s19, 3
    s_add_u32 s28, s28, 320
    s_mul_i32 s28, s28, s25
    s_add_u32 s28, s28, s24
    s_lshl_b32 s29, s19, 12
    s_add_u32 s29, s29, 0
    s_add_u32 m0, s29, 0
    s_nop 0
    buffer_load_dwordx4 v52, s[12:15], s28 offen lds
    s_add_u32 m0, s29, 1024
    s_nop 0
    buffer_load_dwordx4 v53, s[12:15], s28 offen lds
    s_add_u32 m0, s29, 2048
    s_nop 0
    buffer_load_dwordx4 v54, s[12:15], s28 offen lds
    s_add_u32 m0, s29, 3072
    s_nop 0
    buffer_load_dwordx4 v55, s[12:15], s28 offen lds
    s_waitcnt vmcnt(36)
    s_barrier
    v_add_u32 v44, 16384, v56
    ds_read_b64_tr_b16 a[4:5], v44
    ds_read_b64_tr_b16 a[6:7], v44 offset:2048
    v_add_u32 v44, 16384, v57
    ds_read_b64_tr_b16 a[76:77], v44
    ds_read_b64_tr_b16 a[78:79], v44 offset:2048
    v_add_u32 v44, 16384, v58
    ds_read_b64_tr_b16 a[148:149], v44
    ds_read_b64_tr_b16 a[150:151], v44 offset:2048
    v_add_u32 v44, 16384, v59
    ds_read_b64_tr_b16 a[220:221], v44
    ds_read_b64_tr_b16 a[222:223], v44 offset:2048
    s_waitcnt lgkmcnt(0)
    s_barrier
    s_lshl_b32 s28, s19, 3
    s_add_u32 s28, s28, 352
    s_mul_i32 s28, s28, s25
    s_add_u32 s28, s28, s24
    s_lshl_b32 s29, s19, 12
    s_add_u32 s29, s29, 16384
    s_add_u32 m0, s29, 0
    s_nop 0
    buffer_load_dwordx4 v52, s[12:15], s28 offen lds
    s_add_u32 m0, s29, 1024
    s_nop 0
    buffer_load_dwordx4 v53, s[12:15], s28 offen lds
    s_add_u32 m0, s29, 2048
    s_nop 0
    buffer_load_dwordx4 v54, s[12:15], s28 offen lds
    s_add_u32 m0, s29, 3072
    s_nop 0
    buffer_load_dwordx4 v55, s[12:15], s28 offen lds
    s_waitcnt vmcnt(36)
    s_barrier
    v_add_u32 v44, 32768, v56
    ds_read_b64_tr_b16 a[8:9], v44
    ds_read_b64_tr_b16 a[10:11], v44 offset:2048
    v_add_u32 v44, 32768, v57
    ds_read_b64_tr_b16 a[80:81], v44
    ds_read_b64_tr_b16 a[82:83], v44 offset:2048
    v_add_u32 v44, 32768, v58
    ds_read_b64_tr_b16 a[152:153], v44
    ds_read_b64_tr_b16 a[154:155], v44 offset:2048
    v_add_u32 v44, 32768, v59
    ds_read_b64_tr_b16 a[224:225], v44
    ds_read_b64_tr_b16 a[226:227], v44 offset:2048
    s_waitcnt lgkmcnt(0)
    s_barrier
    s_lshl_b32 s28, s19, 3
    s_add_u32 s28, s28, 384
    s_mul_i32 s28, s28, s25
    s_add_u32 s28, s28, s24
    s_lshl_b32 s29, s19, 12
    s_add_u32 s29, s29, 32768
    s_add_u32 m0, s29, 0
    s_nop 0
    buffer_load_dwordx4 v52, s[12:15], s28 offen lds
    s_add_u32 m0, s29, 1024
    s_nop 0
    buffer_load_dwordx4 v53, s[12:15], s28 offen lds
    s_add_u32 m0, s29, 2048
    s_nop 0
    buffer_load_dwordx4 v54, s[12:15], s28 offen lds
    s_add_u32 m0, s29, 3072
    s_nop 0
    buffer_load_dwordx4 v55, s[12:15], s28 offen lds
    s_waitcnt vmcnt(36)
    s_barrier
    v_add_u32 v44, 49152, v56
    ds_read_b64_tr_b16 a[12:13], v44
    ds_read_b64_tr_b16 a[14:15], v44 offset:2048
    v_add_u32 v44, 49152, v57
    ds_read_b64_tr_b16 a[84:85], v44
    ds_read_b64_tr_b16 a[86:87], v44 offset:2048
    v_add_u32 v44, 49152, v58
    ds_read_b64_tr_b16 a[156:157], v44
    ds_read_b64_tr_b16 a[158:159], v44 offset:2048
    v_add_u32 v44, 49152, v59
    ds_read_b64_tr_b16 a[228:229], v44
    ds_read_b64_tr_b16 a[230:231], v44 offset:2048
    s_waitcnt lgkmcnt(0)
    s_barrier
    s_lshl_b32 s28, s19, 3
    s_add_u32 s28, s28, 416
    s_mul_i32 s28, s28, s25
    s_add_u32 s28, s28, s24
    s_lshl_b32 s29, s19, 12
    s_add_u32 s29, s29, 49152
    s_add_u32 m0, s29, 0
    s_nop 0
    buffer_load_dwordx4 v52, s[12:15], s28 offen lds
    s_add_u32 m0, s29, 1024
    s_nop 0
    buffer_load_dwordx4 v53, s[12:15], s28 offen lds
    s_add_u32 m0, s29, 2048
    s_nop 0
    buffer_load_dwordx4 v54, s[12:15], s28 offen lds
    s_add_u32 m0, s29, 3072
    s_nop 0
    buffer_load_dwordx4 v55, s[12:15], s28 offen lds
    s_waitcnt vmcnt(36)
    s_barrier
    v_add_u32 v44, 65536, v56
    ds_read_b64_tr_b16 a[16:17], v44
    ds_read_b64_tr_b16 a[18:19], v44 offset:2048
    v_add_u32 v44, 65536, v57
    ds_read_b64_tr_b16 a[88:89], v44
    ds_read_b64_tr_b16 a[90:91], v44 offset:2048
    v_add_u32 v44, 65536, v58
    ds_read_b64_tr_b16 a[160:161], v44
    ds_read_b64_tr_b16 a[162:163], v44 offset:2048
    v_add_u32 v44, 65536, v59
    ds_read_b64_tr_b16 a[232:233], v44
    ds_read_b64_tr_b16 a[234:235], v44 offset:2048
    s_waitcnt lgkmcnt(0)
    s_barrier
    s_lshl_b32 s28, s19, 3
    s_add_u32 s28, s28, 448
    s_mul_i32 s28, s28, s25
    s_add_u32 s28, s28, s24
    s_lshl_b32 s29, s19, 12
    s_add_u32 s29, s29, 65536
    s_add_u32 m0, s29, 0
    s_nop 0
    buffer_load_dwordx4 v52, s[12:15], s28 offen lds
    s_add_u32 m0, s29, 1024
    s_nop 0
    buffer_load_dwordx4 v53, s[12:15], s28 offen lds
    s_add_u32 m0, s29, 2048
    s_nop 0
    buffer_load_dwordx4 v54, s[12:15], s28 offen lds
    s_add_u32 m0, s29, 3072
    s_nop 0
    buffer_load_dwordx4 v55, s[12:15], s28 offen lds
    s_waitcnt vmcnt(36)
    s_barrier
    v_add_u32 v44, 81920, v56
    ds_read_b64_tr_b16 a[20:21], v44
    ds_read_b64_tr_b16 a[22:23], v44 offset:2048
    v_add_u32 v44, 81920, v57
    ds_read_b64_tr_b16 a[92:93], v44
    ds_read_b64_tr_b16 a[94:95], v44 offset:2048
    v_add_u32 v44, 81920, v58
    ds_read_b64_tr_b16 a[164:165], v44
    ds_read_b64_tr_b16 a[166:167], v44 offset:2048
    v_add_u32 v44, 81920, v59
    ds_read_b64_tr_b16 a[236:237], v44
    ds_read_b64_tr_b16 a[238:239], v44 offset:2048
    s_waitcnt lgkmcnt(0)
    s_barrier
    s_lshl_b32 s28, s19, 3
    s_add_u32 s28, s28, 480
    s_mul_i32 s28, s28, s25
    s_add_u32 s28, s28, s24
    s_lshl_b32 s29, s19, 12
    s_add_u32 s29, s29, 81920
    s_add_u32 m0, s29, 0
    s_nop 0
    buffer_load_dwordx4 v52, s[12:15], s28 offen lds
    s_add_u32 m0, s29, 1024
    s_nop 0
    buffer_load_dwordx4 v53, s[12:15], s28 offen lds
    s_add_u32 m0, s29, 2048
    s_nop 0
    buffer_load_dwordx4 v54, s[12:15], s28 offen lds
    s_add_u32 m0, s29, 3072
    s_nop 0
    buffer_load_dwordx4 v55, s[12:15], s28 offen lds
    s_waitcnt vmcnt(36)
    s_barrier
    v_add_u32 v44, 98304, v56
    ds_read_b64_tr_b16 a[24:25], v44
    ds_read_b64_tr_b16 a[26:27], v44 offset:2048
    v_add_u32 v44, 98304, v57
    ds_read_b64_tr_b16 a[96:97], v44
    ds_read_b64_tr_b16 a[98:99], v44 offset:2048
    v_add_u32 v44, 98304, v58
    ds_read_b64_tr_b16 a[168:169], v44
    ds_read_b64_tr_b16 a[170:171], v44 offset:2048
    v_add_u32 v44, 98304, v59
    ds_read_b64_tr_b16 a[240:241], v44
    ds_read_b64_tr_b16 a[242:243], v44 offset:2048
    s_waitcnt lgkmcnt(0)
    s_barrier
    s_lshl_b32 s28, s19, 3
    s_add_u32 s28, s28, 512
    s_mul_i32 s28, s28, s25
    s_add_u32 s28, s28, s24
    s_lshl_b32 s29, s19, 12
    s_add_u32 s29, s29, 98304
    s_add_u32 m0, s29, 0
    s_nop 0
    buffer_load_dwordx4 v52, s[12:15], s28 offen lds
    s_add_u32 m0, s29, 1024
    s_nop 0
    buffer_load_dwordx4 v53, s[12:15], s28 offen lds
    s_add_u32 m0, s29, 2048
    s_nop 0
    buffer_load_dwordx4 v54, s[12:15], s28 offen lds
    s_add_u32 m0, s29, 3072
    s_nop 0
    buffer_load_dwordx4 v55, s[12:15], s28 offen lds
    s_waitcnt vmcnt(36)
    s_barrier
    v_add_u32 v44, 114688, v56
    ds_read_b64_tr_b16 a[28:29], v44
    ds_read_b64_tr_b16 a[30:31], v44 offset:2048
    v_add_u32 v44, 114688, v57
    ds_read_b64_tr_b16 a[100:101], v44
    ds_read_b64_tr_b16 a[102:103], v44 offset:2048
    v_add_u32 v44, 114688, v58
    ds_read_b64_tr_b16 a[172:173], v44
    ds_read_b64_tr_b16 a[174:175], v44 offset:2048
    v_add_u32 v44, 114688, v59
    ds_read_b64_tr_b16 a[244:245], v44
    ds_read_b64_tr_b16 a[246:247], v44 offset:2048
    s_waitcnt lgkmcnt(0)
    s_barrier
    s_lshl_b32 s28, s19, 3
    s_add_u32 s28, s28, 544
    s_mul_i32 s28, s28, s25
    s_add_u32 s28, s28, s24
    s_lshl_b32 s29, s19, 12
    s_add_u32 s29, s29, 114688
    s_add_u32 m0, s29, 0
    s_nop 0
    buffer_load_dwordx4 v52, s[12:15], s28 offen lds
    s_add_u32 m0, s29, 1024
    s_nop 0
    buffer_load_dwordx4 v53, s[12:15], s28 offen lds
    s_add_u32 m0, s29, 2048
    s_nop 0
    buffer_load_dwordx4 v54, s[12:15], s28 offen lds
    s_add_u32 m0, s29, 3072
    s_nop 0
    buffer_load_dwordx4 v55, s[12:15], s28 offen lds
    s_waitcnt vmcnt(36)
    s_barrier
    v_add_u32 v44, 131072, v56
    ds_read_b64_tr_b16 a[32:33], v44
    ds_read_b64_tr_b16 a[34:35], v44 offset:2048
    v_add_u32 v44, 131072, v57
    ds_read_b64_tr_b16 a[104:105], v44
    ds_read_b64_tr_b16 a[106:107], v44 offset:2048
    v_add_u32 v44, 131072, v58
    ds_read_b64_tr_b16 a[176:177], v44
    ds_read_b64_tr_b16 a[178:179], v44 offset:2048
    v_add_u32 v44, 131072, v59
    ds_read_b64_tr_b16 a[248:249], v44
    ds_read_b64_tr_b16 a[250:251], v44 offset:2048
    s_waitcnt lgkmcnt(0)
    s_barrier
    s_waitcnt vmcnt(32)
    s_barrier
    v_add_u32 v44, 147456, v56
    ds_read_b64_tr_b16 a[36:37], v44
    ds_read_b64_tr_b16 a[38:39], v44 offset:2048
    v_add_u32 v44, 147456, v57
    ds_read_b64_tr_b16 a[108:109], v44
    ds_read_b64_tr_b16 a[110:111], v44 offset:2048
    v_add_u32 v44, 147456, v58
    ds_read_b64_tr_b16 a[180:181], v44
    ds_read_b64_tr_b16 a[182:183], v44 offset:2048
    v_add_u32 v44, 147456, v59
    ds_read_b64_tr_b16 a[252:253], v44
    ds_read_b64_tr_b16 a[254:255], v44 offset:2048
    s_waitcnt lgkmcnt(0)
    s_barrier
    s_waitcnt vmcnt(28)
    s_barrier
    v_add_u32 v44, 0, v56
    ds_read_b64_tr_b16 a[40:41], v44
    ds_read_b64_tr_b16 a[42:43], v44 offset:2048
    v_add_u32 v44, 0, v57
    ds_read_b64_tr_b16 a[112:113], v44
    ds_read_b64_tr_b16 a[114:115], v44 offset:2048
    v_add_u32 v44, 0, v58
    ds_read_b64_tr_b16 a[184:185], v44
    ds_read_b64_tr_b16 a[186:187], v44 offset:2048
    v_add_u32 v44, 0, v59
    ds_read_b64_tr_b16 v[128:129], v44
    ds_read_b64_tr_b16 v[130:131], v44 offset:2048
    s_waitcnt lgkmcnt(0)
    s_barrier
    s_waitcnt vmcnt(24)
    s_barrier
    v_add_u32 v44, 16384, v56
    ds_read_b64_tr_b16 a[44:45], v44
    ds_read_b64_tr_b16 a[46:47], v44 offset:2048
    v_add_u32 v44, 16384, v57
    ds_read_b64_tr_b16 a[116:117], v44
    ds_read_b64_tr_b16 a[118:119], v44 offset:2048
    v_add_u32 v44, 16384, v58
    ds_read_b64_tr_b16 a[188:189], v44
    ds_read_b64_tr_b16 a[190:191], v44 offset:2048
    v_add_u32 v44, 16384, v59
    ds_read_b64_tr_b16 v[132:133], v44
    ds_read_b64_tr_b16 v[134:135], v44 offset:2048
    s_waitcnt lgkmcnt(0)
    s_barrier
    s_waitcnt vmcnt(20)
    s_barrier
    v_add_u32 v44, 32768, v56
    ds_read_b64_tr_b16 a[48:49], v44
    ds_read_b64_tr_b16 a[50:51], v44 offset:2048
    v_add_u32 v44, 32768, v57
    ds_read_b64_tr_b16 a[120:121], v44
    ds_read_b64_tr_b16 a[122:123], v44 offset:2048
    v_add_u32 v44, 32768, v58
    ds_read_b64_tr_b16 a[192:193], v44
    ds_read_b64_tr_b16 a[194:195], v44 offset:2048
    v_add_u32 v44, 32768, v59
    ds_read_b64_tr_b16 v[136:137], v44
    ds_read_b64_tr_b16 v[138:139], v44 offset:2048
    s_waitcnt lgkmcnt(0)
    s_barrier
    s_waitcnt vmcnt(16)
    s_barrier
    v_add_u32 v44, 49152, v56
    ds_read_b64_tr_b16 a[52:53], v44
    ds_read_b64_tr_b16 a[54:55], v44 offset:2048
    v_add_u32 v44, 49152, v57
    ds_read_b64_tr_b16 a[124:125], v44
    ds_read_b64_tr_b16 a[126:127], v44 offset:2048
    v_add_u32 v44, 49152, v58
    ds_read_b64_tr_b16 a[196:197], v44
    ds_read_b64_tr_b16 a[198:199], v44 offset:2048
    v_add_u32 v44, 49152, v59
    ds_read_b64_tr_b16 v[140:141], v44
    ds_read_b64_tr_b16 v[142:143], v44 offset:2048
    s_waitcnt lgkmcnt(0)
    s_barrier
    s_waitcnt vmcnt(12)
    s_barrier
    v_add_u32 v44, 65536, v56
    ds_read_b64_tr_b16 a[56:57], v44
    ds_read_b64_tr_b16 a[58:59], v44 offset:2048
    v_add_u32 v44, 65536, v57
    ds_read_b64_tr_b16 a[128:129], v44
    ds_read_b64_tr_b16 a[130:131], v44 offset:2048
    v_add_u32 v44, 65536, v58
    ds_read_b64_tr_b16 a[200:201], v44
    ds_read_b64_tr_b16 a[202:203], v44 offset:2048
    v_add_u32 v44, 65536, v59
    ds_read_b64_tr_b16 v[144:145], v44
    ds_read_b64_tr_b16 v[146:147], v44 offset:2048
    s_waitcnt lgkmcnt(0)
    s_barrier
    s_waitcnt vmcnt(8)
    s_barrier
    v_add_u32 v44, 81920, v56
    ds_read_b64_tr_b16 a[60:61], v44
    ds_read_b64_tr_b16 a[62:63], v44 offset:2048
    v_add_u32 v44, 81920, v57
    ds_read_b64_tr_b16 a[132:133], v44
    ds_read_b64_tr_b16 a[134:135], v44 offset:2048
    v_add_u32 v44, 81920, v58
    ds_read_b64_tr_b16 a[204:205], v44
    ds_read_b64_tr_b16 a[206:207], v44 offset:2048
    v_add_u32 v44, 81920, v59
    ds_read_b64_tr_b16 v[148:149], v44
    ds_read_b64_tr_b16 v[150:151], v44 offset:2048
    s_waitcnt lgkmcnt(0)
    s_barrier
    s_waitcnt vmcnt(4)
    s_barrier
    v_add_u32 v44, 98304, v56
    ds_read_b64_tr_b16 a[64:65], v44
    ds_read_b64_tr_b16 a[66:67], v44 offset:2048
    v_add_u32 v44, 98304, v57
    ds_read_b64_tr_b16 a[136:137], v44
    ds_read_b64_tr_b16 a[138:139], v44 offset:2048
    v_add_u32 v44, 98304, v58
    ds_read_b64_tr_b16 a[208:209], v44
    ds_read_b64_tr_b16 a[210:211], v44 offset:2048
    v_add_u32 v44, 98304, v59
    ds_read_b64_tr_b16 v[152:153], v44
    ds_read_b64_tr_b16 v[154:155], v44 offset:2048
    s_waitcnt lgkmcnt(0)
    s_barrier
    s_waitcnt vmcnt(0)
    s_barrier
    v_add_u32 v44, 114688, v56
    ds_read_b64_tr_b16 a[68:69], v44
    ds_read_b64_tr_b16 a[70:71], v44 offset:2048
    v_add_u32 v44, 114688, v57
    ds_read_b64_tr_b16 a[140:141], v44
    ds_read_b64_tr_b16 a[142:143], v44 offset:2048
    v_add_u32 v44, 114688, v58
    ds_read_b64_tr_b16 a[212:213], v44
    ds_read_b64_tr_b16 a[214:215], v44 offset:2048
    v_add_u32 v44, 114688, v59
    ds_read_b64_tr_b16 v[156:157], v44
    ds_read_b64_tr_b16 v[158:159], v44 offset:2048
    s_waitcnt lgkmcnt(0)
    s_barrier
    v_lshrrev_b32 v40, 2, v33
    v_lshrrev_b32 v41, 4, v33
    v_lshrrev_b32 v43, 1, v41
    v_xor_b32 v42, v41, v43
    v_and_b32 v42, 1, v42
    v_lshl_or_b32 v42, v42, 1, v43
    v_and_b32 v43, 3, v33
    v_xor_b32 v42, v42, v43
    v_mul_u32_u24 v1, 1152, v40
    v_lshl_add_u32 v1, v42, 4, v1
    v_lshrrev_b32 v41, 2, v34
    v_lshrrev_b32 v43, 1, v41
    v_xor_b32 v42, v41, v43
    v_and_b32 v42, 1, v42
    v_lshl_or_b32 v42, v42, 1, v43
    v_xor_b32 v42, v42, v35
    v_lshlrev_b32 v2, 6, v34
    v_lshl_add_u32 v2, v42, 4, v2
    s_mov_b32 s30, 0
    v_mov_b32 v48, 52
iw_64:
    global_load_dword v49, v48, s[16:17] sc1
    s_waitcnt vmcnt(0)
    v_readfirstlane_b32 s28, v49
    s_nop 0
    s_cmp_lg_u32 s28, 0
    s_cbranch_scc1 id_65
    s_sleep 2
    s_add_u32 s30, s30, 1
    s_cmp_lt_u32 s30, 0x100000
    s_cbranch_scc1 iw_64
    s_mov_b32 s99, 1
id_65:
    s_cmp_eq_u32 s37, 1
    s_cbranch_scc1 isv_66
    s_mov_b32 s23, 0
    s_mov_b32 s34, 0
    s_mov_b32 s33, -1
    s_mul_i32 s28, s20, 36864
    s_lshr_b32 s29, s19, 1
    s_mul_i32 s29, s29, 18432
    s_add_u32 s28, s28, s29
    s_and_b32 s29, s19, 1
    s_mul_i32 s29, s29, 576
    s_add_u32 s28, s28, s29
    s_mul_i32 s29, s19, 9216
    s_add_u32 s29, s29, s34
    s_add_u32 m0, s29, 0
    s_add_u32 s30, s28, 0
    buffer_load_dwordx4 v1, s[8:11], s30 offen lds
    s_add_u32 m0, s29, 1024
    s_add_u32 s30, s28, 64
    buffer_load_dwordx4 v1, s[8:11], s30 offen lds
    s_add_u32 m0, s29, 2048
    s_add_u32 s30, s28, 128
    buffer_load_dwordx4 v1, s[8:11], s30 offen lds
    s_add_u32 m0, s29, 3072
    s_add_u32 s30, s28, 192
    buffer_load_dwordx4 v1, s[8:11], s30 offen lds
    s_add_u32 m0, s29, 4096
    s_add_u32 s30, s28, 256
    buffer_load_dwordx4 v1, s[8:11], s30 offen lds
    s_add_u32 m0, s29, 5120
    s_add_u32 s30, s28, 320
    buffer_load_dwordx4 v1, s[8:11], s30 offen lds
    s_add_u32 m0, s29, 6144
    s_add_u32 s30, s28, 384
    buffer_load_dwordx4 v1, s[8:11], s30 offen lds
    s_add_u32 m0, s29, 7168
    s_add_u32 s30, s28, 448
    buffer_load_dwordx4 v1, s[8:11], s30 offen lds
    s_add_u32 m0, s29, 8192
    s_add_u32 s30, s28, 512
    buffer_load_dwordx4 v1, s[8:11], s30 offen lds
    s_waitcnt vmcnt(0)
g_loop_68:
    s_waitcnt vmcnt(4)
    s_barrier
    s_cmp_lt_u32 s23, 5
    s_cbranch_scc1 nosig_69
    s_cmp_lg_u32 s19, 0
    s_cbranch_scc1 nosig_69
    s_lshl_b32 s28, s21, 1
    s_sub_u32 s28, s20, s28
    s_lshl_b32 s28, s28, 2
    s_add_u32 s28, s28, s27
    s_mov_b64 exec, 1
    v_mov_b32 v48, 1
    v_mov_b32 v49, 0
    buffer_atomic_add v48, v49, s[4:7], s28 offen
    s_mov_b64 exec, -1
nosig_69:
    s_add_u32 s31, s23, 1
    s_cmp_ge_u32 s31, s22
    s_cbranch_scc1 nopf_70
    s_add_u32 s32, s20, s21
    s_sub_u32 s31, 36864, s34
    s_add_u32 s31, s31, 0
    s_mul_i32 s28, s32, 36864
    s_lshr_b32 s29, s19, 1
    s_mul_i32 s29, s29, 18432
    s_add_u32 s28, s28, s29
    s_and_b32 s29, s19, 1
    s_mul_i32 s29, s29, 576
    s_add_u32 s28, s28, s29
    s_mul_i32 s29, s19, 9216
    s_add_u32 s29, s29, s31
    s_add_u32 m0, s29, 0
    s_add_u32 s30, s28, 0
    buffer_load_dwordx4 v1, s[8:11], s30 offen lds
    s_add_u32 m0, s29, 1024
    s_add_u32 s30, s28, 64
    buffer_load_dwordx4 v1, s[8:11], s30 offen lds
    s_add_u32 m0, s29, 2048
    s_add_u32 s30, s28, 128
    buffer_load_dwordx4 v1, s[8:11], s30 offen lds
    s_add_u32 m0, s29, 3072
    s_add_u32 s30, s28, 192
    buffer_load_dwordx4 v1, s[8:11], s30 offen lds
    s_add_u32 m0, s29, 4096
    s_add_u32 s30, s28, 256
    buffer_load_dwordx4 v1, s[8:11], s30 offen lds
    s_add_u32 m0, s29, 5120
    s_add_u32 s30, s28, 320
    buffer_load_dwordx4 v1, s[8:11], s30 offen lds
    s_add_u32 m0, s29, 6144
    s_add_u32 s30, s28, 384
    buffer_load_dwordx4 v1, s[8:11], s30 offen lds
    s_add_u32 m0, s29, 7168
    s_add_u32 s30, s28, 448
    buffer_load_dwordx4 v1, s[8:11], s30 offen lds
    s_add_u32 m0, s29, 8192
    s_add_u32 s30, s28, 512
    buffer_load_dwordx4 v1, s[8:11], s30 offen lds
nopf_70:
    v_add_u32 v3, s34, v2
    ds_read_b128 v[32:35], v3 offset:0
    ds_read_b128 v[36:39], v3 offset:18432
    ds_read_b128 v[40:43], v3 offset:1024
    ds_read_b128 v[44:47], v3 offset:19456
    s_waitcnt lgkmcnt(3)
    v_mfma_f32_16x16x32_bf16 v[64:67], a[0:3], v[32:35], 0
    s_waitcnt lgkmcnt(2)
    v_mfma_f32_16x16x32_bf16 v[68:71], a[0:3], v[36:39], 0
    v_mfma_f32_16x16x32_bf16 v[72:75], a[72:75], v[32:35], 0
    v_mfma_f32_16x16x32_bf16 v[76:79], a[72:75], v[36:39], 0
    v_mfma_f32_16x16x32_bf16 v[80:83], a[144:147], v[32:35], 0
    v_mfma_f32_16x16x32_bf16 v[84:87], a[144:147], v[36:39], 0
    v_mfma_f32_16x16x32_bf16 v[88:91], a[216:219], v[32:35], 0
    v_mfma_f32_16x16x32_bf16 v[92:95], a[216:219], v[36:39], 0
    ds_read_b128 v[32:35], v3 offset:2048
    ds_read_b128 v[36:39], v3 offset:20480
    s_waitcnt lgkmcnt(3)
    v_mfma_f32_16x16x32_bf16 v[64:67], a[4:7], v[40:43], v[64:67]
    s_waitcnt lgkmcnt(2)
    v_mfma_f32_16x16x32_bf16 v[68:71], a[4:7], v[44:47], v[68:71]
    v_mfma_f32_16x16x32_bf16 v[72:75], a[76:79], v[40:43], v[72:75]
    v_mfma_f32_16x16x32_bf16 v[76:79], a[76:79], v[44:47], v[76:79]
    v_mfma_f32_16x16x32_bf16 v[80:83], a[148:151], v[40:43], v[80:83]
    v_mfma_f32_16x16x32_bf16 v[84:87], a[148:151], v[44:47], v[84:87]
    v_mfma_f32_16x16x32_bf16 v[88:91], a[220:223], v[40:43], v[88:91]
    v_mfma_f32_16x16x32_bf16 v[92:95], a[220:223], v[44:47], v[92:95]
    ds_read_b128 v[40:43], v3 offset:3072
    ds_read_b128 v[44:47], v3 offset:21504
    s_waitcnt lgkmcnt(3)
    v_mfma_f32_16x16x32_bf16 v[64:67], a[8:11], v[32:35], v[64:67]
    s_waitcnt lgkmcnt(2)
    v_mfma_f32_16x16x32_bf16 v[68:71], a[8:11], v[36:39], v[68:71]
    v_mfma_f32_16x16x32_bf16 v[72:75], a[80:83], v[32:35], v[72:75]
    v_mfma_f32_16x16x32_bf16 v[76:79], a[80:83], v[36:39], v[76:79]
    v_mfma_f32_16x16x32_bf16 v[80:83], a[152:155], v[32:35], v[80:83]
    v_mfma_f32_16x16x32_bf16 v[84:87], a[152:155], v[36:39], v[84:87]
    v_mfma_f32_16x16x32_bf16 v[88:91], a[224:227], v[32:35], v[88:91]
    v_mfma_f32_16x16x32_bf16 v[92:95], a[224:227], v[36:39], v[92:95]
    ds_read_b128 v[32:35], v3 offset:4096
    ds_read_b128 v[36:39], v3 offset:22528
    s_waitcnt lgkmcnt(3)
    v_mfma_f32_16x16x32_bf16 v[64:67], a[12:15], v[40:43], v[64:67]
    s_waitcnt lgkmcnt(2)
    v_mfma_f32_16x16x32_bf16 v[68:71], a[12:15], v[44:47], v[68:71]
    v_mfma_f32_16x16x32_bf16 v[72:75], a[84:87], v[40:43], v[72:75]
    v_mfma_f32_16x16x32_bf16 v[76:79], a[84:87], v[44:47], v[76:79]
    v_mfma_f32_16x16x32_bf16 v[80:83], a[156:159], v[40:43], v[80:83]
    v_mfma_f32_16x16x32_bf16 v[84:87], a[156:159], v[44:47], v[84:87]
    v_mfma_f32_16x16x32_bf16 v[88:91], a[228:231], v[40:43], v[88:91]
    v_mfma_f32_16x16x32_bf16 v[92:95], a[228:231], v[44:47], v[92:95]
    ds_read_b128 v[40:43], v3 offset:5120
    ds_read_b128 v[44:47], v3 offset:23552
    s_waitcnt lgkmcnt(3)
    v_mfma_f32_16x16x32_bf16 v[64:67], a[16:19], v[32:35], v[64:67]
    s_waitcnt lgkmcnt(2)
    v_mfma_f32_16x16x32_bf16 v[68:71], a[16:19], v[36:39], v[68:71]
    v_mfma_f32_16x16x32_bf16 v[72:75], a[88:91], v[32:35], v[72:75]
    v_mfma_f32_16x16x32_bf16 v[76:79], a[88:91], v[36:39], v[76:79]
    v_mfma_f32_16x16x32_bf16 v[80:83], a[160:163], v[32:35], v[80:83]
    v_mfma_f32_16x16x32_bf16 v[84:87], a[160:163], v[36:39], v[84:87]
    v_mfma_f32_16x16x32_bf16 v[88:91], a[232:235], v[32:35], v[88:91]
    v_mfma_f32_16x16x32_bf16 v[92:95], a[232:235], v[36:39], v[92:95]
    ds_read_b128 v[32:35], v3 offset:6144
    ds_read_b128 v[36:39], v3 offset:24576
    s_waitcnt lgkmcnt(3)
    v_mfma_f32_16x16x32_bf16 v[64:67], a[20:23], v[40:43], v[64:67]
    s_waitcnt lgkmcnt(2)
    v_mfma_f32_16x16x32_bf16 v[68:71], a[20:23], v[44:47], v[68:71]
    v_mfma_f32_16x16x32_bf16 v[72:75], a[92:95], v[40:43], v[72:75]
    v_mfma_f32_16x16x32_bf16 v[76:79], a[92:95], v[44:47], v[76:79]
    v_mfma_f32_16x16x32_bf16 v[80:83], a[164:167], v[40:43], v[80:83]
    v_mfma_f32_16x16x32_bf16 v[84:87], a[164:167], v[44:47], v[84:87]
    v_mfma_f32_16x16x32_bf16 v[88:91], a[236:239], v[40:43], v[88:91]
    v_mfma_f32_16x16x32_bf16 v[92:95], a[236:239], v[44:47], v[92:95]
    ds_read_b128 v[40:43], v3 offset:7168
    ds_read_b128 v[44:47], v3 offset:25600
    s_waitcnt lgkmcnt(3)
    v_mfma_f32_16x16x32_bf16 v[64:67], a[24:27], v[32:35], v[64:67]
    s_waitcnt lgkmcnt(2)
    v_mfma_f32_16x16x32_bf16 v[68:71], a[24:27], v[36:39], v[68:71]
    v_mfma_f32_16x16x32_bf16 v[72:75], a[96:99], v[32:35], v[72:75]
    v_mfma_f32_16x16x32_bf16 v[76:79], a[96:99], v[36:39], v[76:79]
    v_mfma_f32_16x16x32_bf16 v[80:83], a[168:171], v[32:35], v[80:83]
    v_mfma_f32_16x16x32_bf16 v[84:87], a[168:171], v[36:39], v[84:87]
    v_mfma_f32_16x16x32_bf16 v[88:91], a[240:243], v[32:35], v[88:91]
    v_mfma_f32_16x16x32_bf16 v[92:95], a[240:243], v[36:39], v[92:95]
    ds_read_b128 v[32:35], v3 offset:8192
    ds_read_b128 v[36:39], v3 offset:26624
    s_waitcnt lgkmcnt(3)
    v_mfma_f32_16x16x32_bf16 v[64:67], a[28:31], v[40:43], v[64:67]
    s_waitcnt lgkmcnt(2)
    v_mfma_f32_16x16x32_bf16 v[68:71], a[28:31], v[44:47], v[68:71]
    v_mfma_f32_16x16x32_bf16 v[72:75], a[100:103], v[40:43], v[72:75]
    v_mfma_f32_16x16x32_bf16 v[76:79], a[100:103], v[44:47], v[76:79]
    v_mfma_f32_16x16x32_bf16 v[80:83], a[172:175], v[40:43], v[80:83]
    v_mfma_f32_16x16x32_bf16 v[84:87], a[172:175], v[44:47], v[84:87]
    v_mfma_f32_16x16x32_bf16 v[88:91], a[244:247], v[40:43], v[88:91]
    v_mfma_f32_16x16x32_bf16 v[92:95], a[244:247], v[44:47], v[92:95]
    ds_read_b128 v[40:43], v3 offset:9216
    ds_read_b128 v[44:47], v3 offset:27648
    s_waitcnt lgkmcnt(3)
    v_mfma_f32_16x16x32_bf16 v[64:67], a[32:35], v[32:35], v[64:67]
    s_waitcnt lgkmcnt(2)
    v_mfma_f32_16x16x32_bf16 v[68:71], a[32:35], v[36:39], v[68:71]
    v_mfma_f32_16x16x32_bf16 v[72:75], a[104:107], v[32:35], v[72:75]
    v_mfma_f32_16x16x32_bf16 v[76:79], a[104:107], v[36:39], v[76:79]
    v_mfma_f32_16x16x32_bf16 v[80:83], a[176:179], v[32:35], v[80:83]
    v_mfma_f32_16x16x32_bf16 v[84:87], a[176:179], v[36:39], v[84:87]
    v_mfma_f32_16x16x32_bf16 v[88:91], a[248:251], v[32:35], v[88:91]
    v_mfma_f32_16x16x32_bf16 v[92:95], a[248:251], v[36:39], v[92:95]
    ds_read_b128 v[32:35], v3 offset:10240
    ds_read_b128 v[36:39], v3 offset:28672
    s_waitcnt lgkmcnt(3)
    v_mfma_f32_16x16x32_bf16 v[64:67], a[36:39], v[40:43], v[64:67]
    s_waitcnt lgkmcnt(2)
    v_mfma_f32_16x16x32_bf16 v[68:71], a[36:39], v[44:47], v[68:71]
    v_mfma_f32_16x16x32_bf16 v[72:75], a[108:111], v[40:43], v[72:75]
    v_mfma_f32_16x16x32_bf16 v[76:79], a[108:111], v[44:47], v[76:79]
    v_mfma_f32_16x16x32_bf16 v[80:83], a[180:183], v[40:43], v[80:83]
    v_mfma_f32_16x16x32_bf16 v[84:87], a[180:183], v[44:47], v[84:87]
    v_mfma_f32_16x16x32_bf16 v[88:91], a[252:255], v[40:43], v[88:91]
    v_mfma_f32_16x16x32_bf16 v[92:95], a[252:255], v[44:47], v[92:95]
    ds_read_b128 v[40:43], v3 offset:11264
    ds_read_b128 v[44:47], v3 offset:29696
    s_waitcnt lgkmcnt(3)
    v_mfma_f32_16x16x32_bf16 v[64:67], a[40:43], v[32:35], v[64:67]
    s_waitcnt lgkmcnt(2)
    v_mfma_f32_16x16x32_bf16 v[68:71], a[40:43], v[36:39], v[68:71]
    v_mfma_f32_16x16x32_bf16 v[72:75], a[112:115], v[32:35], v[72:75]
    v_mfma_f32_16x16x32_bf16 v[76:79], a[112:115], v[36:39], v[76:79]
    v_mfma_f32_16x16x32_bf16 v[80:83], a[184:187], v[32:35], v[80:83]
    v_mfma_f32_16x16x32_bf16 v[84:87], a[184:187], v[36:39], v[84:87]
    v_mfma_f32_16x16x32_bf16 v[88:91], v[128:131], v[32:35], v[88:91]
    v_mfma_f32_16x16x32_bf16 v[92:95], v[128:131], v[36:39], v[92:95]
    ds_read_b128 v[32:35], v3 offset:12288
    ds_read_b128 v[36:39], v3 offset:30720
    s_waitcnt lgkmcnt(3)
    v_mfma_f32_16x16x32_bf16 v[64:67], a[44:47], v[40:43], v[64:67]
    s_waitcnt lgkmcnt(2)
    v_mfma_f32_16x16x32_bf16 v[68:71], a[44:47], v[44:47], v[68:71]
    v_mfma_f32_16x16x32_bf16 v[72:75], a[116:119], v[40:43], v[72:75]
    v_mfma_f32_16x16x32_bf16 v[76:79], a[116:119], v[44:47], v[76:79]
    v_mfma_f32_16x16x32_bf16 v[80:83], a[188:191], v[40:43], v[80:83]
    v_mfma_f32_16x16x32_bf16 v[84:87], a[188:191], v[44:47], v[84:87]
    v_mfma_f32_16x16x32_bf16 v[88:91], v[132:135], v[40:43], v[88:91]
    v_mfma_f32_16x16x32_bf16 v[92:95], v[132:135], v[44:47], v[92:95]
    ds_read_b128 v[40:43], v3 offset:13312
    ds_read_b128 v[44:47], v3 offset:31744
    s_waitcnt lgkmcnt(3)
    v_mfma_f32_16x16x32_bf16 v[64:67], a[48:51], v[32:35], v[64:67]
    s_waitcnt lgkmcnt(2)
    v_mfma_f32_16x16x32_bf16 v[68:71], a[48:51], v[36:39], v[68:71]
    v_mfma_f32_16x16x32_bf16 v[72:75], a[120:123], v[32:35], v[72:75]
    v_mfma_f32_16x16x32_bf16 v[76:79], a[120:123], v[36:39], v[76:79]
    v_mfma_f32_16x16x32_bf16 v[80:83], a[192:195], v[32:35], v[80:83]
    v_mfma_f32_16x16x32_bf16 v[84:87], a[192:195], v[36:39], v[84:87]
    v_mfma_f32_16x16x32_bf16 v[88:91], v[136:139], v[32:35], v[88:91]
    v_mfma_f32_16x16x32_bf16 v[92:95], v[136:139], v[36:39], v[92:95]
    ds_read_b128 v[32:35], v3 offset:14336
    ds_read_b128 v[36:39], v3 offset:32768
    s_waitcnt lgkmcnt(3)
    v_mfma_f32_16x16x32_bf16 v[64:67], a[52:55], v[40:43], v[64:67]
    s_waitcnt lgkmcnt(2)
    v_mfma_f32_16x16x32_bf16 v[68:71], a[52:55], v[44:47], v[68:71]
    v_mfma_f32_16x16x32_bf16 v[72:75], a[124:127], v[40:43], v[72:75]
    v_mfma_f32_16x16x32_bf16 v[76:79], a[124:127], v[44:47], v[76:79]
    v_mfma_f32_16x16x32_bf16 v[80:83], a[196:199], v[40:43], v[80:83]
    v_mfma_f32_16x16x32_bf16 v[84:87], a[196:199], v[44:47], v[84:87]
    v_mfma_f32_16x16x32_bf16 v[88:91], v[140:143], v[40:43], v[88:91]
    v_mfma_f32_16x16x32_bf16 v[92:95], v[140:143], v[44:47], v[92:95]
    ds_read_b128 v[40:43], v3 offset:15360
    ds_read_b128 v[44:47], v3 offset:33792
    s_waitcnt lgkmcnt(3)
    v_mfma_f32_16x16x32_bf16 v[64:67], a[56:59], v[32:35], v[64:67]
    s_waitcnt lgkmcnt(2)
    v_mfma_f32_16x16x32_bf16 v[68:71], a[56:59], v[36:39], v[68:71]
    v_mfma_f32_16x16x32_bf16 v[72:75], a[128:131], v[32:35], v[72:75]
    v_mfma_f32_16x16x32_bf16 v[76:79], a[128:131], v[36:39], v[76:79]
    v_mfma_f32_16x16x32_bf16 v[80:83], a[200:203], v[32:35], v[80:83]
    v_mfma_f32_16x16x32_bf16 v[84:87], a[200:203], v[36:39], v[84:87]
    v_mfma_f32_16x16x32_bf16 v[88:91], v[144:147], v[32:35], v[88:91]
    v_mfma_f32_16x16x32_bf16 v[92:95], v[144:147], v[36:39], v[92:95]
    ds_read_b128 v[32:35], v3 offset:16384
    ds_read_b128 v[36:39], v3 offset:34816
    s_waitcnt lgkmcnt(3)
    v_mfma_f32_16x16x32_bf16 v[64:67], a[60:63], v[40:43], v[64:67]
    s_waitcnt lgkmcnt(2)
    v_mfma_f32_16x16x32_bf16 v[68:71], a[60:63], v[44:47], v[68:71]
    v_mfma_f32_16x16x32_bf16 v[72:75], a[132:135], v[40:43], v[72:75]
    v_mfma_f32_16x16x32_bf16 v[76:79], a[132:135], v[44:47], v[76:79]
    v_mfma_f32_16x16x32_bf16 v[80:83], a[204:207], v[40:43], v[80:83]
    v_mfma_f32_16x16x32_bf16 v[84:87], a[204:207], v[44:47], v[84:87]
    v_mfma_f32_16x16x32_bf16 v[88:91], v[148:151], v[40:43], v[88:91]
    v_mfma_f32_16x16x32_bf16 v[92:95], v[148:151], v[44:47], v[92:95]
    ds_read_b128 v[40:43], v3 offset:17408
    ds_read_b128 v[44:47], v3 offset:35840
    s_waitcnt lgkmcnt(3)
    v_mfma_f32_16x16x32_bf16 v[64:67], a[64:67], v[32:35], v[64:67]
    s_waitcnt lgkmcnt(2)
    v_mfma_f32_16x16x32_bf16 v[68:71], a[64:67], v[36:39], v[68:71]
    v_mfma_f32_16x16x32_bf16 v[72:75], a[136:139], v[32:35], v[72:75]
    v_mfma_f32_16x16x32_bf16 v[76:79], a[136:139], v[36:39], v[76:79]
    v_mfma_f32_16x16x32_bf16 v[80:83], a[208:211], v[32:35], v[80:83]
    v_mfma_f32_16x16x32_bf16 v[84:87], a[208:211], v[36:39], v[84:87]
    v_mfma_f32_16x16x32_bf16 v[88:91], v[152:155], v[32:35], v[88:91]
    v_mfma_f32_16x16x32_bf16 v[92:95], v[152:155], v[36:39], v[92:95]
    s_waitcnt lgkmcnt(1)
    v_mfma_f32_16x16x32_bf16 v[64:67], a[68:71], v[40:43], v[64:67]
    s_waitcnt lgkmcnt(0)
    v_mfma_f32_16x16x32_bf16 v[68:71], a[68:71], v[44:47], v[68:71]
    v_mfma_f32_16x16x32_bf16 v[72:75], a[140:143], v[40:43], v[72:75]
    v_mfma_f32_16x16x32_bf16 v[76:79], a[140:143], v[44:47], v[76:79]
    v_mfma_f32_16x16x32_bf16 v[80:83], a[212:215], v[40:43], v[80:83]
    v_mfma_f32_16x16x32_bf16 v[84:87], a[212:215], v[44:47], v[84:87]
    v_mfma_f32_16x16x32_bf16 v[88:91], v[156:159], v[40:43], v[88:91]
    v_mfma_f32_16x16x32_bf16 v[92:95], v[156:159], v[44:47], v[92:95]
    s_mul_i32 s28, s20, 262144
    s_add_u32 s28, s28, s26
    v_cvt_pk_bf16_f32 v48, v64, v65
    v_cvt_pk_bf16_f32 v49, v66, v67
    v_cvt_pk_bf16_f32 v50, v72, v73
    v_cvt_pk_bf16_f32 v51, v74, v75
    buffer_store_dwordx4 v[48:51], v0, s[4:7], s28 offen offset:0 sc1
    v_cvt_pk_bf16_f32 v52, v68, v69
    v_cvt_pk_bf16_f32 v53, v70, v71
    v_cvt_pk_bf16_f32 v54, v76, v77
    v_cvt_pk_bf16_f32 v55, v78, v79
    buffer_store_dwordx4 v[52:55], v0, s[4:7], s28 offen offset:1024 sc1
    v_cvt_pk_bf16_f32 v48, v80, v81
    v_cvt_pk_bf16_f32 v49, v82, v83
    v_cvt_pk_bf16_f32 v50, v88, v89
    v_cvt_pk_bf16_f32 v51, v90, v91
    buffer_store_dwordx4 v[48:51], v0, s[4:7], s28 offen offset:2048 sc1
    v_cvt_pk_bf16_f32 v52, v84, v85
    v_cvt_pk_bf16_f32 v53, v86, v87
    v_cvt_pk_bf16_f32 v54, v92, v93
    v_cvt_pk_bf16_f32 v55, v94, v95
    buffer_store_dwordx4 v[52:55], v0, s[4:7], s28 offen offset:3072 sc1
    s_cmp_ge_u32 s23, 3
    s_cbranch_scc1 nofirst_71
    s_waitcnt vmcnt(0)
    s_barrier
    s_cmp_lg_u32 s19, 0
    s_cbranch_scc1 nofirst_71
    s_lshl_b32 s28, s20, 2
    s_add_u32 s28, s28, s27
    s_mov_b64 exec, 1
    v_mov_b32 v48, 1
    v_mov_b32 v49, 0
    buffer_atomic_add v48, v49, s[4:7], s28 offen
    s_mov_b64 exec, -1
nofirst_71:
    s_add_u32 s20, s20, s21
    s_sub_u32 s28, 36864, s34
    s_add_u32 s34, s28, 0
    s_add_u32 s23, s23, 1
    s_cmp_lt_u32 s23, s22
    s_cbranch_scc1 g_loop_68
    s_waitcnt vmcnt(0)
    s_barrier
    s_cmp_lg_u32 s19, 0
    s_cbranch_scc1 nosig_72
    s_mov_b64 exec, 1
    v_mov_b32 v48, 1
    v_mov_b32 v49, 0
    s_mul_i32 s28, s21, 1
    s_sub_u32 s28, s20, s28
    s_lshl_b32 s28, s28, 2
    s_add_u32 s28, s28, s27
    buffer_atomic_add v48, v49, s[4:7], s28 offen
    s_mul_i32 s28, s21, 2
    s_sub_u32 s28, s20, s28
    s_lshl_b32 s28, s28, 2
    s_add_u32 s28, s28, s27
    buffer_atomic_add v48, v49, s[4:7], s28 offen
    s_mov_b64 exec, -1
nosig_72:
    s_branch g1done_67
isv_66:
    s_mov_b32 s23, 0
    s_mov_b32 s34, 0
    s_mov_b32 s33, -1
    s_mul_i32 s28, s20, 36864
    s_lshr_b32 s29, s19, 1
    s_mul_i32 s29, s29, 18432
    s_add_u32 s28, s28, s29
    s_and_b32 s29, s19, 1
    s_mul_i32 s29, s29, 576
    s_add_u32 s28, s28, s29
    s_mul_i32 s29, s19, 9216
    s_add_u32 s29, s29, s34
    s_add_u32 m0, s29, 0
    s_add_u32 s30, s28, 0
    buffer_load_dwordx4 v1, s[8:11], s30 offen lds
    s_add_u32 m0, s29, 1024
    s_add_u32 s30, s28, 64
    buffer_load_dwordx4 v1, s[8:11], s30 offen lds
    s_add_u32 m0, s29, 2048
    s_add_u32 s30, s28, 128
    buffer_load_dwordx4 v1, s[8:11], s30 offen lds
    s_add_u32 m0, s29, 3072
    s_add_u32 s30, s28, 192
    buffer_load_dwordx4 v1, s[8:11], s30 offen lds
    s_add_u32 m0, s29, 4096
    s_add_u32 s30, s28, 256
    buffer_load_dwordx4 v1, s[8:11], s30 offen lds
    s_add_u32 m0, s29, 5120
    s_add_u32 s30, s28, 320
    buffer_load_dwordx4 v1, s[8:11], s30 offen lds
    s_add_u32 m0, s29, 6144
    s_add_u32 s30, s28, 384
    buffer_load_dwordx4 v1, s[8:11], s30 offen lds
    s_add_u32 m0, s29, 7168
    s_add_u32 s30, s28, 448
    buffer_load_dwordx4 v1, s[8:11], s30 offen lds
    s_add_u32 m0, s29, 8192
    s_add_u32 s30, s28, 512
    buffer_load_dwordx4 v1, s[8:11], s30 offen lds
    s_waitcnt vmcnt(0)
g_loop_73:
    s_waitcnt vmcnt(4)
    s_barrier
    s_cmp_lt_u32 s23, 5
    s_cbranch_scc1 nosig_74
    s_cmp_lg_u32 s19, 0
    s_cbranch_scc1 nosig_74
    s_lshl_b32 s28, s21, 1
    s_sub_u32 s28, s20, s28
    s_lshl_b32 s28, s28, 2
    s_add_u32 s28, s28, s27
    s_mov_b64 exec, 1
    v_mov_b32 v48, 1
    v_mov_b32 v49, 0
    buffer_atomic_add v48, v49, s[4:7], s28 offen
    s_mov_b64 exec, -1
nosig_74:
    s_add_u32 s31, s23, 1
    s_cmp_ge_u32 s31, s22
    s_cbranch_scc1 nopf_75
    s_add_u32 s32, s20, s21
    s_sub_u32 s31, 36864, s34
    s_add_u32 s31, s31, 0
    s_mul_i32 s28, s32, 36864
    s_lshr_b32 s29, s19, 1
    s_mul_i32 s29, s29, 18432
    s_add_u32 s28, s28, s29
    s_and_b32 s29, s19, 1
    s_mul_i32 s29, s29, 576
    s_add_u32 s28, s28, s29
    s_mul_i32 s29, s19, 9216
    s_add_u32 s29, s29, s31
    s_add_u32 m0, s29, 0
    s_add_u32 s30, s28, 0
    buffer_load_dwordx4 v1, s[8:11], s30 offen lds
    s_add_u32 m0, s29, 1024
    s_add_u32 s30, s28, 64
    buffer_load_dwordx4 v1, s[8:11], s30 offen lds
    s_add_u32 m0, s29, 2048
    s_add_u32 s30, s28, 128
    buffer_load_dwordx4 v1, s[8:11], s30 offen lds
    s_add_u32 m0, s29, 3072
    s_add_u32 s30, s28, 192
    buffer_load_dwordx4 v1, s[8:11], s30 offen lds
    s_add_u32 m0, s29, 4096
    s_add_u32 s30, s28, 256
    buffer_load_dwordx4 v1, s[8:11], s30 offen lds
    s_add_u32 m0, s29, 5120
    s_add_u32 s30, s28, 320
    buffer_load_dwordx4 v1, s[8:11], s30 offen lds
    s_add_u32 m0, s29, 6144
    s_add_u32 s30, s28, 384
    buffer_load_dwordx4 v1, s[8:11], s30 offen lds
    s_add_u32 m0, s29, 7168
    s_add_u32 s30, s28, 448
    buffer_load_dwordx4 v1, s[8:11], s30 offen lds
    s_add_u32 m0, s29, 8192
    s_add_u32 s30, s28, 512
    buffer_load_dwordx4 v1, s[8:11], s30 offen lds
nopf_75:
    v_add_u32 v3, s34, v2
    ds_read_b128 v[32:35], v3 offset:0
    ds_read_b128 v[36:39], v3 offset:18432
    ds_read_b128 v[40:43], v3 offset:1024
    ds_read_b128 v[44:47], v3 offset:19456
    s_waitcnt lgkmcnt(3)
    v_mfma_f32_16x16x32_bf16 v[64:67], v[32:35], a[0:3], 0
    s_waitcnt lgkmcnt(2)
    v_mfma_f32_16x16x32_bf16 v[68:71], v[36:39], a[0:3], 0
    v_mfma_f32_16x16x32_bf16 v[72:75], v[32:35], a[72:75], 0
    v_mfma_f32_16x16x32_bf16 v[76:79], v[36:39], a[72:75], 0
    v_mfma_f32_16x16x32_bf16 v[80:83], v[32:35], a[144:147], 0
    v_mfma_f32_16x16x32_bf16 v[84:87], v[36:39], a[144:147], 0
    v_mfma_f32_16x16x32_bf16 v[88:91], v[32:35], a[216:219], 0
    v_mfma_f32_16x16x32_bf16 v[92:95], v[36:39], a[216:219], 0
    ds_read_b128 v[32:35], v3 offset:2048
    ds_read_b128 v[36:39], v3 offset:20480
    s_waitcnt lgkmcnt(3)
    v_mfma_f32_16x16x32_bf16 v[64:67], v[40:43], a[4:7], v[64:67]
    s_waitcnt lgkmcnt(2)
    v_mfma_f32_16x16x32_bf16 v[68:71], v[44:47], a[4:7], v[68:71]
    v_mfma_f32_16x16x32_bf16 v[72:75], v[40:43], a[76:79], v[72:75]
    v_mfma_f32_16x16x32_bf16 v[76:79], v[44:47], a[76:79], v[76:79]
    v_mfma_f32_16x16x32_bf16 v[80:83], v[40:43], a[148:151], v[80:83]
    v_mfma_f32_16x16x32_bf16 v[84:87], v[44:47], a[148:151], v[84:87]
    v_mfma_f32_16x16x32_bf16 v[88:91], v[40:43], a[220:223], v[88:91]
    v_mfma_f32_16x16x32_bf16 v[92:95], v[44:47], a[220:223], v[92:95]
    ds_read_b128 v[40:43], v3 offset:3072
    ds_read_b128 v[44:47], v3 offset:21504
    s_waitcnt lgkmcnt(3)
    v_mfma_f32_16x16x32_bf16 v[64:67], v[32:35], a[8:11], v[64:67]
    s_waitcnt lgkmcnt(2)
    v_mfma_f32_16x16x32_bf16 v[68:71], v[36:39], a[8:11], v[68:71]
    v_mfma_f32_16x16x32_bf16 v[72:75], v[32:35], a[80:83], v[72:75]
    v_mfma_f32_16x16x32_bf16 v[76:79], v[36:39], a[80:83], v[76:79]
    v_mfma_f32_16x16x32_bf16 v[80:83], v[32:35], a[152:155], v[80:83]
    v_mfma_f32_16x16x32_bf16 v[84:87], v[36:39], a[152:155], v[84:87]
    v_mfma_f32_16x16x32_bf16 v[88:91], v[32:35], a[224:227], v[88:91]
    v_mfma_f32_16x16x32_bf16 v[92:95], v[36:39], a[224:227], v[92:95]
    ds_read_b128 v[32:35], v3 offset:4096
    ds_read_b128 v[36:39], v3 offset:22528
    s_waitcnt lgkmcnt(3)
    v_mfma_f32_16x16x32_bf16 v[64:67], v[40:43], a[12:15], v[64:67]
    s_waitcnt lgkmcnt(2)
    v_mfma_f32_16x16x32_bf16 v[68:71], v[44:47], a[12:15], v[68:71]
    v_mfma_f32_16x16x32_bf16 v[72:75], v[40:43], a[84:87], v[72:75]
    v_mfma_f32_16x16x32_bf16 v[76:79], v[44:47], a[84:87], v[76:79]
    v_mfma_f32_16x16x32_bf16 v[80:83], v[40:43], a[156:159], v[80:83]
    v_mfma_f32_16x16x32_bf16 v[84:87], v[44:47], a[156:159], v[84:87]
    v_mfma_f32_16x16x32_bf16 v[88:91], v[40:43], a[228:231], v[88:91]
    v_mfma_f32_16x16x32_bf16 v[92:95], v[44:47], a[228:231], v[92:95]
    ds_read_b128 v[40:43], v3 offset:5120
    ds_read_b128 v[44:47], v3 offset:23552
    s_waitcnt lgkmcnt(3)
    v_mfma_f32_16x16x32_bf16 v[64:67], v[32:35], a[16:19], v[64:67]
    s_waitcnt lgkmcnt(2)
    v_mfma_f32_16x16x32_bf16 v[68:71], v[36:39], a[16:19], v[68:71]
    v_mfma_f32_16x16x32_bf16 v[72:75], v[32:35], a[88:91], v[72:75]
    v_mfma_f32_16x16x32_bf16 v[76:79], v[36:39], a[88:91], v[76:79]
    v_mfma_f32_16x16x32_bf16 v[80:83], v[32:35], a[160:163], v[80:83]
    v_mfma_f32_16x16x32_bf16 v[84:87], v[36:39], a[160:163], v[84:87]
    v_mfma_f32_16x16x32_bf16 v[88:91], v[32:35], a[232:235], v[88:91]
    v_mfma_f32_16x16x32_bf16 v[92:95], v[36:39], a[232:235], v[92:95]
    ds_read_b128 v[32:35], v3 offset:6144
    ds_read_b128 v[36:39], v3 offset:24576
    s_waitcnt lgkmcnt(3)
    v_mfma_f32_16x16x32_bf16 v[64:67], v[40:43], a[20:23], v[64:67]
    s_waitcnt lgkmcnt(2)
    v_mfma_f32_16x16x32_bf16 v[68:71], v[44:47], a[20:23], v[68:71]
    v_mfma_f32_16x16x32_bf16 v[72:75], v[40:43], a[92:95], v[72:75]
    v_mfma_f32_16x16x32_bf16 v[76:79], v[44:47], a[92:95], v[76:79]
    v_mfma_f32_16x16x32_bf16 v[80:83], v[40:43], a[164:167], v[80:83]
    v_mfma_f32_16x16x32_bf16 v[84:87], v[44:47], a[164:167], v[84:87]
    v_mfma_f32_16x16x32_bf16 v[88:91], v[40:43], a[236:239], v[88:91]
    v_mfma_f32_16x16x32_bf16 v[92:95], v[44:47], a[236:239], v[92:95]
    ds_read_b128 v[40:43], v3 offset:7168
    ds_read_b128 v[44:47], v3 offset:25600
    s_waitcnt lgkmcnt(3)
    v_mfma_f32_16x16x32_bf16 v[64:67], v[32:35], a[24:27], v[64:67]
    s_waitcnt lgkmcnt(2)
    v_mfma_f32_16x16x32_bf16 v[68:71], v[36:39], a[24:27], v[68:71]
    v_mfma_f32_16x16x32_bf16 v[72:75], v[32:35], a[96:99], v[72:75]
    v_mfma_f32_16x16x32_bf16 v[76:79], v[36:39], a[96:99], v[76:79]
    v_mfma_f32_16x16x32_bf16 v[80:83], v[32:35], a[168:171], v[80:83]
    v_mfma_f32_16x16x32_bf16 v[84:87], v[36:39], a[168:171], v[84:87]
    v_mfma_f32_16x16x32_bf16 v[88:91], v[32:35], a[240:243], v[88:91]
    v_mfma_f32_16x16x32_bf16 v[92:95], v[36:39], a[240:243], v[92:95]
    ds_read_b128 v[32:35], v3 offset:8192
    ds_read_b128 v[36:39], v3 offset:26624
    s_waitcnt lgkmcnt(3)
    v_mfma_f32_16x16x32_bf16 v[64:67], v[40:43], a[28:31], v[64:67]
    s_waitcnt lgkmcnt(2)
    v_mfma_f32_16x16x32_bf16 v[68:71], v[44:47], a[28:31], v[68:71]
    v_mfma_f32_16x16x32_bf16 v[72:75], v[40:43], a[100:103], v[72:75]
    v_mfma_f32_16x16x32_bf16 v[76:79], v[44:47], a[100:103], v[76:79]
    v_mfma_f32_16x16x32_bf16 v[80:83], v[40:43], a[172:175], v[80:83]
    v_mfma_f32_16x16x32_bf16 v[84:87], v[44:47], a[172:175], v[84:87]
    v_mfma_f32_16x16x32_bf16 v[88:91], v[40:43], a[244:247], v[88:91]
    v_mfma_f32_16x16x32_bf16 v[92:95], v[44:47], a[244:247], v[92:95]
    ds_read_b128 v[40:43], v3 offset:9216
    ds_read_b128 v[44:47], v3 offset:27648
    s_waitcnt lgkmcnt(3)
    v_mfma_f32_16x16x32_bf16 v[64:67], v[32:35], a[32:35], v[64:67]
    s_waitcnt lgkmcnt(2)
    v_mfma_f32_16x16x32_bf16 v[68:71], v[36:39], a[32:35], v[68:71]
    v_mfma_f32_16x16x32_bf16 v[72:75], v[32:35], a[104:107], v[72:75]
    v_mfma_f32_16x16x32_bf16 v[76:79], v[36:39], a[104:107], v[76:79]
    v_mfma_f32_16x16x32_bf16 v[80:83], v[32:35], a[176:179], v[80:83]
    v_mfma_f32_16x16x32_bf16 v[84:87], v[36:39], a[176:179], v[84:87]
    v_mfma_f32_16x16x32_bf16 v[88:91], v[32:35], a[248:251], v[88:91]
    v_mfma_f32_16x16x32_bf16 v[92:95], v[36:39], a[248:251], v[92:95]
    ds_read_b128 v[32:35], v3 offset:10240
    ds_read_b128 v[36:39], v3 offset:28672
    s_waitcnt lgkmcnt(3)
    v_mfma_f32_16x16x32_bf16 v[64:67], v[40:43], a[36:39], v[64:67]
    s_waitcnt lgkmcnt(2)
    v_mfma_f32_16x16x32_bf16 v[68:71], v[44:47], a[36:39], v[68:71]
    v_mfma_f32_16x16x32_bf16 v[72:75], v[40:43], a[108:111], v[72:75]
    v_mfma_f32_16x16x32_bf16 v[76:79], v[44:47], a[108:111], v[76:79]
    v_mfma_f32_16x16x32_bf16 v[80:83], v[40:43], a[180:183], v[80:83]
    v_mfma_f32_16x16x32_bf16 v[84:87], v[44:47], a[180:183], v[84:87]
    v_mfma_f32_16x16x32_bf16 v[88:91], v[40:43], a[252:255], v[88:91]
    v_mfma_f32_16x16x32_bf16 v[92:95], v[44:47], a[252:255], v[92:95]
    ds_read_b128 v[40:43], v3 offset:11264
    ds_read_b128 v[44:47], v3 offset:29696
    s_waitcnt lgkmcnt(3)
    v_mfma_f32_16x16x32_bf16 v[64:67], v[32:35], a[40:43], v[64:67]
    s_waitcnt lgkmcnt(2)
    v_mfma_f32_16x16x32_bf16 v[68:71], v[36:39], a[40:43], v[68:71]
    v_mfma_f32_16x16x32_bf16 v[72:75], v[32:35], a[112:115], v[72:75]
    v_mfma_f32_16x16x32_bf16 v[76:79], v[36:39], a[112:115], v[76:79]
    v_mfma_f32_16x16x32_bf16 v[80:83], v[32:35], a[184:187], v[80:83]
    v_mfma_f32_16x16x32_bf16 v[84:87], v[36:39], a[184:187], v[84:87]
    v_mfma_f32_16x16x32_bf16 v[88:91], v[32:35], v[128:131], v[88:91]
    v_mfma_f32_16x16x32_bf16 v[92:95], v[36:39], v[128:131], v[92:95]
    ds_read_b128 v[32:35], v3 offset:12288
    ds_read_b128 v[36:39], v3 offset:30720
    s_waitcnt lgkmcnt(3)
    v_mfma_f32_16x16x32_bf16 v[64:67], v[40:43], a[44:47], v[64:67]
    s_waitcnt lgkmcnt(2)
    v_mfma_f32_16x16x32_bf16 v[68:71], v[44:47], a[44:47], v[68:71]
    v_mfma_f32_16x16x32_bf16 v[72:75], v[40:43], a[116:119], v[72:75]
    v_mfma_f32_16x16x32_bf16 v[76:79], v[44:47], a[116:119], v[76:79]
    v_mfma_f32_16x16x32_bf16 v[80:83], v[40:43], a[188:191], v[80:83]
    v_mfma_f32_16x16x32_bf16 v[84:87], v[44:47], a[188:191], v[84:87]
    v_mfma_f32_16x16x32_bf16 v[88:91], v[40:43], v[132:135], v[88:91]
    v_mfma_f32_16x16x32_bf16 v[92:95], v[44:47], v[132:135], v[92:95]
    ds_read_b128 v[40:43], v3 offset:13312
    ds_read_b128 v[44:47], v3 offset:31744
    s_waitcnt lgkmcnt(3)
    v_mfma_f32_16x16x32_bf16 v[64:67], v[32:35], a[48:51], v[64:67]
    s_waitcnt lgkmcnt(2)
    v_mfma_f32_16x16x32_bf16 v[68:71], v[36:39], a[48:51], v[68:71]
    v_mfma_f32_16x16x32_bf16 v[72:75], v[32:35], a[120:123], v[72:75]
    v_mfma_f32_16x16x32_bf16 v[76:79], v[36:39], a[120:123], v[76:79]
    v_mfma_f32_16x16x32_bf16 v[80:83], v[32:35], a[192:195], v[80:83]
    v_mfma_f32_16x16x32_bf16 v[84:87], v[36:39], a[192:195], v[84:87]
    v_mfma_f32_16x16x32_bf16 v[88:91], v[32:35], v[136:139], v[88:91]
    v_mfma_f32_16x16x32_bf16 v[92:95], v[36:39], v[136:139], v[92:95]
    ds_read_b128 v[32:35], v3 offset:14336
    ds_read_b128 v[36:39], v3 offset:32768
    s_waitcnt lgkmcnt(3)
    v_mfma_f32_16x16x32_bf16 v[64:67], v[40:43], a[52:55], v[64:67]
    s_waitcnt lgkmcnt(2)
    v_mfma_f32_16x16x32_bf16 v[68:71], v[44:47], a[52:55], v[68:71]
    v_mfma_f32_16x16x32_bf16 v[72:75], v[40:43], a[124:127], v[72:75]
    v_mfma_f32_16x16x32_bf16 v[76:79], v[44:47], a[124:127], v[76:79]
    v_mfma_f32_16x16x32_bf16 v[80:83], v[40:43], a[196:199], v[80:83]
    v_mfma_f32_16x16x32_bf16 v[84:87], v[44:47], a[196:199], v[84:87]
    v_mfma_f32_16x16x32_bf16 v[88:91], v[40:43], v[140:143], v[88:91]
    v_mfma_f32_16x16x32_bf16 v[92:95], v[44:47], v[140:143], v[92:95]
    ds_read_b128 v[40:43], v3 offset:15360
    ds_read_b128 v[44:47], v3 offset:33792
    s_waitcnt lgkmcnt(3)
    v_mfma_f32_16x16x32_bf16 v[64:67], v[32:35], a[56:59], v[64:67]
    s_waitcnt lgkmcnt(2)
    v_mfma_f32_16x16x32_bf16 v[68:71], v[36:39], a[56:59], v[68:71]
    v_mfma_f32_16x16x32_bf16 v[72:75], v[32:35], a[128:131], v[72:75]
    v_mfma_f32_16x16x32_bf16 v[76:79], v[36:39], a[128:131], v[76:79]
    v_mfma_f32_16x16x32_bf16 v[80:83], v[32:35], a[200:203], v[80:83]
    v_mfma_f32_16x16x32_bf16 v[84:87], v[36:39], a[200:203], v[84:87]
    v_mfma_f32_16x16x32_bf16 v[88:91], v[32:35], v[144:147], v[88:91]
    v_mfma_f32_16x16x32_bf16 v[92:95], v[36:39], v[144:147], v[92:95]
    ds_read_b128 v[32:35], v3 offset:16384
    ds_read_b128 v[36:39], v3 offset:34816
    s_waitcnt lgkmcnt(3)
    v_mfma_f32_16x16x32_bf16 v[64:67], v[40:43], a[60:63], v[64:67]
    s_waitcnt lgkmcnt(2)
    v_mfma_f32_16x16x32_bf16 v[68:71], v[44:47], a[60:63], v[68:71]
    v_mfma_f32_16x16x32_bf16 v[72:75], v[40:43], a[132:135], v[72:75]
    v_mfma_f32_16x16x32_bf16 v[76:79], v[44:47], a[132:135], v[76:79]
    v_mfma_f32_16x16x32_bf16 v[80:83], v[40:43], a[204:207], v[80:83]
    v_mfma_f32_16x16x32_bf16 v[84:87], v[44:47], a[204:207], v[84:87]
    v_mfma_f32_16x16x32_bf16 v[88:91], v[40:43], v[148:151], v[88:91]
    v_mfma_f32_16x16x32_bf16 v[92:95], v[44:47], v[148:151], v[92:95]
    ds_read_b128 v[40:43], v3 offset:17408
    ds_read_b128 v[44:47], v3 offset:35840
    s_waitcnt lgkmcnt(3)
    v_mfma_f32_16x16x32_bf16 v[64:67], v[32:35], a[64:67], v[64:67]
    s_waitcnt lgkmcnt(2)
    v_mfma_f32_16x16x32_bf16 v[68:71], v[36:39], a[64:67], v[68:71]
    v_mfma_f32_16x16x32_bf16 v[72:75], v[32:35], a[136:139], v[72:75]
    v_mfma_f32_16x16x32_bf16 v[76:79], v[36:39], a[136:139], v[76:79]
    v_mfma_f32_16x16x32_bf16 v[80:83], v[32:35], a[208:211], v[80:83]
    v_mfma_f32_16x16x32_bf16 v[84:87], v[36:39], a[208:211], v[84:87]
    v_mfma_f32_16x16x32_bf16 v[88:91], v[32:35], v[152:155], v[88:91]
    v_mfma_f32_16x16x32_bf16 v[92:95], v[36:39], v[152:155], v[92:95]
    s_waitcnt lgkmcnt(1)
    v_mfma_f32_16x16x32_bf16 v[64:67], v[40:43], a[68:71], v[64:67]
    s_waitcnt lgkmcnt(0)
    v_mfma_f32_16x16x32_bf16 v[68:71], v[44:47], a[68:71], v[68:71]
    v_mfma_f32_16x16x32_bf16 v[72:75], v[40:43], a[140:143], v[72:75]
    v_mfma_f32_16x16x32_bf16 v[76:79], v[44:47], a[140:143], v[76:79]
    v_mfma_f32_16x16x32_bf16 v[80:83], v[40:43], a[212:215], v[80:83]
    v_mfma_f32_16x16x32_bf16 v[84:87], v[44:47], a[212:215], v[84:87]
    v_mfma_f32_16x16x32_bf16 v[88:91], v[40:43], v[156:159], v[88:91]
    v_mfma_f32_16x16x32_bf16 v[92:95], v[44:47], v[156:159], v[92:95]
    s_mul_i32 s28, s20, 262144
    s_add_u32 s28, s28, s26
    v_cvt_pk_bf16_f32 v48, v64, v65
    v_cvt_pk_bf16_f32 v49, v66, v67
    v_cvt_pk_bf16_f32 v50, v68, v69
    v_cvt_pk_bf16_f32 v51, v70, v71
    buffer_store_dwordx4 v[48:51], v0, s[4:7], s28 offen offset:0 sc1
    v_cvt_pk_bf16_f32 v52, v72, v73
    v_cvt_pk_bf16_f32 v53, v74, v75
    v_cvt_pk_bf16_f32 v54, v76, v77
    v_cvt_pk_bf16_f32 v55, v78, v79
    buffer_store_dwordx4 v[52:55], v0, s[4:7], s28 offen offset:1024 sc1
    v_cvt_pk_bf16_f32 v48, v80, v81
    v_cvt_pk_bf16_f32 v49, v82, v83
    v_cvt_pk_bf16_f32 v50, v84, v85
    v_cvt_pk_bf16_f32 v51, v86, v87
    buffer_store_dwordx4 v[48:51], v0, s[4:7], s28 offen offset:2048 sc1
    v_cvt_pk_bf16_f32 v52, v88, v89
    v_cvt_pk_bf16_f32 v53, v90, v91
    v_cvt_pk_bf16_f32 v54, v92, v93
    v_cvt_pk_bf16_f32 v55, v94, v95
    buffer_store_dwordx4 v[52:55], v0, s[4:7], s28 offen offset:3072 sc1
    s_cmp_ge_u32 s23, 3
    s_cbranch_scc1 nofirst_76
    s_waitcnt vmcnt(0)
    s_barrier
    s_cmp_lg_u32 s19, 0
    s_cbranch_scc1 nofirst_76
    s_lshl_b32 s28, s20, 2
    s_add_u32 s28, s28, s27
    s_mov_b64 exec, 1
    v_mov_b32 v48, 1
    v_mov_b32 v49, 0
    buffer_atomic_add v48, v49, s[4:7], s28 offen
    s_mov_b64 exec, -1
nofirst_76:
    s_add_u32 s20, s20, s21
    s_sub_u32 s28, 36864, s34
    s_add_u32 s34, s28, 0
    s_add_u32 s23, s23, 1
    s_cmp_lt_u32 s23, s22
    s_cbranch_scc1 g_loop_73
    s_waitcnt vmcnt(0)
    s_barrier
    s_cmp_lg_u32 s19, 0
    s_cbranch_scc1 nosig_77
    s_mov_b64 exec, 1
    v_mov_b32 v48, 1
    v_mov_b32 v49, 0
    s_mul_i32 s28, s21, 1
    s_sub_u32 s28, s20, s28
    s_lshl_b32 s28, s28, 2
    s_add_u32 s28, s28, s27
    buffer_atomic_add v48, v49, s[4:7], s28 offen
    s_mul_i32 s28, s21, 2
    s_sub_u32 s28, s20, s28
    s_lshl_b32 s28, s28, 2
    s_add_u32 s28, s28, s27
    buffer_atomic_add v48, v49, s[4:7], s28 offen
    s_mov_b64 exec, -1
nosig_77:
g1done_67:
    s_branch L_p2
L_p1b:
    s_cmp_ge_u32 s44, 216
    s_cbranch_scc1 L_p1c
    s_sub_u32 s36, s44, 192
    s_mul_hi_u32 s20, s36, 1431655766
    s_mul_i32 s28, s20, 3
    s_sub_u32 s37, s36, s28
    s_mov_b32 s8, s84
    s_and_b32 s9, s85, 0xffff
    s_mov_b32 s10, 2359296
    s_mov_b32 s11, 0x20000
    s_mov_b32 s12, s86
    s_and_b32 s13, s87, 0xffff
    s_mov_b32 s14, 663552
    s_mov_b32 s15, 0x20000
    s_mul_i32 s24, s37, 384
    s_mov_b32 s25, 1152
    s_mov_b32 s21, 8
    s_mov_b32 s22, 8
    s_mov_b32 s35, 1152
    s_mov_b32 s40, s4
    s_mov_b32 s41, s5
    s_mov_b32 s42, s6
    s_mov_b32 s43, s7
    s_mul_i32 s26, s19, 96
    s_add_u32 s26, s26, s24
    s_add_u32 s26, s26, 83886080
    v_lshrrev_b32 v40, 5, v33
    v_and_b32 v41, 31, v33
    s_and_b32 s28, s19, 1
    s_lshl_b32 s28, s28, 2
    v_add_u32 v42, 0, v40
    v_and_b32 v43, 3, v42
    v_or_b32 v43, s28, v43
    v_lshlrev_b32 v43, 1, v43
    v_xor_b32 v43, v43, v41
    v_lshlrev_b32 v43, 4, v43
    v_mul_lo_u32 v42, v42, s25
    v_add_u32 v52, v42, v43
    v_add_u32 v42, 2, v40
    v_and_b32 v43, 3, v42
    v_or_b32 v43, s28, v43
    v_lshlrev_b32 v43, 1, v43
    v_xor_b32 v43, v43, v41
    v_lshlrev_b32 v43, 4, v43
    v_mul_lo_u32 v42, v42, s25
    v_add_u32 v53, v42, v43
    v_add_u32 v42, 4, v40
    v_and_b32 v43, 3, v42
    v_or_b32 v43, s28, v43
    v_lshlrev_b32 v43, 1, v43
    v_xor_b32 v43, v43, v41
    v_lshlrev_b32 v43, 4, v43
    v_mul_lo_u32 v42, v42, s25
    v_add_u32 v54, v42, v43
    v_add_u32 v42, 6, v40
    v_and_b32 v43, 3, v42
    v_or_b32 v43, s28, v43
    v_lshlrev_b32 v43, 1, v43
    v_xor_b32 v43, v43, v41
    v_lshlrev_b32 v43, 4, v43
    v_mul_lo_u32 v42, v42, s25
    v_add_u32 v55, v42, v43
    v_lshrrev_b32 v40, 2, v34
    v_and_b32 v41, 3, v34
    v_and_b32 v42, 1, v35
    v_lshl_or_b32 v42, v42, 2, v40
    v_lshl_add_u32 v43, v35, 3, v40
    v_lshlrev_b32 v43, 9, v43
    v_lshl_add_u32 v43, v41, 3, v43
    s_mul_i32 s28, s19, 3
    s_add_u32 s29, s28, 0
    v_xor_b32 v44, s29, v42
    v_lshl_add_u32 v56, v44, 5, v43
    s_add_u32 s29, s28, 1
    v_xor_b32 v44, s29, v42
    v_lshl_add_u32 v57, v44, 5, v43
    s_add_u32 s29, s28, 2
    v_xor_b32 v44, s29, v42
    v_lshl_add_u32 v58, v44, 5, v43
    s_lshl_b32 s28, s19, 3
    s_add_u32 s28, s28, 0
    s_mul_i32 s28, s28, s25
    s_add_u32 s28, s28, s24
    s_lshl_b32 s29, s19, 12
    s_add_u32 s29, s29, 0
    s_add_u32 m0, s29, 0
    s_nop 0
    buffer_load_dwordx4 v52, s[12:15], s28 offen lds
    s_add_u32 m0, s29, 1024
    s_nop 0
    buffer_load_dwordx4 v53, s[12:15], s28 offen lds
    s_add_u32 m0, s29, 2048
    s_nop 0
    buffer_load_dwordx4 v54, s[12:15], s28 offen lds
    s_add_u32 m0, s29, 3072
    s_nop 0
    buffer_load_dwordx4 v55, s[12:15], s28 offen lds
    s_lshl_b32 s28, s19, 3
    s_add_u32 s28, s28, 32
    s_mul_i32 s28, s28, s25
    s_add_u32 s28, s28, s24
    s_lshl_b32 s29, s19, 12
    s_add_u32 s29, s29, 16384
    s_add_u32 m0, s29, 0
    s_nop 0
    buffer_load_dwordx4 v52, s[12:15], s28 offen lds
    s_add_u32 m0, s29, 1024
    s_nop 0
    buffer_load_dwordx4 v53, s[12:15], s28 offen lds
    s_add_u32 m0, s29, 2048
    s_nop 0
    buffer_load_dwordx4 v54, s[12:15], s28 offen lds
    s_add_u32 m0, s29, 3072
    s_nop 0
    buffer_load_dwordx4 v55, s[12:15], s28 offen lds
    s_lshl_b32 s28, s19, 3
    s_add_u32 s28, s28, 64
    s_mul_i32 s28, s28, s25
    s_add_u32 s28, s28, s24
    s_lshl_b32 s29, s19, 12
    s_add_u32 s29, s29, 32768
    s_add_u32 m0, s29, 0
    s_nop 0
    buffer_load_dwordx4 v52, s[12:15], s28 offen lds
    s_add_u32 m0, s29, 1024
    s_nop 0
    buffer_load_dwordx4 v53, s[12:15], s28 offen lds
    s_add_u32 m0, s29, 2048
    s_nop 0
    buffer_load_dwordx4 v54, s[12:15], s28 offen lds
    s_add_u32 m0, s29, 3072
    s_nop 0
    buffer_load_dwordx4 v55, s[12:15], s28 offen lds
    s_lshl_b32 s28, s19, 3
    s_add_u32 s28, s28, 96
    s_mul_i32 s28, s28, s25
    s_add_u32 s28, s28, s24
    s_lshl_b32 s29, s19, 12
    s_add_u32 s29, s29, 49152
    s_add_u32 m0, s29, 0
    s_nop 0
    buffer_load_dwordx4 v52, s[12:15], s28 offen lds
    s_add_u32 m0, s29, 1024
    s_nop 0
    buffer_load_dwordx4 v53, s[12:15], s28 offen lds
    s_add_u32 m0, s29, 2048
    s_nop 0
    buffer_load_dwordx4 v54, s[12:15], s28 offen lds
    s_add_u32 m0, s29, 3072
    s_nop 0
    buffer_load_dwordx4 v55, s[12:15], s28 offen lds
    s_lshl_b32 s28, s19, 3
    s_add_u32 s28, s28, 128
    s_mul_i32 s28, s28, s25
    s_add_u32 s28, s28, s24
    s_lshl_b32 s29, s19, 12
    s_add_u32 s29, s29, 65536
    s_add_u32 m0, s29, 0
    s_nop 0
    buffer_load_dwordx4 v52, s[12:15], s28 offen lds
    s_add_u32 m0, s29, 1024
    s_nop 0
    buffer_load_dwordx4 v53, s[12:15], s28 offen lds
    s_add_u32 m0, s29, 2048
    s_nop 0
    buffer_load_dwordx4 v54, s[12:15], s28 offen lds
    s_add_u32 m0, s29, 3072
    s_nop 0
    buffer_load_dwordx4 v55, s[12:15], s28 offen lds
    s_lshl_b32 s28, s19, 3
    s_add_u32 s28, s28, 160
    s_mul_i32 s28, s28, s25
    s_add_u32 s28, s28, s24
    s_lshl_b32 s29, s19, 12
    s_add_u32 s29, s29, 81920
    s_add_u32 m0, s29, 0
    s_nop 0
    buffer_load_dwordx4 v52, s[12:15], s28 offen lds
    s_add_u32 m0, s29, 1024
    s_nop 0
    buffer_load_dwordx4 v53, s[12:15], s28 offen lds
    s_add_u32 m0, s29, 2048
    s_nop 0
    buffer_load_dwordx4 v54, s[12:15], s28 offen lds
    s_add_u32 m0, s29, 3072
    s_nop 0
    buffer_load_dwordx4 v55, s[12:15], s28 offen lds
    s_lshl_b32 s28, s19, 3
    s_add_u32 s28, s28, 192
    s_mul_i32 s28, s28, s25
    s_add_u32 s28, s28, s24
    s_lshl_b32 s29, s19, 12
    s_add_u32 s29, s29, 98304
    s_add_u32 m0, s29, 0
    s_nop 0
    buffer_load_dwordx4 v52, s[12:15], s28 offen lds
    s_add_u32 m0, s29, 1024
    s_nop 0
    buffer_load_dwordx4 v53, s[12:15], s28 offen lds
    s_add_u32 m0, s29, 2048
    s_nop 0
    buffer_load_dwordx4 v54, s[12:15], s28 offen lds
    s_add_u32 m0, s29, 3072
    s_nop 0
    buffer_load_dwordx4 v55, s[12:15], s28 offen lds
    s_lshl_b32 s28, s19, 3
    s_add_u32 s28, s28, 224
    s_mul_i32 s28, s28, s25
    s_add_u32 s28, s28, s24
    s_lshl_b32 s29, s19, 12
    s_add_u32 s29, s29, 114688
    s_add_u32 m0, s29, 0
    s_nop 0
    buffer_load_dwordx4 v52, s[12:15], s28 offen lds
    s_add_u32 m0, s29, 1024
    s_nop 0
    buffer_load_dwordx4 v53, s[12:15], s28 offen lds
    s_add_u32 m0, s29, 2048
    s_nop 0
    buffer_load_dwordx4 v54, s[12:15], s28 offen lds
    s_add_u32 m0, s29, 3072
    s_nop 0
    buffer_load_dwordx4 v55, s[12:15], s28 offen lds
    s_lshl_b32 s28, s19, 3
    s_add_u32 s28, s28, 256
    s_mul_i32 s28, s28, s25
    s_add_u32 s28, s28, s24
    s_lshl_b32 s29, s19, 12
    s_add_u32 s29, s29, 131072
    s_add_u32 m0, s29, 0
    s_nop 0
    buffer_load_dwordx4 v52, s[12:15], s28 offen lds
    s_add_u32 m0, s29, 1024
    s_nop 0
    buffer_load_dwordx4 v53, s[12:15], s28 offen lds
    s_add_u32 m0, s29, 2048
    s_nop 0
    buffer_load_dwordx4 v54, s[12:15], s28 offen lds
    s_add_u32 m0, s29, 3072
    s_nop 0
    buffer_load_dwordx4 v55, s[12:15], s28 offen lds
    s_lshl_b32 s28, s19, 3
    s_add_u32 s28, s28, 288
    s_mul_i32 s28, s28, s25
    s_add_u32 s28, s28, s24
    s_lshl_b32 s29, s19, 12
    s_add_u32 s29, s29, 147456
    s_add_u32 m0, s29, 0
    s_nop 0
    buffer_load_dwordx4 v52, s[12:15], s28 offen lds
    s_add_u32 m0, s29, 1024
    s_nop 0
    buffer_load_dwordx4 v53, s[12:15], s28 offen lds
    s_add_u32 m0, s29, 2048
    s_nop 0
    buffer_load_dwordx4 v54, s[12:15], s28 offen lds
    s_add_u32 m0, s29, 3072
    s_nop 0
    buffer_load_dwordx4 v55, s[12:15], s28 offen lds
    s_waitcnt vmcnt(36)
    s_barrier
    v_add_u32 v44, 0, v56
    ds_read_b64_tr_b16 a[0:1], v44
    ds_read_b64_tr_b16 a[2:3], v44 offset:2048
    v_add_u32 v44, 0, v57
    ds_read_b64_tr_b16 a[72:73], v44
    ds_read_b64_tr_b16 a[74:75], v44 offset:2048
    v_add_u32 v44, 0, v58
    ds_read_b64_tr_b16 a[144:145], v44
    ds_read_b64_tr_b16 a[146:147], v44 offset:2048
    s_waitcnt lgkmcnt(0)
    s_barrier
    s_lshl_b32 s28, s19, 3
    s_add_u32 s28, s28, 320
    s_mul_i32 s28, s28, s25
    s_add_u32 s28, s28, s24
    s_lshl_b32 s29, s19, 12
    s_add_u32 s29, s29, 0
    s_add_u32 m0, s29, 0
    s_nop 0
    buffer_load_dwordx4 v52, s[12:15], s28 offen lds
    s_add_u32 m0, s29, 1024
    s_nop 0
    buffer_load_dwordx4 v53, s[12:15], s28 offen lds
    s_add_u32 m0, s29, 2048
    s_nop 0
    buffer_load_dwordx4 v54, s[12:15], s28 offen lds
    s_add_u32 m0, s29, 3072
    s_nop 0
    buffer_load_dwordx4 v55, s[12:15], s28 offen lds
    s_waitcnt vmcnt(36)
    s_barrier
    v_add_u32 v44, 16384, v56
    ds_read_b64_tr_b16 a[4:5], v44
    ds_read_b64_tr_b16 a[6:7], v44 offset:2048
    v_add_u32 v44, 16384, v57
    ds_read_b64_tr_b16 a[76:77], v44
    ds_read_b64_tr_b16 a[78:79], v44 offset:2048
    v_add_u32 v44, 16384, v58
    ds_read_b64_tr_b16 a[148:149], v44
    ds_read_b64_tr_b16 a[150:151], v44 offset:2048
    s_waitcnt lgkmcnt(0)
    s_barrier
    s_lshl_b32 s28, s19, 3
    s_add_u32 s28, s28, 352
    s_mul_i32 s28, s28, s25
    s_add_u32 s28, s28, s24
    s_lshl_b32 s29, s19, 12
    s_add_u32 s29, s29, 16384
    s_add_u32 m0, s29, 0
    s_nop 0
    buffer_load_dwordx4 v52, s[12:15], s28 offen lds
    s_add_u32 m0, s29, 1024
    s_nop 0
    buffer_load_dwordx4 v53, s[12:15], s28 offen lds
    s_add_u32 m0, s29, 2048
    s_nop 0
    buffer_load_dwordx4 v54, s[12:15], s28 offen lds
    s_add_u32 m0, s29, 3072
    s_nop 0
    buffer_load_dwordx4 v55, s[12:15], s28 offen lds
    s_waitcnt vmcnt(36)
    s_barrier
    v_add_u32 v44, 32768, v56
    ds_read_b64_tr_b16 a[8:9], v44
    ds_read_b64_tr_b16 a[10:11], v44 offset:2048
    v_add_u32 v44, 32768, v57
    ds_read_b64_tr_b16 a[80:81], v44
    ds_read_b64_tr_b16 a[82:83], v44 offset:2048
    v_add_u32 v44, 32768, v58
    ds_read_b64_tr_b16 a[152:153], v44
    ds_read_b64_tr_b16 a[154:155], v44 offset:2048
    s_waitcnt lgkmcnt(0)
    s_barrier
    s_lshl_b32 s28, s19, 3
    s_add_u32 s28, s28, 384
    s_mul_i32 s28, s28, s25
    s_add_u32 s28, s28, s24
    s_lshl_b32 s29, s19, 12
    s_add_u32 s29, s29, 32768
    s_add_u32 m0, s29, 0
    s_nop 0
    buffer_load_dwordx4 v52, s[12:15], s28 offen lds
    s_add_u32 m0, s29, 1024
    s_nop 0
    buffer_load_dwordx4 v53, s[12:15], s28 offen lds
    s_add_u32 m0, s29, 2048
    s_nop 0
    buffer_load_dwordx4 v54, s[12:15], s28 offen lds
    s_add_u32 m0, s29, 3072
    s_nop 0
    buffer_load_dwordx4 v55, s[12:15], s28 offen lds
    s_waitcnt vmcnt(36)
    s_barrier
    v_add_u32 v44, 49152, v56
    ds_read_b64_tr_b16 a[12:13], v44
    ds_read_b64_tr_b16 a[14:15], v44 offset:2048
    v_add_u32 v44, 49152, v57
    ds_read_b64_tr_b16 a[84:85], v44
    ds_read_b64_tr_b16 a[86:87], v44 offset:2048
    v_add_u32 v44, 49152, v58
    ds_read_b64_tr_b16 a[156:157], v44
    ds_read_b64_tr_b16 a[158:159], v44 offset:2048
    s_waitcnt lgkmcnt(0)
    s_barrier
    s_lshl_b32 s28, s19, 3
    s_add_u32 s28, s28, 416
    s_mul_i32 s28, s28, s25
    s_add_u32 s28, s28, s24
    s_lshl_b32 s29, s19, 12
    s_add_u32 s29, s29, 49152
    s_add_u32 m0, s29, 0
    s_nop 0
    buffer_load_dwordx4 v52, s[12:15], s28 offen lds
    s_add_u32 m0, s29, 1024
    s_nop 0
    buffer_load_dwordx4 v53, s[12:15], s28 offen lds
    s_add_u32 m0, s29, 2048
    s_nop 0
    buffer_load_dwordx4 v54, s[12:15], s28 offen lds
    s_add_u32 m0, s29, 3072
    s_nop 0
    buffer_load_dwordx4 v55, s[12:15], s28 offen lds
    s_waitcnt vmcnt(36)
    s_barrier
    v_add_u32 v44, 65536, v56
    ds_read_b64_tr_b16 a[16:17], v44
    ds_read_b64_tr_b16 a[18:19], v44 offset:2048
    v_add_u32 v44, 65536, v57
    ds_read_b64_tr_b16 a[88:89], v44
    ds_read_b64_tr_b16 a[90:91], v44 offset:2048
    v_add_u32 v44, 65536, v58
    ds_read_b64_tr_b16 a[160:161], v44
    ds_read_b64_tr_b16 a[162:163], v44 offset:2048
    s_waitcnt lgkmcnt(0)
    s_barrier
    s_lshl_b32 s28, s19, 3
    s_add_u32 s28, s28, 448
    s_mul_i32 s28, s28, s25
    s_add_u32 s28, s28, s24
    s_lshl_b32 s29, s19, 12
    s_add_u32 s29, s29, 65536
    s_add_u32 m0, s29, 0
    s_nop 0
    buffer_load_dwordx4 v52, s[12:15], s28 offen lds
    s_add_u32 m0, s29, 1024
    s_nop 0
    buffer_load_dwordx4 v53, s[12:15], s28 offen lds
    s_add_u32 m0, s29, 2048
    s_nop 0
    buffer_load_dwordx4 v54, s[12:15], s28 offen lds
    s_add_u32 m0, s29, 3072
    s_nop 0
    buffer_load_dwordx4 v55, s[12:15], s28 offen lds
    s_waitcnt vmcnt(36)
    s_barrier
    v_add_u32 v44, 81920, v56
    ds_read_b64_tr_b16 a[20:21], v44
    ds_read_b64_tr_b16 a[22:23], v44 offset:2048
    v_add_u32 v44, 81920, v57
    ds_read_b64_tr_b16 a[92:93], v44
    ds_read_b64_tr_b16 a[94:95], v44 offset:2048
    v_add_u32 v44, 81920, v58
    ds_read_b64_tr_b16 a[164:165], v44
    ds_read_b64_tr_b16 a[166:167], v44 offset:2048
    s_waitcnt lgkmcnt(0)
    s_barrier
    s_lshl_b32 s28, s19, 3
    s_add_u32 s28, s28, 480
    s_mul_i32 s28, s28, s25
    s_add_u32 s28, s28, s24
    s_lshl_b32 s29, s19, 12
    s_add_u32 s29, s29, 81920
    s_add_u32 m0, s29, 0
    s_nop 0
    buffer_load_dwordx4 v52, s[12:15], s28 offen lds
    s_add_u32 m0, s29, 1024
    s_nop 0
    buffer_load_dwordx4 v53, s[12:15], s28 offen lds
    s_add_u32 m0, s29, 2048
    s_nop 0
    buffer_load_dwordx4 v54, s[12:15], s28 offen lds
    s_add_u32 m0, s29, 3072
    s_nop 0
    buffer_load_dwordx4 v55, s[12:15], s28 offen lds
    s_waitcnt vmcnt(36)
    s_barrier
    v_add_u32 v44, 98304, v56
    ds_read_b64_tr_b16 a[24:25], v44
    ds_read_b64_tr_b16 a[26:27], v44 offset:2048
    v_add_u32 v44, 98304, v57
    ds_read_b64_tr_b16 a[96:97], v44
    ds_read_b64_tr_b16 a[98:99], v44 offset:2048
    v_add_u32 v44, 98304, v58
    ds_read_b64_tr_b16 a[168:169], v44
    ds_read_b64_tr_b16 a[170:171], v44 offset:2048
    s_waitcnt lgkmcnt(0)
    s_barrier
    s_lshl_b32 s28, s19, 3
    s_add_u32 s28, s28, 512
    s_mul_i32 s28, s28, s25
    s_add_u32 s28, s28, s24
    s_lshl_b32 s29, s19, 12
    s_add_u32 s29, s29, 98304
    s_add_u32 m0, s29, 0
    s_nop 0
    buffer_load_dwordx4 v52, s[12:15], s28 offen lds
    s_add_u32 m0, s29, 1024
    s_nop 0
    buffer_load_dwordx4 v53, s[12:15], s28 offen lds
    s_add_u32 m0, s29, 2048
    s_nop 0
    buffer_load_dwordx4 v54, s[12:15], s28 offen lds
    s_add_u32 m0, s29, 3072
    s_nop 0
    buffer_load_dwordx4 v55, s[12:15], s28 offen lds
    s_waitcnt vmcnt(36)
    s_barrier
    v_add_u32 v44, 114688, v56
    ds_read_b64_tr_b16 a[28:29], v44
    ds_read_b64_tr_b16 a[30:31], v44 offset:2048
    v_add_u32 v44, 114688, v57
    ds_read_b64_tr_b16 a[100:101], v44
    ds_read_b64_tr_b16 a[102:103], v44 offset:2048
    v_add_u32 v44, 114688, v58
    ds_read_b64_tr_b16 a[172:173], v44
    ds_read_b64_tr_b16 a[174:175], v44 offset:2048
    s_waitcnt lgkmcnt(0)
    s_barrier
    s_lshl_b32 s28, s19, 3
    s_add_u32 s28, s28, 544
    s_mul_i32 s28, s28, s25
    s_add_u32 s28, s28, s24
    s_lshl_b32 s29, s19, 12
    s_add_u32 s29, s29, 114688
    s_add_u32 m0, s29, 0
    s_nop 0
    buffer_load_dwordx4 v52, s[12:15], s28 offen lds
    s_add_u32 m0, s29, 1024
    s_nop 0
    buffer_load_dwordx4 v53, s[12:15], s28 offen lds
    s_add_u32 m0, s29, 2048
    s_nop 0
    buffer_load_dwordx4 v54, s[12:15], s28 offen lds
    s_add_u32 m0, s29, 3072
    s_nop 0
    buffer_load_dwordx4 v55, s[12:15], s28 offen lds
    s_waitcnt vmcnt(36)
    s_barrier
    v_add_u32 v44, 131072, v56
    ds_read_b64_tr_b16 a[32:33], v44
    ds_read_b64_tr_b16 a[34:35], v44 offset:2048
    v_add_u32 v44, 131072, v57
    ds_read_b64_tr_b16 a[104:105], v44
    ds_read_b64_tr_b16 a[106:107], v44 offset:2048
    v_add_u32 v44, 131072, v58
    ds_read_b64_tr_b16 a[176:177], v44
    ds_read_b64_tr_b16 a[178:179], v44 offset:2048
    s_waitcnt lgkmcnt(0)
    s_barrier
    s_waitcnt vmcnt(32)
    s_barrier
    v_add_u32 v44, 147456, v56
    ds_read_b64_tr_b16 a[36:37], v44
    ds_read_b64_tr_b16 a[38:39], v44 offset:2048
    v_add_u32 v44, 147456, v57
    ds_read_b64_tr_b16 a[108:109], v44
    ds_read_b64_tr_b16 a[110:111], v44 offset:2048
    v_add_u32 v44, 147456, v58
    ds_read_b64_tr_b16 a[180:181], v44
    ds_read_b64_tr_b16 a[182:183], v44 offset:2048
    s_waitcnt lgkmcnt(0)
    s_barrier
    s_waitcnt vmcnt(28)
    s_barrier
    v_add_u32 v44, 0, v56
    ds_read_b64_tr_b16 a[40:41], v44
    ds_read_b64_tr_b16 a[42:43], v44 offset:2048
    v_add_u32 v44, 0, v57
    ds_read_b64_tr_b16 a[112:113], v44
    ds_read_b64_tr_b16 a[114:115], v44 offset:2048
    v_add_u32 v44, 0, v58
    ds_read_b64_tr_b16 a[184:185], v44
    ds_read_b64_tr_b16 a[186:187], v44 offset:2048
    s_waitcnt lgkmcnt(0)
    s_barrier
    s_waitcnt vmcnt(24)
    s_barrier
    v_add_u32 v44, 16384, v56
    ds_read_b64_tr_b16 a[44:45], v44
    ds_read_b64_tr_b16 a[46:47], v44 offset:2048
    v_add_u32 v44, 16384, v57
    ds_read_b64_tr_b16 a[116:117], v44
    ds_read_b64_tr_b16 a[118:119], v44 offset:2048
    v_add_u32 v44, 16384, v58
    ds_read_b64_tr_b16 a[188:189], v44
    ds_read_b64_tr_b16 a[190:191], v44 offset:2048
    s_waitcnt lgkmcnt(0)
    s_barrier
    s_waitcnt vmcnt(20)
    s_barrier
    v_add_u32 v44, 32768, v56
    ds_read_b64_tr_b16 a[48:49], v44
    ds_read_b64_tr_b16 a[50:51], v44 offset:2048
    v_add_u32 v44, 32768, v57
    ds_read_b64_tr_b16 a[120:121], v44
    ds_read_b64_tr_b16 a[122:123], v44 offset:2048
    v_add_u32 v44, 32768, v58
    ds_read_b64_tr_b16 a[192:193], v44
    ds_read_b64_tr_b16 a[194:195], v44 offset:2048
    s_waitcnt lgkmcnt(0)
    s_barrier
    s_waitcnt vmcnt(16)
    s_barrier
    v_add_u32 v44, 49152, v56
    ds_read_b64_tr_b16 a[52:53], v44
    ds_read_b64_tr_b16 a[54:55], v44 offset:2048
    v_add_u32 v44, 49152, v57
    ds_read_b64_tr_b16 a[124:125], v44
    ds_read_b64_tr_b16 a[126:127], v44 offset:2048
    v_add_u32 v44, 49152, v58
    ds_read_b64_tr_b16 a[196:197], v44
    ds_read_b64_tr_b16 a[198:199], v44 offset:2048
    s_waitcnt lgkmcnt(0)
    s_barrier
    s_waitcnt vmcnt(12)
    s_barrier
    v_add_u32 v44, 65536, v56
    ds_read_b64_tr_b16 a[56:57], v44
    ds_read_b64_tr_b16 a[58:59], v44 offset:2048
    v_add_u32 v44, 65536, v57
    ds_read_b64_tr_b16 a[128:129], v44
    ds_read_b64_tr_b16 a[130:131], v44 offset:2048
    v_add_u32 v44, 65536, v58
    ds_read_b64_tr_b16 a[200:201], v44
    ds_read_b64_tr_b16 a[202:203], v44 offset:2048
    s_waitcnt lgkmcnt(0)
    s_barrier
    s_waitcnt vmcnt(8)
    s_barrier
    v_add_u32 v44, 81920, v56
    ds_read_b64_tr_b16 a[60:61], v44
    ds_read_b64_tr_b16 a[62:63], v44 offset:2048
    v_add_u32 v44, 81920, v57
    ds_read_b64_tr_b16 a[132:133], v44
    ds_read_b64_tr_b16 a[134:135], v44 offset:2048
    v_add_u32 v44, 81920, v58
    ds_read_b64_tr_b16 a[204:205], v44
    ds_read_b64_tr_b16 a[206:207], v44 offset:2048
    s_waitcnt lgkmcnt(0)
    s_barrier
    s_waitcnt vmcnt(4)
    s_barrier
    v_add_u32 v44, 98304, v56
    ds_read_b64_tr_b16 a[64:65], v44
    ds_read_b64_tr_b16 a[66:67], v44 offset:2048
    v_add_u32 v44, 98304, v57
    ds_read_b64_tr_b16 a[136:137], v44
    ds_read_b64_tr_b16 a[138:139], v44 offset:2048
    v_add_u32 v44, 98304, v58
    ds_read_b64_tr_b16 a[208:209], v44
    ds_read_b64_tr_b16 a[210:211], v44 offset:2048
    s_waitcnt lgkmcnt(0)
    s_barrier
    s_waitcnt vmcnt(0)
    s_barrier
    v_add_u32 v44, 114688, v56
    ds_read_b64_tr_b16 a[68:69], v44
    ds_read_b64_tr_b16 a[70:71], v44 offset:2048
    v_add_u32 v44, 114688, v57
    ds_read_b64_tr_b16 a[140:141], v44
    ds_read_b64_tr_b16 a[142:143], v44 offset:2048
    v_add_u32 v44, 114688, v58
    ds_read_b64_tr_b16 a[212:213], v44
    ds_read_b64_tr_b16 a[214:215], v44 offset:2048
    s_waitcnt lgkmcnt(0)
    s_barrier
    v_lshrrev_b32 v40, 2, v33
    v_lshrrev_b32 v41, 4, v33
    v_lshrrev_b32 v43, 1, v41
    v_xor_b32 v42, v41, v43
    v_and_b32 v42, 1, v42
    v_lshl_or_b32 v42, v42, 1, v43
    v_and_b32 v43, 3, v33
    v_xor_b32 v42, v42, v43
    v_mul_u32_u24 v1, 1152, v40
    v_lshl_add_u32 v1, v42, 4, v1
    v_lshrrev_b32 v41, 2, v34
    v_lshrrev_b32 v43, 1, v41
    v_xor_b32 v42, v41, v43
    v_and_b32 v42, 1, v42
    v_lshl_or_b32 v42, v42, 1, v43
    v_xor_b32 v42, v42, v35
    v_lshlrev_b32 v2, 6, v34
    v_lshl_add_u32 v2, v42, 4, v2
    v_mul_u32_u24 v4, 1152, v34
    v_lshl_add_u32 v4, v35, 3, v4
    s_mov_b32 s30, 0
    v_mov_b32 v48, 52
iw_78:
    global_load_dword v49, v48, s[16:17] sc1
    s_waitcnt vmcnt(0)
    v_readfirstlane_b32 s28, v49
    s_nop 0
    s_cmp_lg_u32 s28, 0
    s_cbranch_scc1 id_79
    s_sleep 2
    s_add_u32 s30, s30, 1
    s_cmp_lt_u32 s30, 0x100000
    s_cbranch_scc1 iw_78
    s_mov_b32 s99, 1
id_79:
    s_mov_b32 s23, 0
    s_mov_b32 s34, 0
    s_mov_b32 s33, -1
    s_mul_i32 s28, s20, 36864
    s_lshr_b32 s29, s19, 1
    s_mul_i32 s29, s29, 18432
    s_add_u32 s28, s28, s29
    s_and_b32 s29, s19, 1
    s_mul_i32 s29, s29, 576
    s_add_u32 s28, s28, s29
    s_mul_i32 s29, s19, 9216
    s_add_u32 s29, s29, s34
    s_add_u32 m0, s29, 0
    s_add_u32 s30, s28, 0
    buffer_load_dwordx4 v1, s[8:11], s30 offen lds
    s_add_u32 m0, s29, 1024
    s_add_u32 s30, s28, 64
    buffer_load_dwordx4 v1, s[8:11], s30 offen lds
    s_add_u32 m0, s29, 2048
    s_add_u32 s30, s28, 128
    buffer_load_dwordx4 v1, s[8:11], s30 offen lds
    s_add_u32 m0, s29, 3072
    s_add_u32 s30, s28, 192
    buffer_load_dwordx4 v1, s[8:11], s30 offen lds
    s_add_u32 m0, s29, 4096
    s_add_u32 s30, s28, 256
    buffer_load_dwordx4 v1, s[8:11], s30 offen lds
    s_add_u32 m0, s29, 5120
    s_add_u32 s30, s28, 320
    buffer_load_dwordx4 v1, s[8:11], s30 offen lds
    s_add_u32 m0, s29, 6144
    s_add_u32 s30, s28, 384
    buffer_load_dwordx4 v1, s[8:11], s30 offen lds
    s_add_u32 m0, s29, 7168
    s_add_u32 s30, s28, 448
    buffer_load_dwordx4 v1, s[8:11], s30 offen lds
    s_add_u32 m0, s29, 8192
    s_add_u32 s30, s28, 512
    buffer_load_dwordx4 v1, s[8:11], s30 offen lds
    s_waitcnt vmcnt(0)
g_loop_80:
    s_waitcnt vmcnt(6)
    s_barrier
    s_add_u32 s31, s23, 1
    s_cmp_ge_u32 s31, s22
    s_cbranch_scc1 nopf_81
    s_add_u32 s32, s20, s21
    s_sub_u32 s31, 36864, s34
    s_add_u32 s31, s31, 0
    s_mul_i32 s28, s32, 36864
    s_lshr_b32 s29, s19, 1
    s_mul_i32 s29, s29, 18432
    s_add_u32 s28, s28, s29
    s_and_b32 s29, s19, 1
    s_mul_i32 s29, s29, 576
    s_add_u32 s28, s28, s29
    s_mul_i32 s29, s19, 9216
    s_add_u32 s29, s29, s31
    s_add_u32 m0, s29, 0
    s_add_u32 s30, s28, 0
    buffer_load_dwordx4 v1, s[8:11], s30 offen lds
    s_add_u32 m0, s29, 1024
    s_add_u32 s30, s28, 64
    buffer_load_dwordx4 v1, s[8:11], s30 offen lds
    s_add_u32 m0, s29, 2048
    s_add_u32 s30, s28, 128
    buffer_load_dwordx4 v1, s[8:11], s30 offen lds
    s_add_u32 m0, s29, 3072
    s_add_u32 s30, s28, 192
    buffer_load_dwordx4 v1, s[8:11], s30 offen lds
    s_add_u32 m0, s29, 4096
    s_add_u32 s30, s28, 256
    buffer_load_dwordx4 v1, s[8:11], s30 offen lds
    s_add_u32 m0, s29, 5120
    s_add_u32 s30, s28, 320
    buffer_load_dwordx4 v1, s[8:11], s30 offen lds
    s_add_u32 m0, s29, 6144
    s_add_u32 s30, s28, 384
    buffer_load_dwordx4 v1, s[8:11], s30 offen lds
    s_add_u32 m0, s29, 7168
    s_add_u32 s30, s28, 448
    buffer_load_dwordx4 v1, s[8:11], s30 offen lds
    s_add_u32 m0, s29, 8192
    s_add_u32 s30, s28, 512
    buffer_load_dwordx4 v1, s[8:11], s30 offen lds
nopf_81:
    v_add_u32 v3, s34, v2
    ds_read_b128 v[32:35], v3 offset:0
    ds_read_b128 v[36:39], v3 offset:18432
    ds_read_b128 v[40:43], v3 offset:1024
    ds_read_b128 v[44:47], v3 offset:19456
    s_waitcnt lgkmcnt(3)
    v_mfma_f32_16x16x32_bf16 v[64:67], a[0:3], v[32:35], 0
    s_waitcnt lgkmcnt(2)
    v_mfma_f32_16x16x32_bf16 v[68:71], a[0:3], v[36:39], 0
    v_mfma_f32_16x16x32_bf16 v[72:75], a[72:75], v[32:35], 0
    v_mfma_f32_16x16x32_bf16 v[76:79], a[72:75], v[36:39], 0
    v_mfma_f32_16x16x32_bf16 v[80:83], a[144:147], v[32:35], 0
    v_mfma_f32_16x16x32_bf16 v[84:87], a[144:147], v[36:39], 0
    ds_read_b128 v[32:35], v3 offset:2048
    ds_read_b128 v[36:39], v3 offset:20480
    s_waitcnt lgkmcnt(3)
    v_mfma_f32_16x16x32_bf16 v[64:67], a[4:7], v[40:43], v[64:67]
    s_waitcnt lgkmcnt(2)
    v_mfma_f32_16x16x32_bf16 v[68:71], a[4:7], v[44:47], v[68:71]
    v_mfma_f32_16x16x32_bf16 v[72:75], a[76:79], v[40:43], v[72:75]
    v_mfma_f32_16x16x32_bf16 v[76:79], a[76:79], v[44:47], v[76:79]
    v_mfma_f32_16x16x32_bf16 v[80:83], a[148:151], v[40:43], v[80:83]
    v_mfma_f32_16x16x32_bf16 v[84:87], a[148:151], v[44:47], v[84:87]
    ds_read_b128 v[40:43], v3 offset:3072
    ds_read_b128 v[44:47], v3 offset:21504
    s_waitcnt lgkmcnt(3)
    v_mfma_f32_16x16x32_bf16 v[64:67], a[8:11], v[32:35], v[64:67]
    s_waitcnt lgkmcnt(2)
    v_mfma_f32_16x16x32_bf16 v[68:71], a[8:11], v[36:39], v[68:71]
    v_mfma_f32_16x16x32_bf16 v[72:75], a[80:83], v[32:35], v[72:75]
    v_mfma_f32_16x16x32_bf16 v[76:79], a[80:83], v[36:39], v[76:79]
    v_mfma_f32_16x16x32_bf16 v[80:83], a[152:155], v[32:35], v[80:83]
    v_mfma_f32_16x16x32_bf16 v[84:87], a[152:155], v[36:39], v[84:87]
    ds_read_b128 v[32:35], v3 offset:4096
    ds_read_b128 v[36:39], v3 offset:22528
    s_waitcnt lgkmcnt(3)
    v_mfma_f32_16x16x32_bf16 v[64:67], a[12:15], v[40:43], v[64:67]
    s_waitcnt lgkmcnt(2)
    v_mfma_f32_16x16x32_bf16 v[68:71], a[12:15], v[44:47], v[68:71]
    v_mfma_f32_16x16x32_bf16 v[72:75], a[84:87], v[40:43], v[72:75]
    v_mfma_f32_16x16x32_bf16 v[76:79], a[84:87], v[44:47], v[76:79]
    v_mfma_f32_16x16x32_bf16 v[80:83], a[156:159], v[40:43], v[80:83]
    v_mfma_f32_16x16x32_bf16 v[84:87], a[156:159], v[44:47], v[84:87]
    ds_read_b128 v[40:43], v3 offset:5120
    ds_read_b128 v[44:47], v3 offset:23552
    s_waitcnt lgkmcnt(3)
    v_mfma_f32_16x16x32_bf16 v[64:67], a[16:19], v[32:35], v[64:67]
    s_waitcnt lgkmcnt(2)
    v_mfma_f32_16x16x32_bf16 v[68:71], a[16:19], v[36:39], v[68:71]
    v_mfma_f32_16x16x32_bf16 v[72:75], a[88:91], v[32:35], v[72:75]
    v_mfma_f32_16x16x32_bf16 v[76:79], a[88:91], v[36:39], v[76:79]
    v_mfma_f32_16x16x32_bf16 v[80:83], a[160:163], v[32:35], v[80:83]
    v_mfma_f32_16x16x32_bf16 v[84:87], a[160:163], v[36:39], v[84:87]
    ds_read_b128 v[32:35], v3 offset:6144
    ds_read_b128 v[36:39], v3 offset:24576
    s_waitcnt lgkmcnt(3)
    v_mfma_f32_16x16x32_bf16 v[64:67], a[20:23], v[40:43], v[64:67]
    s_waitcnt lgkmcnt(2)
    v_mfma_f32_16x16x32_bf16 v[68:71], a[20:23], v[44:47], v[68:71]
    v_mfma_f32_16x16x32_bf16 v[72:75], a[92:95], v[40:43], v[72:75]
    v_mfma_f32_16x16x32_bf16 v[76:79], a[92:95], v[44:47], v[76:79]
    v_mfma_f32_16x16x32_bf16 v[80:83], a[164:167], v[40:43], v[80:83]
    v_mfma_f32_16x16x32_bf16 v[84:87], a[164:167], v[44:47], v[84:87]
    ds_read_b128 v[40:43], v3 offset:7168
    ds_read_b128 v[44:47], v3 offset:25600
    s_waitcnt lgkmcnt(3)
    v_mfma_f32_16x16x32_bf16 v[64:67], a[24:27], v[32:35], v[64:67]
    s_waitcnt lgkmcnt(2)
    v_mfma_f32_16x16x32_bf16 v[68:71], a[24:27], v[36:39], v[68:71]
    v_mfma_f32_16x16x32_bf16 v[72:75], a[96:99], v[32:35], v[72:75]
    v_mfma_f32_16x16x32_bf16 v[76:79], a[96:99], v[36:39], v[76:79]
    v_mfma_f32_16x16x32_bf16 v[80:83], a[168:171], v[32:35], v[80:83]
    v_mfma_f32_16x16x32_bf16 v[84:87], a[168:171], v[36:39], v[84:87]
    ds_read_b128 v[32:35], v3 offset:8192
    ds_read_b128 v[36:39], v3 offset:26624
    s_waitcnt lgkmcnt(3)
    v_mfma_f32_16x16x32_bf16 v[64:67], a[28:31], v[40:43], v[64:67]
    s_waitcnt lgkmcnt(2)
    v_mfma_f32_16x16x32_bf16 v[68:71], a[28:31], v[44:47], v[68:71]
    v_mfma_f32_16x16x32_bf16 v[72:75], a[100:103], v[40:43], v[72:75]
    v_mfma_f32_16x16x32_bf16 v[76:79], a[100:103], v[44:47], v[76:79]
    v_mfma_f32_16x16x32_bf16 v[80:83], a[172:175], v[40:43], v[80:83]
    v_mfma_f32_16x16x32_bf16 v[84:87], a[172:175], v[44:47], v[84:87]
    ds_read_b128 v[40:43], v3 offset:9216
    ds_read_b128 v[44:47], v3 offset:27648
    s_waitcnt lgkmcnt(3)
    v_mfma_f32_16x16x32_bf16 v[64:67], a[32:35], v[32:35], v[64:67]
    s_waitcnt lgkmcnt(2)
    v_mfma_f32_16x16x32_bf16 v[68:71], a[32:35], v[36:39], v[68:71]
    v_mfma_f32_16x16x32_bf16 v[72:75], a[104:107], v[32:35], v[72:75]
    v_mfma_f32_16x16x32_bf16 v[76:79], a[104:107], v[36:39], v[76:79]
    v_mfma_f32_16x16x32_bf16 v[80:83], a[176:179], v[32:35], v[80:83]
    v_mfma_f32_16x16x32_bf16 v[84:87], a[176:179], v[36:39], v[84:87]
    ds_read_b128 v[32:35], v3 offset:10240
    ds_read_b128 v[36:39], v3 offset:28672
    s_waitcnt lgkmcnt(3)
    v_mfma_f32_16x16x32_bf16 v[64:67], a[36:39], v[40:43], v[64:67]
    s_waitcnt lgkmcnt(2)
    v_mfma_f32_16x16x32_bf16 v[68:71], a[36:39], v[44:47], v[68:71]
    v_mfma_f32_16x16x32_bf16 v[72:75], a[108:111], v[40:43], v[72:75]
    v_mfma_f32_16x16x32_bf16 v[76:79], a[108:111], v[44:47], v[76:79]
    v_mfma_f32_16x16x32_bf16 v[80:83], a[180:183], v[40:43], v[80:83]
    v_mfma_f32_16x16x32_bf16 v[84:87], a[180:183], v[44:47], v[84:87]
    ds_read_b128 v[40:43], v3 offset:11264
    ds_read_b128 v[44:47], v3 offset:29696
    s_waitcnt lgkmcnt(3)
    v_mfma_f32_16x16x32_bf16 v[64:67], a[40:43], v[32:35], v[64:67]
    s_waitcnt lgkmcnt(2)
    v_mfma_f32_16x16x32_bf16 v[68:71], a[40:43], v[36:39], v[68:71]
    v_mfma_f32_16x16x32_bf16 v[72:75], a[112:115], v[32:35], v[72:75]
    v_mfma_f32_16x16x32_bf16 v[76:79], a[112:115], v[36:39], v[76:79]
    v_mfma_f32_16x16x32_bf16 v[80:83], a[184:187], v[32:35], v[80:83]
    v_mfma_f32_16x16x32_bf16 v[84:87], a[184:187], v[36:39], v[84:87]
    ds_read_b128 v[32:35], v3 offset:12288
    ds_read_b128 v[36:39], v3 offset:30720
    s_waitcnt lgkmcnt(3)
    v_mfma_f32_16x16x32_bf16 v[64:67], a[44:47], v[40:43], v[64:67]
    s_waitcnt lgkmcnt(2)
    v_mfma_f32_16x16x32_bf16 v[68:71], a[44:47], v[44:47], v[68:71]
    v_mfma_f32_16x16x32_bf16 v[72:75], a[116:119], v[40:43], v[72:75]
    v_mfma_f32_16x16x32_bf16 v[76:79], a[116:119], v[44:47], v[76:79]
    v_mfma_f32_16x16x32_bf16 v[80:83], a[188:191], v[40:43], v[80:83]
    v_mfma_f32_16x16x32_bf16 v[84:87], a[188:191], v[44:47], v[84:87]
    ds_read_b128 v[40:43], v3 offset:13312
    ds_read_b128 v[44:47], v3 offset:31744
    s_waitcnt lgkmcnt(3)
    v_mfma_f32_16x16x32_bf16 v[64:67], a[48:51], v[32:35], v[64:67]
    s_waitcnt lgkmcnt(2)
    v_mfma_f32_16x16x32_bf16 v[68:71], a[48:51], v[36:39], v[68:71]
    v_mfma_f32_16x16x32_bf16 v[72:75], a[120:123], v[32:35], v[72:75]
    v_mfma_f32_16x16x32_bf16 v[76:79], a[120:123], v[36:39], v[76:79]
    v_mfma_f32_16x16x32_bf16 v[80:83], a[192:195], v[32:35], v[80:83]
    v_mfma_f32_16x16x32_bf16 v[84:87], a[192:195], v[36:39], v[84:87]
    ds_read_b128 v[32:35], v3 offset:14336
    ds_read_b128 v[36:39], v3 offset:32768
    s_waitcnt lgkmcnt(3)
    v_mfma_f32_16x16x32_bf16 v[64:67], a[52:55], v[40:43], v[64:67]
    s_waitcnt lgkmcnt(2)
    v_mfma_f32_16x16x32_bf16 v[68:71], a[52:55], v[44:47], v[68:71]
    v_mfma_f32_16x16x32_bf16 v[72:75], a[124:127], v[40:43], v[72:75]
    v_mfma_f32_16x16x32_bf16 v[76:79], a[124:127], v[44:47], v[76:79]
    v_mfma_f32_16x16x32_bf16 v[80:83], a[196:199], v[40:43], v[80:83]
    v_mfma_f32_16x16x32_bf16 v[84:87], a[196:199], v[44:47], v[84:87]
    ds_read_b128 v[40:43], v3 offset:15360
    ds_read_b128 v[44:47], v3 offset:33792
    s_waitcnt lgkmcnt(3)
    v_mfma_f32_16x16x32_bf16 v[64:67], a[56:59], v[32:35], v[64:67]
    s_waitcnt lgkmcnt(2)
    v_mfma_f32_16x16x32_bf16 v[68:71], a[56:59], v[36:39], v[68:71]
    v_mfma_f32_16x16x32_bf16 v[72:75], a[128:131], v[32:35], v[72:75]
    v_mfma_f32_16x16x32_bf16 v[76:79], a[128:131], v[36:39], v[76:79]
    v_mfma_f32_16x16x32_bf16 v[80:83], a[200:203], v[32:35], v[80:83]
    v_mfma_f32_16x16x32_bf16 v[84:87], a[200:203], v[36:39], v[84:87]
    ds_read_b128 v[32:35], v3 offset:16384
    ds_read_b128 v[36:39], v3 offset:34816
    s_waitcnt lgkmcnt(3)
    v_mfma_f32_16x16x32_bf16 v[64:67], a[60:63], v[40:43], v[64:67]
    s_waitcnt lgkmcnt(2)
    v_mfma_f32_16x16x32_bf16 v[68:71], a[60:63], v[44:47], v[68:71]
    v_mfma_f32_16x16x32_bf16 v[72:75], a[132:135], v[40:43], v[72:75]
    v_mfma_f32_16x16x32_bf16 v[76:79], a[132:135], v[44:47], v[76:79]
    v_mfma_f32_16x16x32_bf16 v[80:83], a[204:207], v[40:43], v[80:83]
    v_mfma_f32_16x16x32_bf16 v[84:87], a[204:207], v[44:47], v[84:87]
    ds_read_b128 v[40:43], v3 offset:17408
    ds_read_b128 v[44:47], v3 offset:35840
    s_waitcnt lgkmcnt(3)
    v_mfma_f32_16x16x32_bf16 v[64:67], a[64:67], v[32:35], v[64:67]
    s_waitcnt lgkmcnt(2)
    v_mfma_f32_16x16x32_bf16 v[68:71], a[64:67], v[36:39], v[68:71]
    v_mfma_f32_16x16x32_bf16 v[72:75], a[136:139], v[32:35], v[72:75]
    v_mfma_f32_16x16x32_bf16 v[76:79], a[136:139], v[36:39], v[76:79]
    v_mfma_f32_16x16x32_bf16 v[80:83], a[208:211], v[32:35], v[80:83]
    v_mfma_f32_16x16x32_bf16 v[84:87], a[208:211], v[36:39], v[84:87]
    s_waitcnt lgkmcnt(1)
    v_mfma_f32_16x16x32_bf16 v[64:67], a[68:71], v[40:43], v[64:67]
    s_waitcnt lgkmcnt(0)
    v_mfma_f32_16x16x32_bf16 v[68:71], a[68:71], v[44:47], v[68:71]
    v_mfma_f32_16x16x32_bf16 v[72:75], a[140:143], v[40:43], v[72:75]
    v_mfma_f32_16x16x32_bf16 v[76:79], a[140:143], v[44:47], v[76:79]
    v_mfma_f32_16x16x32_bf16 v[80:83], a[212:215], v[40:43], v[80:83]
    v_mfma_f32_16x16x32_bf16 v[84:87], a[212:215], v[44:47], v[84:87]
    s_lshl_b32 s28, s20, 5
    s_add_u32 s28, s28, 0
    s_mul_i32 s28, s28, s35
    s_add_u32 s28, s28, s26
    v_cvt_pk_bf16_f32 v48, v64, v65
    v_cvt_pk_bf16_f32 v49, v66, v67
    buffer_store_dwordx2 v[48:49], v4, s[40:43], s28 offen offset:0 sc1
    v_cvt_pk_bf16_f32 v50, v72, v73
    v_cvt_pk_bf16_f32 v51, v74, v75
    buffer_store_dwordx2 v[50:51], v4, s[40:43], s28 offen offset:32 sc1
    v_cvt_pk_bf16_f32 v52, v80, v81
    v_cvt_pk_bf16_f32 v53, v82, v83
    buffer_store_dwordx2 v[52:53], v4, s[40:43], s28 offen offset:64 sc1
    s_lshl_b32 s28, s20, 5
    s_add_u32 s28, s28, 16
    s_mul_i32 s28, s28, s35
    s_add_u32 s28, s28, s26
    v_cvt_pk_bf16_f32 v54, v68, v69
    v_cvt_pk_bf16_f32 v55, v70, v71
    buffer_store_dwordx2 v[54:55], v4, s[40:43], s28 offen offset:0 sc1
    v_cvt_pk_bf16_f32 v48, v76, v77
    v_cvt_pk_bf16_f32 v49, v78, v79
    buffer_store_dwordx2 v[48:49], v4, s[40:43], s28 offen offset:32 sc1
    v_cvt_pk_bf16_f32 v50, v84, v85
    v_cvt_pk_bf16_f32 v51, v86, v87
    buffer_store_dwordx2 v[50:51], v4, s[40:43], s28 offen offset:64 sc1
    s_add_u32 s20, s20, s21
    s_sub_u32 s28, 36864, s34
    s_add_u32 s34, s28, 0
    s_add_u32 s23, s23, 1
    s_cmp_lt_u32 s23, s22
    s_cbranch_scc1 g_loop_80
    s_waitcnt vmcnt(0)
    s_barrier
    s_cmp_lg_u32 s19, 0
    s_cbranch_scc1 nosig_82
    s_mov_b32 s28, 65012864
    s_mov_b64 exec, 1
    v_mov_b32 v48, 1
    v_mov_b32 v49, 0
    buffer_atomic_add v48, v49, s[4:7], s28 offen
    s_mov_b64 exec, -1
nosig_82:
    s_branch L_p2
L_p1c:
    s_mov_b32 s8, s84
    s_and_b32 s9, s85, 0xffff
    s_mov_b32 s10, 2359296
    s_mov_b32 s11, 0x20000
    s_sub_u32 s20, s44, 216
    s_lshl_b32 s20, s20, 2
    s_add_u32 s20, s20, s19
    s_mov_b32 s21, 32
    s_mov_b32 s12, s88
    s_and_b32 s13, s89, 0xffff
    s_mov_b32 s14, 20736
    s_mov_b32 s15, 0x20000
    s_lshl_b32 s28, s19, 10
    s_add_u32 s28, s28, 0
    s_add_u32 m0, s28, 0
    s_nop 0
    buffer_load_dwordx4 v0, s[12:15], s28 offen lds
    s_lshl_b32 s28, s19, 10
    s_add_u32 s28, s28, 4096
    s_add_u32 m0, s28, 0
    s_nop 0
    buffer_load_dwordx4 v0, s[12:15], s28 offen lds
    s_lshl_b32 s28, s19, 10
    s_add_u32 s28, s28, 8192
    s_add_u32 m0, s28, 0
    s_nop 0
    buffer_load_dwordx4 v0, s[12:15], s28 offen lds
    s_lshl_b32 s28, s19, 10
    s_add_u32 s28, s28, 12288
    s_add_u32 m0, s28, 0
    s_nop 0
    buffer_load_dwordx4 v0, s[12:15], s28 offen lds
    s_lshl_b32 s28, s19, 10
    s_add_u32 s28, s28, 16384
    s_add_u32 m0, s28, 0
    s_nop 0
    buffer_load_dwordx4 v0, s[12:15], s28 offen lds
    s_lshl_b32 s28, s19, 10
    s_add_u32 s28, s28, 20480
    s_add_u32 m0, s28, 0
    s_nop 0
    buffer_load_dwordx4 v0, s[12:15], s28 offen lds
    s_waitcnt vmcnt(0)
    s_barrier
    s_mov_b32 s12, s90
    s_and_b32 s13, s91, 0xffff
    s_mov_b32 s14, 20736
    s_mov_b32 s15, 0x20000
    s_lshl_b32 s28, s19, 10
    s_add_u32 s28, s28, 0
    s_add_u32 m0, s28, 20992
    s_nop 0
    buffer_load_dwordx4 v0, s[12:15], s28 offen lds
    s_lshl_b32 s28, s19, 10
    s_add_u32 s28, s28, 4096
    s_add_u32 m0, s28, 20992
    s_nop 0
    buffer_load_dwordx4 v0, s[12:15], s28 offen lds
    s_lshl_b32 s28, s19, 10
    s_add_u32 s28, s28, 8192
    s_add_u32 m0, s28, 20992
    s_nop 0
    buffer_load_dwordx4 v0, s[12:15], s28 offen lds
    s_lshl_b32 s28, s19, 10
    s_add_u32 s28, s28, 12288
    s_add_u32 m0, s28, 20992
    s_nop 0
    buffer_load_dwordx4 v0, s[12:15], s28 offen lds
    s_lshl_b32 s28, s19, 10
    s_add_u32 s28, s28, 16384
    s_add_u32 m0, s28, 20992
    s_nop 0
    buffer_load_dwordx4 v0, s[12:15], s28 offen lds
    s_lshl_b32 s28, s19, 10
    s_add_u32 s28, s28, 20480
    s_add_u32 m0, s28, 20992
    s_nop 0
    buffer_load_dwordx4 v0, s[12:15], s28 offen lds
    s_waitcnt vmcnt(0)
    s_barrier
    v_and_b32 v4, 31, v33
    v_lshrrev_b32 v5, 5, v33
    v_mul_u32_u24 v6, 288, v5
    v_lshl_add_u32 v6, v4, 1, v6
    v_mov_b64 v[64:65], 0
    v_mov_b64 v[66:67], 0
    v_mov_b64 v[68:69], 0
    v_mov_b64 v[70:71], 0
    v_mov_b64 v[72:73], 0
    v_mov_b64 v[74:75], 0
    v_mov_b64 v[76:77], 0
    v_mov_b64 v[78:79], 0
    v_mov_b64 v[80:81], 0
    v_mov_b64 v[82:83], 0
    v_mov_b64 v[84:85], 0
    v_mov_b64 v[86:87], 0
    v_mov_b64 v[88:89], 0
    v_mov_b64 v[90:91], 0
    v_mov_b64 v[92:93], 0
    v_mov_b64 v[94:95], 0
    v_mov_b64 v[96:97], 0
    v_mov_b64 v[98:99], 0
    v_mov_b64 v[100:101], 0
    v_mov_b64 v[102:103], 0
    v_mov_b64 v[104:105], 0
    v_mov_b64 v[106:107], 0
    v_mov_b64 v[108:109], 0
    v_mov_b64 v[110:111], 0
    v_mov_b64 v[112:113], 0
    v_mov_b64 v[114:115], 0
    v_mov_b64 v[116:117], 0
    v_mov_b64 v[118:119], 0
    v_mov_b64 v[120:121], 0
    v_mov_b64 v[122:123], 0
    v_mov_b64 v[124:125], 0
    v_mov_b64 v[126:127], 0
    v_mov_b64 v[128:129], 0
    v_mov_b64 v[130:131], 0
    v_mov_b64 v[132:133], 0
    v_mov_b64 v[134:135], 0
    v_mov_b64 v[136:137], 0
    v_mov_b64 v[138:139], 0
    v_mov_b64 v[140:141], 0
    v_mov_b64 v[142:143], 0
    v_mov_b64 v[144:145], 0
    v_mov_b64 v[146:147], 0
    v_mov_b64 v[148:149], 0
    v_mov_b64 v[150:151], 0
    v_mov_b64 v[152:153], 0
    v_mov_b64 v[154:155], 0
    v_mov_b64 v[156:157], 0
    v_mov_b64 v[158:159], 0
    v_mov_b64 v[160:161], 0
    v_mov_b64 v[162:163], 0
    v_mov_b64 v[164:165], 0
    v_mov_b64 v[166:167], 0
    v_mov_b64 v[168:169], 0
    v_mov_b64 v[170:171], 0
    v_mov_b64 v[172:173], 0
    v_mov_b64 v[174:175], 0
    v_mov_b64 v[176:177], 0
    v_mov_b64 v[178:179], 0
    v_mov_b64 v[180:181], 0
    v_mov_b64 v[182:183], 0
    v_mov_b64 v[184:185], 0
    v_mov_b64 v[186:187], 0
    v_mov_b64 v[188:189], 0
    v_mov_b64 v[190:191], 0
    v_mov_b64 v[192:193], 0
    v_mov_b64 v[194:195], 0
    v_mov_b64 v[196:197], 0
    v_mov_b64 v[198:199], 0
    v_mov_b64 v[200:201], 0
    v_mov_b64 v[202:203], 0
    v_mov_b64 v[204:205], 0
    v_mov_b64 v[206:207], 0
    v_accvgpr_write_b32 a0, 0
    v_accvgpr_write_b32 a1, 0
    v_accvgpr_write_b32 a2, 0
    v_accvgpr_write_b32 a3, 0
    v_accvgpr_write_b32 a4, 0
    v_accvgpr_write_b32 a5, 0
    v_accvgpr_write_b32 a6, 0
    v_accvgpr_write_b32 a7, 0
    v_accvgpr_write_b32 a8, 0
    v_accvgpr_write_b32 a9, 0
    v_accvgpr_write_b32 a10, 0
    v_accvgpr_write_b32 a11, 0
    v_accvgpr_write_b32 a12, 0
    v_accvgpr_write_b32 a13, 0
    v_accvgpr_write_b32 a14, 0
    v_accvgpr_write_b32 a15, 0
    v_accvgpr_write_b32 a16, 0
    v_accvgpr_write_b32 a17, 0
    v_accvgpr_write_b32 a18, 0
    v_accvgpr_write_b32 a19, 0
    v_accvgpr_write_b32 a20, 0
    v_accvgpr_write_b32 a21, 0
    v_accvgpr_write_b32 a22, 0
    v_accvgpr_write_b32 a23, 0
    v_accvgpr_write_b32 a24, 0
    v_accvgpr_write_b32 a25, 0
    v_accvgpr_write_b32 a26, 0
    v_accvgpr_write_b32 a27, 0
    v_accvgpr_write_b32 a28, 0
    v_accvgpr_write_b32 a29, 0
    v_accvgpr_write_b32 a30, 0
    v_accvgpr_write_b32 a31, 0
    v_accvgpr_write_b32 a32, 0
    v_accvgpr_write_b32 a33, 0
    v_accvgpr_write_b32 a34, 0
    v_accvgpr_write_b32 a35, 0
    v_accvgpr_write_b32 a36, 0
    v_accvgpr_write_b32 a37, 0
    v_accvgpr_write_b32 a38, 0
    v_accvgpr_write_b32 a39, 0
    v_accvgpr_write_b32 a40, 0
    v_accvgpr_write_b32 a41, 0
    v_accvgpr_write_b32 a42, 0
    v_accvgpr_write_b32 a43, 0
    v_accvgpr_write_b32 a44, 0
    v_accvgpr_write_b32 a45, 0
    v_accvgpr_write_b32 a46, 0
    v_accvgpr_write_b32 a47, 0
    v_accvgpr_write_b32 a48, 0
    v_accvgpr_write_b32 a49, 0
    v_accvgpr_write_b32 a50, 0
    v_accvgpr_write_b32 a51, 0
    v_accvgpr_write_b32 a52, 0
    v_accvgpr_write_b32 a53, 0
    v_accvgpr_write_b32 a54, 0
    v_accvgpr_write_b32 a55, 0
    v_accvgpr_write_b32 a56, 0
    v_accvgpr_write_b32 a57, 0
    v_accvgpr_write_b32 a58, 0
    v_accvgpr_write_b32 a59, 0
    v_accvgpr_write_b32 a60, 0
    v_accvgpr_write_b32 a61, 0
    v_accvgpr_write_b32 a62, 0
    v_accvgpr_write_b32 a63, 0
    v_accvgpr_write_b32 a64, 0
    v_accvgpr_write_b32 a65, 0
    v_accvgpr_write_b32 a66, 0
    v_accvgpr_write_b32 a67, 0
    v_accvgpr_write_b32 a68, 0
    v_accvgpr_write_b32 a69, 0
    v_accvgpr_write_b32 a70, 0
    v_accvgpr_write_b32 a71, 0
    v_accvgpr_write_b32 a72, 0
    v_accvgpr_write_b32 a73, 0
    v_accvgpr_write_b32 a74, 0
    v_accvgpr_write_b32 a75, 0
    v_accvgpr_write_b32 a76, 0
    v_accvgpr_write_b32 a77, 0
    v_accvgpr_write_b32 a78, 0
    v_accvgpr_write_b32 a79, 0
    v_accvgpr_write_b32 a80, 0
    v_accvgpr_write_b32 a81, 0
    v_accvgpr_write_b32 a82, 0
    v_accvgpr_write_b32 a83, 0
    v_accvgpr_write_b32 a84, 0
    v_accvgpr_write_b32 a85, 0
    v_accvgpr_write_b32 a86, 0
    v_accvgpr_write_b32 a87, 0
    v_accvgpr_write_b32 a88, 0
    v_accvgpr_write_b32 a89, 0
    v_accvgpr_write_b32 a90, 0
    v_accvgpr_write_b32 a91, 0
    v_accvgpr_write_b32 a92, 0
    v_accvgpr_write_b32 a93, 0
    v_accvgpr_write_b32 a94, 0
    v_accvgpr_write_b32 a95, 0
    v_accvgpr_write_b32 a96, 0
    v_accvgpr_write_b32 a97, 0
    v_accvgpr_write_b32 a98, 0
    v_accvgpr_write_b32 a99, 0
    v_accvgpr_write_b32 a100, 0
    v_accvgpr_write_b32 a101, 0
    v_accvgpr_write_b32 a102, 0
    v_accvgpr_write_b32 a103, 0
    v_accvgpr_write_b32 a104, 0
    v_accvgpr_write_b32 a105, 0
    v_accvgpr_write_b32 a106, 0
    v_accvgpr_write_b32 a107, 0
    v_accvgpr_write_b32 a108, 0
    v_accvgpr_write_b32 a109, 0
    v_accvgpr_write_b32 a110, 0
    v_accvgpr_write_b32 a111, 0
    v_accvgpr_write_b32 a112, 0
    v_accvgpr_write_b32 a113, 0
    v_accvgpr_write_b32 a114, 0
    v_accvgpr_write_b32 a115, 0
    v_accvgpr_write_b32 a116, 0
    v_accvgpr_write_b32 a117, 0
    v_accvgpr_write_b32 a118, 0
    v_accvgpr_write_b32 a119, 0
    v_accvgpr_write_b32 a120, 0
    v_accvgpr_write_b32 a121, 0
    v_accvgpr_write_b32 a122, 0
    v_accvgpr_write_b32 a123, 0
    v_accvgpr_write_b32 a124, 0
    v_accvgpr_write_b32 a125, 0
    v_accvgpr_write_b32 a126, 0
    v_accvgpr_write_b32 a127, 0
    v_accvgpr_write_b32 a128, 0
    v_accvgpr_write_b32 a129, 0
    v_accvgpr_write_b32 a130, 0
    v_accvgpr_write_b32 a131, 0
    v_accvgpr_write_b32 a132, 0
    v_accvgpr_write_b32 a133, 0
    v_accvgpr_write_b32 a134, 0
    v_accvgpr_write_b32 a135, 0
    v_accvgpr_write_b32 a136, 0
    v_accvgpr_write_b32 a137, 0
    v_accvgpr_write_b32 a138, 0
    v_accvgpr_write_b32 a139, 0
    v_accvgpr_write_b32 a140, 0
    v_accvgpr_write_b32 a141, 0
    v_accvgpr_write_b32 a142, 0
    v_accvgpr_write_b32 a143, 0
    v_cmp_gt_u32 vcc, 18, v4
    s_nop 0
    s_and_saveexec_b64 s[60:61], vcc
    ds_read_u16 v208, v6 offset:0
    ds_read_u16_d16_hi v209, v6 offset:36
    ds_read_u16 v210, v6 offset:72
    ds_read_u16_d16_hi v211, v6 offset:108
    ds_read_u16 v212, v6 offset:144
    ds_read_u16_d16_hi v213, v6 offset:180
    ds_read_u16 v214, v6 offset:216
    ds_read_u16_d16_hi v215, v6 offset:252
    s_waitcnt lgkmcnt(6)
    v_or_b32 v64, v208, v209
    s_waitcnt lgkmcnt(4)
    v_or_b32 v65, v210, v211
    s_waitcnt lgkmcnt(2)
    v_or_b32 v66, v212, v213
    s_waitcnt lgkmcnt(0)
    v_or_b32 v67, v214, v215
    ds_read_u16 v208, v6 offset:576
    ds_read_u16_d16_hi v209, v6 offset:612
    ds_read_u16 v210, v6 offset:648
    ds_read_u16_d16_hi v211, v6 offset:684
    ds_read_u16 v212, v6 offset:720
    ds_read_u16_d16_hi v213, v6 offset:756
    ds_read_u16 v214, v6 offset:792
    ds_read_u16_d16_hi v215, v6 offset:828
    s_waitcnt lgkmcnt(6)
    v_or_b32 v68, v208, v209
    s_waitcnt lgkmcnt(4)
    v_or_b32 v69, v210, v211
    s_waitcnt lgkmcnt(2)
    v_or_b32 v70, v212, v213
    s_waitcnt lgkmcnt(0)
    v_or_b32 v71, v214, v215
    ds_read_u16 v208, v6 offset:1152
    ds_read_u16_d16_hi v209, v6 offset:1188
    ds_read_u16 v210, v6 offset:1224
    ds_read_u16_d16_hi v211, v6 offset:1260
    ds_read_u16 v212, v6 offset:1296
    ds_read_u16_d16_hi v213, v6 offset:1332
    ds_read_u16 v214, v6 offset:1368
    ds_read_u16_d16_hi v215, v6 offset:1404
    s_waitcnt lgkmcnt(6)
    v_or_b32 v72, v208, v209
    s_waitcnt lgkmcnt(4)
    v_or_b32 v73, v210, v211
    s_waitcnt lgkmcnt(2)
    v_or_b32 v74, v212, v213
    s_waitcnt lgkmcnt(0)
    v_or_b32 v75, v214, v215
    ds_read_u16 v208, v6 offset:1728
    ds_read_u16_d16_hi v209, v6 offset:1764
    ds_read_u16 v210, v6 offset:1800
    ds_read_u16_d16_hi v211, v6 offset:1836
    ds_read_u16 v212, v6 offset:1872
    ds_read_u16_d16_hi v213, v6 offset:1908
    ds_read_u16 v214, v6 offset:1944
    ds_read_u16_d16_hi v215, v6 offset:1980
    s_waitcnt lgkmcnt(6)
    v_or_b32 v76, v208, v209
    s_waitcnt lgkmcnt(4)
    v_or_b32 v77, v210, v211
    s_waitcnt lgkmcnt(2)
    v_or_b32 v78, v212, v213
    s_waitcnt lgkmcnt(0)
    v_or_b32 v79, v214, v215
    ds_read_u16 v208, v6 offset:2304
    ds_read_u16_d16_hi v209, v6 offset:2340
    ds_read_u16 v210, v6 offset:2376
    ds_read_u16_d16_hi v211, v6 offset:2412
    ds_read_u16 v212, v6 offset:2448
    ds_read_u16_d16_hi v213, v6 offset:2484
    ds_read_u16 v214, v6 offset:2520
    ds_read_u16_d16_hi v215, v6 offset:2556
    s_waitcnt lgkmcnt(6)
    v_or_b32 v80, v208, v209
    s_waitcnt lgkmcnt(4)
    v_or_b32 v81, v210, v211
    s_waitcnt lgkmcnt(2)
    v_or_b32 v82, v212, v213
    s_waitcnt lgkmcnt(0)
    v_or_b32 v83, v214, v215
    ds_read_u16 v208, v6 offset:2880
    ds_read_u16_d16_hi v209, v6 offset:2916
    ds_read_u16 v210, v6 offset:2952
    ds_read_u16_d16_hi v211, v6 offset:2988
    ds_read_u16 v212, v6 offset:3024
    ds_read_u16_d16_hi v213, v6 offset:3060
    ds_read_u16 v214, v6 offset:3096
    ds_read_u16_d16_hi v215, v6 offset:3132
    s_waitcnt lgkmcnt(6)
    v_or_b32 v84, v208, v209
    s_waitcnt lgkmcnt(4)
    v_or_b32 v85, v210, v211
    s_waitcnt lgkmcnt(2)
    v_or_b32 v86, v212, v213
    s_waitcnt lgkmcnt(0)
    v_or_b32 v87, v214, v215
    ds_read_u16 v208, v6 offset:3456
    ds_read_u16_d16_hi v209, v6 offset:3492
    ds_read_u16 v210, v6 offset:3528
    ds_read_u16_d16_hi v211, v6 offset:3564
    ds_read_u16 v212, v6 offset:3600
    ds_read_u16_d16_hi v213, v6 offset:3636
    ds_read_u16 v214, v6 offset:3672
    ds_read_u16_d16_hi v215, v6 offset:3708
    s_waitcnt lgkmcnt(6)
    v_or_b32 v88, v208, v209
    s_waitcnt lgkmcnt(4)
    v_or_b32 v89, v210, v211
    s_waitcnt lgkmcnt(2)
    v_or_b32 v90, v212, v213
    s_waitcnt lgkmcnt(0)
    v_or_b32 v91, v214, v215
    ds_read_u16 v208, v6 offset:4032
    ds_read_u16_d16_hi v209, v6 offset:4068
    ds_read_u16 v210, v6 offset:4104
    ds_read_u16_d16_hi v211, v6 offset:4140
    ds_read_u16 v212, v6 offset:4176
    ds_read_u16_d16_hi v213, v6 offset:4212
    ds_read_u16 v214, v6 offset:4248
    ds_read_u16_d16_hi v215, v6 offset:4284
    s_waitcnt lgkmcnt(6)
    v_or_b32 v92, v208, v209
    s_waitcnt lgkmcnt(4)
    v_or_b32 v93, v210, v211
    s_waitcnt lgkmcnt(2)
    v_or_b32 v94, v212, v213
    s_waitcnt lgkmcnt(0)
    v_or_b32 v95, v214, v215
    ds_read_u16 v208, v6 offset:4608
    ds_read_u16_d16_hi v209, v6 offset:4644
    ds_read_u16 v210, v6 offset:4680
    ds_read_u16_d16_hi v211, v6 offset:4716
    ds_read_u16 v212, v6 offset:4752
    ds_read_u16_d16_hi v213, v6 offset:4788
    ds_read_u16 v214, v6 offset:4824
    ds_read_u16_d16_hi v215, v6 offset:4860
    s_waitcnt lgkmcnt(6)
    v_or_b32 v96, v208, v209
    s_waitcnt lgkmcnt(4)
    v_or_b32 v97, v210, v211
    s_waitcnt lgkmcnt(2)
    v_or_b32 v98, v212, v213
    s_waitcnt lgkmcnt(0)
    v_or_b32 v99, v214, v215
    ds_read_u16 v208, v6 offset:5184
    ds_read_u16_d16_hi v209, v6 offset:5220
    ds_read_u16 v210, v6 offset:5256
    ds_read_u16_d16_hi v211, v6 offset:5292
    ds_read_u16 v212, v6 offset:5328
    ds_read_u16_d16_hi v213, v6 offset:5364
    ds_read_u16 v214, v6 offset:5400
    ds_read_u16_d16_hi v215, v6 offset:5436
    s_waitcnt lgkmcnt(6)
    v_or_b32 v100, v208, v209
    s_waitcnt lgkmcnt(4)
    v_or_b32 v101, v210, v211
    s_waitcnt lgkmcnt(2)
    v_or_b32 v102, v212, v213
    s_waitcnt lgkmcnt(0)
    v_or_b32 v103, v214, v215
    ds_read_u16 v208, v6 offset:5760
    ds_read_u16_d16_hi v209, v6 offset:5796
    ds_read_u16 v210, v6 offset:5832
    ds_read_u16_d16_hi v211, v6 offset:5868
    ds_read_u16 v212, v6 offset:5904
    ds_read_u16_d16_hi v213, v6 offset:5940
    ds_read_u16 v214, v6 offset:5976
    ds_read_u16_d16_hi v215, v6 offset:6012
    s_waitcnt lgkmcnt(6)
    v_or_b32 v104, v208, v209
    s_waitcnt lgkmcnt(4)
    v_or_b32 v105, v210, v211
    s_waitcnt lgkmcnt(2)
    v_or_b32 v106, v212, v213
    s_waitcnt lgkmcnt(0)
    v_or_b32 v107, v214, v215
    ds_read_u16 v208, v6 offset:6336
    ds_read_u16_d16_hi v209, v6 offset:6372
    ds_read_u16 v210, v6 offset:6408
    ds_read_u16_d16_hi v211, v6 offset:6444
    ds_read_u16 v212, v6 offset:6480
    ds_read_u16_d16_hi v213, v6 offset:6516
    ds_read_u16 v214, v6 offset:6552
    ds_read_u16_d16_hi v215, v6 offset:6588
    s_waitcnt lgkmcnt(6)
    v_or_b32 v108, v208, v209
    s_waitcnt lgkmcnt(4)
    v_or_b32 v109, v210, v211
    s_waitcnt lgkmcnt(2)
    v_or_b32 v110, v212, v213
    s_waitcnt lgkmcnt(0)
    v_or_b32 v111, v214, v215
    ds_read_u16 v208, v6 offset:6912
    ds_read_u16_d16_hi v209, v6 offset:6948
    ds_read_u16 v210, v6 offset:6984
    ds_read_u16_d16_hi v211, v6 offset:7020
    ds_read_u16 v212, v6 offset:7056
    ds_read_u16_d16_hi v213, v6 offset:7092
    ds_read_u16 v214, v6 offset:7128
    ds_read_u16_d16_hi v215, v6 offset:7164
    s_waitcnt lgkmcnt(6)
    v_or_b32 v112, v208, v209
    s_waitcnt lgkmcnt(4)
    v_or_b32 v113, v210, v211
    s_waitcnt lgkmcnt(2)
    v_or_b32 v114, v212, v213
    s_waitcnt lgkmcnt(0)
    v_or_b32 v115, v214, v215
    ds_read_u16 v208, v6 offset:7488
    ds_read_u16_d16_hi v209, v6 offset:7524
    ds_read_u16 v210, v6 offset:7560
    ds_read_u16_d16_hi v211, v6 offset:7596
    ds_read_u16 v212, v6 offset:7632
    ds_read_u16_d16_hi v213, v6 offset:7668
    ds_read_u16 v214, v6 offset:7704
    ds_read_u16_d16_hi v215, v6 offset:7740
    s_waitcnt lgkmcnt(6)
    v_or_b32 v116, v208, v209
    s_waitcnt lgkmcnt(4)
    v_or_b32 v117, v210, v211
    s_waitcnt lgkmcnt(2)
    v_or_b32 v118, v212, v213
    s_waitcnt lgkmcnt(0)
    v_or_b32 v119, v214, v215
    ds_read_u16 v208, v6 offset:8064
    ds_read_u16_d16_hi v209, v6 offset:8100
    ds_read_u16 v210, v6 offset:8136
    ds_read_u16_d16_hi v211, v6 offset:8172
    ds_read_u16 v212, v6 offset:8208
    ds_read_u16_d16_hi v213, v6 offset:8244
    ds_read_u16 v214, v6 offset:8280
    ds_read_u16_d16_hi v215, v6 offset:8316
    s_waitcnt lgkmcnt(6)
    v_or_b32 v120, v208, v209
    s_waitcnt lgkmcnt(4)
    v_or_b32 v121, v210, v211
    s_waitcnt lgkmcnt(2)
    v_or_b32 v122, v212, v213
    s_waitcnt lgkmcnt(0)
    v_or_b32 v123, v214, v215
    ds_read_u16 v208, v6 offset:8640
    ds_read_u16_d16_hi v209, v6 offset:8676
    ds_read_u16 v210, v6 offset:8712
    ds_read_u16_d16_hi v211, v6 offset:8748
    ds_read_u16 v212, v6 offset:8784
    ds_read_u16_d16_hi v213, v6 offset:8820
    ds_read_u16 v214, v6 offset:8856
    ds_read_u16_d16_hi v215, v6 offset:8892
    s_waitcnt lgkmcnt(6)
    v_or_b32 v124, v208, v209
    s_waitcnt lgkmcnt(4)
    v_or_b32 v125, v210, v211
    s_waitcnt lgkmcnt(2)
    v_or_b32 v126, v212, v213
    s_waitcnt lgkmcnt(0)
    v_or_b32 v127, v214, v215
    ds_read_u16 v208, v6 offset:9216
    ds_read_u16_d16_hi v209, v6 offset:9252
    ds_read_u16 v210, v6 offset:9288
    ds_read_u16_d16_hi v211, v6 offset:9324
    ds_read_u16 v212, v6 offset:9360
    ds_read_u16_d16_hi v213, v6 offset:9396
    ds_read_u16 v214, v6 offset:9432
    ds_read_u16_d16_hi v215, v6 offset:9468
    s_waitcnt lgkmcnt(6)
    v_or_b32 v128, v208, v209
    s_waitcnt lgkmcnt(4)
    v_or_b32 v129, v210, v211
    s_waitcnt lgkmcnt(2)
    v_or_b32 v130, v212, v213
    s_waitcnt lgkmcnt(0)
    v_or_b32 v131, v214, v215
    ds_read_u16 v208, v6 offset:9792
    ds_read_u16_d16_hi v209, v6 offset:9828
    ds_read_u16 v210, v6 offset:9864
    ds_read_u16_d16_hi v211, v6 offset:9900
    ds_read_u16 v212, v6 offset:9936
    ds_read_u16_d16_hi v213, v6 offset:9972
    ds_read_u16 v214, v6 offset:10008
    ds_read_u16_d16_hi v215, v6 offset:10044
    s_waitcnt lgkmcnt(6)
    v_or_b32 v132, v208, v209
    s_waitcnt lgkmcnt(4)
    v_or_b32 v133, v210, v211
    s_waitcnt lgkmcnt(2)
    v_or_b32 v134, v212, v213
    s_waitcnt lgkmcnt(0)
    v_or_b32 v135, v214, v215
    ds_read_u16 v208, v6 offset:10368
    ds_read_u16_d16_hi v209, v6 offset:10404
    ds_read_u16 v210, v6 offset:10440
    ds_read_u16_d16_hi v211, v6 offset:10476
    ds_read_u16 v212, v6 offset:10512
    ds_read_u16_d16_hi v213, v6 offset:10548
    ds_read_u16 v214, v6 offset:10584
    ds_read_u16_d16_hi v215, v6 offset:10620
    s_waitcnt lgkmcnt(6)
    v_or_b32 v136, v208, v209
    s_waitcnt lgkmcnt(4)
    v_or_b32 v137, v210, v211
    s_waitcnt lgkmcnt(2)
    v_or_b32 v138, v212, v213
    s_waitcnt lgkmcnt(0)
    v_or_b32 v139, v214, v215
    ds_read_u16 v208, v6 offset:10944
    ds_read_u16_d16_hi v209, v6 offset:10980
    ds_read_u16 v210, v6 offset:11016
    ds_read_u16_d16_hi v211, v6 offset:11052
    ds_read_u16 v212, v6 offset:11088
    ds_read_u16_d16_hi v213, v6 offset:11124
    ds_read_u16 v214, v6 offset:11160
    ds_read_u16_d16_hi v215, v6 offset:11196
    s_waitcnt lgkmcnt(6)
    v_or_b32 v140, v208, v209
    s_waitcnt lgkmcnt(4)
    v_or_b32 v141, v210, v211
    s_waitcnt lgkmcnt(2)
    v_or_b32 v142, v212, v213
    s_waitcnt lgkmcnt(0)
    v_or_b32 v143, v214, v215
    ds_read_u16 v208, v6 offset:11520
    ds_read_u16_d16_hi v209, v6 offset:11556
    ds_read_u16 v210, v6 offset:11592
    ds_read_u16_d16_hi v211, v6 offset:11628
    ds_read_u16 v212, v6 offset:11664
    ds_read_u16_d16_hi v213, v6 offset:11700
    ds_read_u16 v214, v6 offset:11736
    ds_read_u16_d16_hi v215, v6 offset:11772
    s_waitcnt lgkmcnt(6)
    v_or_b32 v144, v208, v209
    s_waitcnt lgkmcnt(4)
    v_or_b32 v145, v210, v211
    s_waitcnt lgkmcnt(2)
    v_or_b32 v146, v212, v213
    s_waitcnt lgkmcnt(0)
    v_or_b32 v147, v214, v215
    ds_read_u16 v208, v6 offset:12096
    ds_read_u16_d16_hi v209, v6 offset:12132
    ds_read_u16 v210, v6 offset:12168
    ds_read_u16_d16_hi v211, v6 offset:12204
    ds_read_u16 v212, v6 offset:12240
    ds_read_u16_d16_hi v213, v6 offset:12276
    ds_read_u16 v214, v6 offset:12312
    ds_read_u16_d16_hi v215, v6 offset:12348
    s_waitcnt lgkmcnt(6)
    v_or_b32 v148, v208, v209
    s_waitcnt lgkmcnt(4)
    v_or_b32 v149, v210, v211
    s_waitcnt lgkmcnt(2)
    v_or_b32 v150, v212, v213
    s_waitcnt lgkmcnt(0)
    v_or_b32 v151, v214, v215
    ds_read_u16 v208, v6 offset:12672
    ds_read_u16_d16_hi v209, v6 offset:12708
    ds_read_u16 v210, v6 offset:12744
    ds_read_u16_d16_hi v211, v6 offset:12780
    ds_read_u16 v212, v6 offset:12816
    ds_read_u16_d16_hi v213, v6 offset:12852
    ds_read_u16 v214, v6 offset:12888
    ds_read_u16_d16_hi v215, v6 offset:12924
    s_waitcnt lgkmcnt(6)
    v_or_b32 v152, v208, v209
    s_waitcnt lgkmcnt(4)
    v_or_b32 v153, v210, v211
    s_waitcnt lgkmcnt(2)
    v_or_b32 v154, v212, v213
    s_waitcnt lgkmcnt(0)
    v_or_b32 v155, v214, v215
    ds_read_u16 v208, v6 offset:13248
    ds_read_u16_d16_hi v209, v6 offset:13284
    ds_read_u16 v210, v6 offset:13320
    ds_read_u16_d16_hi v211, v6 offset:13356
    ds_read_u16 v212, v6 offset:13392
    ds_read_u16_d16_hi v213, v6 offset:13428
    ds_read_u16 v214, v6 offset:13464
    ds_read_u16_d16_hi v215, v6 offset:13500
    s_waitcnt lgkmcnt(6)
    v_or_b32 v156, v208, v209
    s_waitcnt lgkmcnt(4)
    v_or_b32 v157, v210, v211
    s_waitcnt lgkmcnt(2)
    v_or_b32 v158, v212, v213
    s_waitcnt lgkmcnt(0)
    v_or_b32 v159, v214, v215
    ds_read_u16 v208, v6 offset:13824
    ds_read_u16_d16_hi v209, v6 offset:13860
    ds_read_u16 v210, v6 offset:13896
    ds_read_u16_d16_hi v211, v6 offset:13932
    ds_read_u16 v212, v6 offset:13968
    ds_read_u16_d16_hi v213, v6 offset:14004
    ds_read_u16 v214, v6 offset:14040
    ds_read_u16_d16_hi v215, v6 offset:14076
    s_waitcnt lgkmcnt(6)
    v_or_b32 v160, v208, v209
    s_waitcnt lgkmcnt(4)
    v_or_b32 v161, v210, v211
    s_waitcnt lgkmcnt(2)
    v_or_b32 v162, v212, v213
    s_waitcnt lgkmcnt(0)
    v_or_b32 v163, v214, v215
    ds_read_u16 v208, v6 offset:14400
    ds_read_u16_d16_hi v209, v6 offset:14436
    ds_read_u16 v210, v6 offset:14472
    ds_read_u16_d16_hi v211, v6 offset:14508
    ds_read_u16 v212, v6 offset:14544
    ds_read_u16_d16_hi v213, v6 offset:14580
    ds_read_u16 v214, v6 offset:14616
    ds_read_u16_d16_hi v215, v6 offset:14652
    s_waitcnt lgkmcnt(6)
    v_or_b32 v164, v208, v209
    s_waitcnt lgkmcnt(4)
    v_or_b32 v165, v210, v211
    s_waitcnt lgkmcnt(2)
    v_or_b32 v166, v212, v213
    s_waitcnt lgkmcnt(0)
    v_or_b32 v167, v214, v215
    ds_read_u16 v208, v6 offset:14976
    ds_read_u16_d16_hi v209, v6 offset:15012
    ds_read_u16 v210, v6 offset:15048
    ds_read_u16_d16_hi v211, v6 offset:15084
    ds_read_u16 v212, v6 offset:15120
    ds_read_u16_d16_hi v213, v6 offset:15156
    ds_read_u16 v214, v6 offset:15192
    ds_read_u16_d16_hi v215, v6 offset:15228
    s_waitcnt lgkmcnt(6)
    v_or_b32 v168, v208, v209
    s_waitcnt lgkmcnt(4)
    v_or_b32 v169, v210, v211
    s_waitcnt lgkmcnt(2)
    v_or_b32 v170, v212, v213
    s_waitcnt lgkmcnt(0)
    v_or_b32 v171, v214, v215
    ds_read_u16 v208, v6 offset:15552
    ds_read_u16_d16_hi v209, v6 offset:15588
    ds_read_u16 v210, v6 offset:15624
    ds_read_u16_d16_hi v211, v6 offset:15660
    ds_read_u16 v212, v6 offset:15696
    ds_read_u16_d16_hi v213, v6 offset:15732
    ds_read_u16 v214, v6 offset:15768
    ds_read_u16_d16_hi v215, v6 offset:15804
    s_waitcnt lgkmcnt(6)
    v_or_b32 v172, v208, v209
    s_waitcnt lgkmcnt(4)
    v_or_b32 v173, v210, v211
    s_waitcnt lgkmcnt(2)
    v_or_b32 v174, v212, v213
    s_waitcnt lgkmcnt(0)
    v_or_b32 v175, v214, v215
    ds_read_u16 v208, v6 offset:16128
    ds_read_u16_d16_hi v209, v6 offset:16164
    ds_read_u16 v210, v6 offset:16200
    ds_read_u16_d16_hi v211, v6 offset:16236
    ds_read_u16 v212, v6 offset:16272
    ds_read_u16_d16_hi v213, v6 offset:16308
    ds_read_u16 v214, v6 offset:16344
    ds_read_u16_d16_hi v215, v6 offset:16380
    s_waitcnt lgkmcnt(6)
    v_or_b32 v176, v208, v209
    s_waitcnt lgkmcnt(4)
    v_or_b32 v177, v210, v211
    s_waitcnt lgkmcnt(2)
    v_or_b32 v178, v212, v213
    s_waitcnt lgkmcnt(0)
    v_or_b32 v179, v214, v215
    ds_read_u16 v208, v6 offset:16704
    ds_read_u16_d16_hi v209, v6 offset:16740
    ds_read_u16 v210, v6 offset:16776
    ds_read_u16_d16_hi v211, v6 offset:16812
    ds_read_u16 v212, v6 offset:16848
    ds_read_u16_d16_hi v213, v6 offset:16884
    ds_read_u16 v214, v6 offset:16920
    ds_read_u16_d16_hi v215, v6 offset:16956
    s_waitcnt lgkmcnt(6)
    v_or_b32 v180, v208, v209
    s_waitcnt lgkmcnt(4)
    v_or_b32 v181, v210, v211
    s_waitcnt lgkmcnt(2)
    v_or_b32 v182, v212, v213
    s_waitcnt lgkmcnt(0)
    v_or_b32 v183, v214, v215
    ds_read_u16 v208, v6 offset:17280
    ds_read_u16_d16_hi v209, v6 offset:17316
    ds_read_u16 v210, v6 offset:17352
    ds_read_u16_d16_hi v211, v6 offset:17388
    ds_read_u16 v212, v6 offset:17424
    ds_read_u16_d16_hi v213, v6 offset:17460
    ds_read_u16 v214, v6 offset:17496
    ds_read_u16_d16_hi v215, v6 offset:17532
    s_waitcnt lgkmcnt(6)
    v_or_b32 v184, v208, v209
    s_waitcnt lgkmcnt(4)
    v_or_b32 v185, v210, v211
    s_waitcnt lgkmcnt(2)
    v_or_b32 v186, v212, v213
    s_waitcnt lgkmcnt(0)
    v_or_b32 v187, v214, v215
    ds_read_u16 v208, v6 offset:17856
    ds_read_u16_d16_hi v209, v6 offset:17892
    ds_read_u16 v210, v6 offset:17928
    ds_read_u16_d16_hi v211, v6 offset:17964
    ds_read_u16 v212, v6 offset:18000
    ds_read_u16_d16_hi v213, v6 offset:18036
    ds_read_u16 v214, v6 offset:18072
    ds_read_u16_d16_hi v215, v6 offset:18108
    s_waitcnt lgkmcnt(6)
    v_or_b32 v188, v208, v209
    s_waitcnt lgkmcnt(4)
    v_or_b32 v189, v210, v211
    s_waitcnt lgkmcnt(2)
    v_or_b32 v190, v212, v213
    s_waitcnt lgkmcnt(0)
    v_or_b32 v191, v214, v215
    ds_read_u16 v208, v6 offset:18432
    ds_read_u16_d16_hi v209, v6 offset:18468
    ds_read_u16 v210, v6 offset:18504
    ds_read_u16_d16_hi v211, v6 offset:18540
    ds_read_u16 v212, v6 offset:18576
    ds_read_u16_d16_hi v213, v6 offset:18612
    ds_read_u16 v214, v6 offset:18648
    ds_read_u16_d16_hi v215, v6 offset:18684
    s_waitcnt lgkmcnt(6)
    v_or_b32 v192, v208, v209
    s_waitcnt lgkmcnt(4)
    v_or_b32 v193, v210, v211
    s_waitcnt lgkmcnt(2)
    v_or_b32 v194, v212, v213
    s_waitcnt lgkmcnt(0)
    v_or_b32 v195, v214, v215
    ds_read_u16 v208, v6 offset:19008
    ds_read_u16_d16_hi v209, v6 offset:19044
    ds_read_u16 v210, v6 offset:19080
    ds_read_u16_d16_hi v211, v6 offset:19116
    ds_read_u16 v212, v6 offset:19152
    ds_read_u16_d16_hi v213, v6 offset:19188
    ds_read_u16 v214, v6 offset:19224
    ds_read_u16_d16_hi v215, v6 offset:19260
    s_waitcnt lgkmcnt(6)
    v_or_b32 v196, v208, v209
    s_waitcnt lgkmcnt(4)
    v_or_b32 v197, v210, v211
    s_waitcnt lgkmcnt(2)
    v_or_b32 v198, v212, v213
    s_waitcnt lgkmcnt(0)
    v_or_b32 v199, v214, v215
    ds_read_u16 v208, v6 offset:19584
    ds_read_u16_d16_hi v209, v6 offset:19620
    ds_read_u16 v210, v6 offset:19656
    ds_read_u16_d16_hi v211, v6 offset:19692
    ds_read_u16 v212, v6 offset:19728
    ds_read_u16_d16_hi v213, v6 offset:19764
    ds_read_u16 v214, v6 offset:19800
    ds_read_u16_d16_hi v215, v6 offset:19836
    s_waitcnt lgkmcnt(6)
    v_or_b32 v200, v208, v209
    s_waitcnt lgkmcnt(4)
    v_or_b32 v201, v210, v211
    s_waitcnt lgkmcnt(2)
    v_or_b32 v202, v212, v213
    s_waitcnt lgkmcnt(0)
    v_or_b32 v203, v214, v215
    ds_read_u16 v208, v6 offset:20160
    ds_read_u16_d16_hi v209, v6 offset:20196
    ds_read_u16 v210, v6 offset:20232
    ds_read_u16_d16_hi v211, v6 offset:20268
    ds_read_u16 v212, v6 offset:20304
    ds_read_u16_d16_hi v213, v6 offset:20340
    ds_read_u16 v214, v6 offset:20376
    ds_read_u16_d16_hi v215, v6 offset:20412
    s_waitcnt lgkmcnt(6)
    v_or_b32 v204, v208, v209
    s_waitcnt lgkmcnt(4)
    v_or_b32 v205, v210, v211
    s_waitcnt lgkmcnt(2)
    v_or_b32 v206, v212, v213
    s_waitcnt lgkmcnt(0)
    v_or_b32 v207, v214, v215
    ds_read_u16 v208, v6 offset:20992
    ds_read_u16_d16_hi v209, v6 offset:21028
    ds_read_u16 v210, v6 offset:21064
    ds_read_u16_d16_hi v211, v6 offset:21100
    ds_read_u16 v212, v6 offset:21136
    ds_read_u16_d16_hi v213, v6 offset:21172
    ds_read_u16 v214, v6 offset:21208
    ds_read_u16_d16_hi v215, v6 offset:21244
    s_waitcnt lgkmcnt(6)
    v_or_b32 v216, v208, v209
    v_accvgpr_write_b32 a0, v216
    s_waitcnt lgkmcnt(4)
    v_or_b32 v217, v210, v211
    v_accvgpr_write_b32 a1, v217
    s_waitcnt lgkmcnt(2)
    v_or_b32 v218, v212, v213
    v_accvgpr_write_b32 a2, v218
    s_waitcnt lgkmcnt(0)
    v_or_b32 v219, v214, v215
    v_accvgpr_write_b32 a3, v219
    ds_read_u16 v208, v6 offset:21568
    ds_read_u16_d16_hi v209, v6 offset:21604
    ds_read_u16 v210, v6 offset:21640
    ds_read_u16_d16_hi v211, v6 offset:21676
    ds_read_u16 v212, v6 offset:21712
    ds_read_u16_d16_hi v213, v6 offset:21748
    ds_read_u16 v214, v6 offset:21784
    ds_read_u16_d16_hi v215, v6 offset:21820
    s_waitcnt lgkmcnt(6)
    v_or_b32 v216, v208, v209
    v_accvgpr_write_b32 a4, v216
    s_waitcnt lgkmcnt(4)
    v_or_b32 v217, v210, v211
    v_accvgpr_write_b32 a5, v217
    s_waitcnt lgkmcnt(2)
    v_or_b32 v218, v212, v213
    v_accvgpr_write_b32 a6, v218
    s_waitcnt lgkmcnt(0)
    v_or_b32 v219, v214, v215
    v_accvgpr_write_b32 a7, v219
    ds_read_u16 v208, v6 offset:22144
    ds_read_u16_d16_hi v209, v6 offset:22180
    ds_read_u16 v210, v6 offset:22216
    ds_read_u16_d16_hi v211, v6 offset:22252
    ds_read_u16 v212, v6 offset:22288
    ds_read_u16_d16_hi v213, v6 offset:22324
    ds_read_u16 v214, v6 offset:22360
    ds_read_u16_d16_hi v215, v6 offset:22396
    s_waitcnt lgkmcnt(6)
    v_or_b32 v216, v208, v209
    v_accvgpr_write_b32 a8, v216
    s_waitcnt lgkmcnt(4)
    v_or_b32 v217, v210, v211
    v_accvgpr_write_b32 a9, v217
    s_waitcnt lgkmcnt(2)
    v_or_b32 v218, v212, v213
    v_accvgpr_write_b32 a10, v218
    s_waitcnt lgkmcnt(0)
    v_or_b32 v219, v214, v215
    v_accvgpr_write_b32 a11, v219
    ds_read_u16 v208, v6 offset:22720
    ds_read_u16_d16_hi v209, v6 offset:22756
    ds_read_u16 v210, v6 offset:22792
    ds_read_u16_d16_hi v211, v6 offset:22828
    ds_read_u16 v212, v6 offset:22864
    ds_read_u16_d16_hi v213, v6 offset:22900
    ds_read_u16 v214, v6 offset:22936
    ds_read_u16_d16_hi v215, v6 offset:22972
    s_waitcnt lgkmcnt(6)
    v_or_b32 v216, v208, v209
    v_accvgpr_write_b32 a12, v216
    s_waitcnt lgkmcnt(4)
    v_or_b32 v217, v210, v211
    v_accvgpr_write_b32 a13, v217
    s_waitcnt lgkmcnt(2)
    v_or_b32 v218, v212, v213
    v_accvgpr_write_b32 a14, v218
    s_waitcnt lgkmcnt(0)
    v_or_b32 v219, v214, v215
    v_accvgpr_write_b32 a15, v219
    ds_read_u16 v208, v6 offset:23296
    ds_read_u16_d16_hi v209, v6 offset:23332
    ds_read_u16 v210, v6 offset:23368
    ds_read_u16_d16_hi v211, v6 offset:23404
    ds_read_u16 v212, v6 offset:23440
    ds_read_u16_d16_hi v213, v6 offset:23476
    ds_read_u16 v214, v6 offset:23512
    ds_read_u16_d16_hi v215, v6 offset:23548
    s_waitcnt lgkmcnt(6)
    v_or_b32 v216, v208, v209
    v_accvgpr_write_b32 a16, v216
    s_waitcnt lgkmcnt(4)
    v_or_b32 v217, v210, v211
    v_accvgpr_write_b32 a17, v217
    s_waitcnt lgkmcnt(2)
    v_or_b32 v218, v212, v213
    v_accvgpr_write_b32 a18, v218
    s_waitcnt lgkmcnt(0)
    v_or_b32 v219, v214, v215
    v_accvgpr_write_b32 a19, v219
    ds_read_u16 v208, v6 offset:23872
    ds_read_u16_d16_hi v209, v6 offset:23908
    ds_read_u16 v210, v6 offset:23944
    ds_read_u16_d16_hi v211, v6 offset:23980
    ds_read_u16 v212, v6 offset:24016
    ds_read_u16_d16_hi v213, v6 offset:24052
    ds_read_u16 v214, v6 offset:24088
    ds_read_u16_d16_hi v215, v6 offset:24124
    s_waitcnt lgkmcnt(6)
    v_or_b32 v216, v208, v209
    v_accvgpr_write_b32 a20, v216
    s_waitcnt lgkmcnt(4)
    v_or_b32 v217, v210, v211
    v_accvgpr_write_b32 a21, v217
    s_waitcnt lgkmcnt(2)
    v_or_b32 v218, v212, v213
    v_accvgpr_write_b32 a22, v218
    s_waitcnt lgkmcnt(0)
    v_or_b32 v219, v214, v215
    v_accvgpr_write_b32 a23, v219
    ds_read_u16 v208, v6 offset:24448
    ds_read_u16_d16_hi v209, v6 offset:24484
    ds_read_u16 v210, v6 offset:24520
    ds_read_u16_d16_hi v211, v6 offset:24556
    ds_read_u16 v212, v6 offset:24592
    ds_read_u16_d16_hi v213, v6 offset:24628
    ds_read_u16 v214, v6 offset:24664
    ds_read_u16_d16_hi v215, v6 offset:24700
    s_waitcnt lgkmcnt(6)
    v_or_b32 v216, v208, v209
    v_accvgpr_write_b32 a24, v216
    s_waitcnt lgkmcnt(4)
    v_or_b32 v217, v210, v211
    v_accvgpr_write_b32 a25, v217
    s_waitcnt lgkmcnt(2)
    v_or_b32 v218, v212, v213
    v_accvgpr_write_b32 a26, v218
    s_waitcnt lgkmcnt(0)
    v_or_b32 v219, v214, v215
    v_accvgpr_write_b32 a27, v219
    ds_read_u16 v208, v6 offset:25024
    ds_read_u16_d16_hi v209, v6 offset:25060
    ds_read_u16 v210, v6 offset:25096
    ds_read_u16_d16_hi v211, v6 offset:25132
    ds_read_u16 v212, v6 offset:25168
    ds_read_u16_d16_hi v213, v6 offset:25204
    ds_read_u16 v214, v6 offset:25240
    ds_read_u16_d16_hi v215, v6 offset:25276
    s_waitcnt lgkmcnt(6)
    v_or_b32 v216, v208, v209
    v_accvgpr_write_b32 a28, v216
    s_waitcnt lgkmcnt(4)
    v_or_b32 v217, v210, v211
    v_accvgpr_write_b32 a29, v217
    s_waitcnt lgkmcnt(2)
    v_or_b32 v218, v212, v213
    v_accvgpr_write_b32 a30, v218
    s_waitcnt lgkmcnt(0)
    v_or_b32 v219, v214, v215
    v_accvgpr_write_b32 a31, v219
    ds_read_u16 v208, v6 offset:25600
    ds_read_u16_d16_hi v209, v6 offset:25636
    ds_read_u16 v210, v6 offset:25672
    ds_read_u16_d16_hi v211, v6 offset:25708
    ds_read_u16 v212, v6 offset:25744
    ds_read_u16_d16_hi v213, v6 offset:25780
    ds_read_u16 v214, v6 offset:25816
    ds_read_u16_d16_hi v215, v6 offset:25852
    s_waitcnt lgkmcnt(6)
    v_or_b32 v216, v208, v209
    v_accvgpr_write_b32 a32, v216
    s_waitcnt lgkmcnt(4)
    v_or_b32 v217, v210, v211
    v_accvgpr_write_b32 a33, v217
    s_waitcnt lgkmcnt(2)
    v_or_b32 v218, v212, v213
    v_accvgpr_write_b32 a34, v218
    s_waitcnt lgkmcnt(0)
    v_or_b32 v219, v214, v215
    v_accvgpr_write_b32 a35, v219
    ds_read_u16 v208, v6 offset:26176
    ds_read_u16_d16_hi v209, v6 offset:26212
    ds_read_u16 v210, v6 offset:26248
    ds_read_u16_d16_hi v211, v6 offset:26284
    ds_read_u16 v212, v6 offset:26320
    ds_read_u16_d16_hi v213, v6 offset:26356
    ds_read_u16 v214, v6 offset:26392
    ds_read_u16_d16_hi v215, v6 offset:26428
    s_waitcnt lgkmcnt(6)
    v_or_b32 v216, v208, v209
    v_accvgpr_write_b32 a36, v216
    s_waitcnt lgkmcnt(4)
    v_or_b32 v217, v210, v211
    v_accvgpr_write_b32 a37, v217
    s_waitcnt lgkmcnt(2)
    v_or_b32 v218, v212, v213
    v_accvgpr_write_b32 a38, v218
    s_waitcnt lgkmcnt(0)
    v_or_b32 v219, v214, v215
    v_accvgpr_write_b32 a39, v219
    ds_read_u16 v208, v6 offset:26752
    ds_read_u16_d16_hi v209, v6 offset:26788
    ds_read_u16 v210, v6 offset:26824
    ds_read_u16_d16_hi v211, v6 offset:26860
    ds_read_u16 v212, v6 offset:26896
    ds_read_u16_d16_hi v213, v6 offset:26932
    ds_read_u16 v214, v6 offset:26968
    ds_read_u16_d16_hi v215, v6 offset:27004
    s_waitcnt lgkmcnt(6)
    v_or_b32 v216, v208, v209
    v_accvgpr_write_b32 a40, v216
    s_waitcnt lgkmcnt(4)
    v_or_b32 v217, v210, v211
    v_accvgpr_write_b32 a41, v217
    s_waitcnt lgkmcnt(2)
    v_or_b32 v218, v212, v213
    v_accvgpr_write_b32 a42, v218
    s_waitcnt lgkmcnt(0)
    v_or_b32 v219, v214, v215
    v_accvgpr_write_b32 a43, v219
    ds_read_u16 v208, v6 offset:27328
    ds_read_u16_d16_hi v209, v6 offset:27364
    ds_read_u16 v210, v6 offset:27400
    ds_read_u16_d16_hi v211, v6 offset:27436
    ds_read_u16 v212, v6 offset:27472
    ds_read_u16_d16_hi v213, v6 offset:27508
    ds_read_u16 v214, v6 offset:27544
    ds_read_u16_d16_hi v215, v6 offset:27580
    s_waitcnt lgkmcnt(6)
    v_or_b32 v216, v208, v209
    v_accvgpr_write_b32 a44, v216
    s_waitcnt lgkmcnt(4)
    v_or_b32 v217, v210, v211
    v_accvgpr_write_b32 a45, v217
    s_waitcnt lgkmcnt(2)
    v_or_b32 v218, v212, v213
    v_accvgpr_write_b32 a46, v218
    s_waitcnt lgkmcnt(0)
    v_or_b32 v219, v214, v215
    v_accvgpr_write_b32 a47, v219
    ds_read_u16 v208, v6 offset:27904
    ds_read_u16_d16_hi v209, v6 offset:27940
    ds_read_u16 v210, v6 offset:27976
    ds_read_u16_d16_hi v211, v6 offset:28012
    ds_read_u16 v212, v6 offset:28048
    ds_read_u16_d16_hi v213, v6 offset:28084
    ds_read_u16 v214, v6 offset:28120
    ds_read_u16_d16_hi v215, v6 offset:28156
    s_waitcnt lgkmcnt(6)
    v_or_b32 v216, v208, v209
    v_accvgpr_write_b32 a48, v216
    s_waitcnt lgkmcnt(4)
    v_or_b32 v217, v210, v211
    v_accvgpr_write_b32 a49, v217
    s_waitcnt lgkmcnt(2)
    v_or_b32 v218, v212, v213
    v_accvgpr_write_b32 a50, v218
    s_waitcnt lgkmcnt(0)
    v_or_b32 v219, v214, v215
    v_accvgpr_write_b32 a51, v219
    ds_read_u16 v208, v6 offset:28480
    ds_read_u16_d16_hi v209, v6 offset:28516
    ds_read_u16 v210, v6 offset:28552
    ds_read_u16_d16_hi v211, v6 offset:28588
    ds_read_u16 v212, v6 offset:28624
    ds_read_u16_d16_hi v213, v6 offset:28660
    ds_read_u16 v214, v6 offset:28696
    ds_read_u16_d16_hi v215, v6 offset:28732
    s_waitcnt lgkmcnt(6)
    v_or_b32 v216, v208, v209
    v_accvgpr_write_b32 a52, v216
    s_waitcnt lgkmcnt(4)
    v_or_b32 v217, v210, v211
    v_accvgpr_write_b32 a53, v217
    s_waitcnt lgkmcnt(2)
    v_or_b32 v218, v212, v213
    v_accvgpr_write_b32 a54, v218
    s_waitcnt lgkmcnt(0)
    v_or_b32 v219, v214, v215
    v_accvgpr_write_b32 a55, v219
    ds_read_u16 v208, v6 offset:29056
    ds_read_u16_d16_hi v209, v6 offset:29092
    ds_read_u16 v210, v6 offset:29128
    ds_read_u16_d16_hi v211, v6 offset:29164
    ds_read_u16 v212, v6 offset:29200
    ds_read_u16_d16_hi v213, v6 offset:29236
    ds_read_u16 v214, v6 offset:29272
    ds_read_u16_d16_hi v215, v6 offset:29308
    s_waitcnt lgkmcnt(6)
    v_or_b32 v216, v208, v209
    v_accvgpr_write_b32 a56, v216
    s_waitcnt lgkmcnt(4)
    v_or_b32 v217, v210, v211
    v_accvgpr_write_b32 a57, v217
    s_waitcnt lgkmcnt(2)
    v_or_b32 v218, v212, v213
    v_accvgpr_write_b32 a58, v218
    s_waitcnt lgkmcnt(0)
    v_or_b32 v219, v214, v215
    v_accvgpr_write_b32 a59, v219
    ds_read_u16 v208, v6 offset:29632
    ds_read_u16_d16_hi v209, v6 offset:29668
    ds_read_u16 v210, v6 offset:29704
    ds_read_u16_d16_hi v211, v6 offset:29740
    ds_read_u16 v212, v6 offset:29776
    ds_read_u16_d16_hi v213, v6 offset:29812
    ds_read_u16 v214, v6 offset:29848
    ds_read_u16_d16_hi v215, v6 offset:29884
    s_waitcnt lgkmcnt(6)
    v_or_b32 v216, v208, v209
    v_accvgpr_write_b32 a60, v216
    s_waitcnt lgkmcnt(4)
    v_or_b32 v217, v210, v211
    v_accvgpr_write_b32 a61, v217
    s_waitcnt lgkmcnt(2)
    v_or_b32 v218, v212, v213
    v_accvgpr_write_b32 a62, v218
    s_waitcnt lgkmcnt(0)
    v_or_b32 v219, v214, v215
    v_accvgpr_write_b32 a63, v219
    ds_read_u16 v208, v6 offset:30208
    ds_read_u16_d16_hi v209, v6 offset:30244
    ds_read_u16 v210, v6 offset:30280
    ds_read_u16_d16_hi v211, v6 offset:30316
    ds_read_u16 v212, v6 offset:30352
    ds_read_u16_d16_hi v213, v6 offset:30388
    ds_read_u16 v214, v6 offset:30424
    ds_read_u16_d16_hi v215, v6 offset:30460
    s_waitcnt lgkmcnt(6)
    v_or_b32 v216, v208, v209
    v_accvgpr_write_b32 a64, v216
    s_waitcnt lgkmcnt(4)
    v_or_b32 v217, v210, v211
    v_accvgpr_write_b32 a65, v217
    s_waitcnt lgkmcnt(2)
    v_or_b32 v218, v212, v213
    v_accvgpr_write_b32 a66, v218
    s_waitcnt lgkmcnt(0)
    v_or_b32 v219, v214, v215
    v_accvgpr_write_b32 a67, v219
    ds_read_u16 v208, v6 offset:30784
    ds_read_u16_d16_hi v209, v6 offset:30820
    ds_read_u16 v210, v6 offset:30856
    ds_read_u16_d16_hi v211, v6 offset:30892
    ds_read_u16 v212, v6 offset:30928
    ds_read_u16_d16_hi v213, v6 offset:30964
    ds_read_u16 v214, v6 offset:31000
    ds_read_u16_d16_hi v215, v6 offset:31036
    s_waitcnt lgkmcnt(6)
    v_or_b32 v216, v208, v209
    v_accvgpr_write_b32 a68, v216
    s_waitcnt lgkmcnt(4)
    v_or_b32 v217, v210, v211
    v_accvgpr_write_b32 a69, v217
    s_waitcnt lgkmcnt(2)
    v_or_b32 v218, v212, v213
    v_accvgpr_write_b32 a70, v218
    s_waitcnt lgkmcnt(0)
    v_or_b32 v219, v214, v215
    v_accvgpr_write_b32 a71, v219
    ds_read_u16 v208, v6 offset:31360
    ds_read_u16_d16_hi v209, v6 offset:31396
    ds_read_u16 v210, v6 offset:31432
    ds_read_u16_d16_hi v211, v6 offset:31468
    ds_read_u16 v212, v6 offset:31504
    ds_read_u16_d16_hi v213, v6 offset:31540
    ds_read_u16 v214, v6 offset:31576
    ds_read_u16_d16_hi v215, v6 offset:31612
    s_waitcnt lgkmcnt(6)
    v_or_b32 v216, v208, v209
    v_accvgpr_write_b32 a72, v216
    s_waitcnt lgkmcnt(4)
    v_or_b32 v217, v210, v211
    v_accvgpr_write_b32 a73, v217
    s_waitcnt lgkmcnt(2)
    v_or_b32 v218, v212, v213
    v_accvgpr_write_b32 a74, v218
    s_waitcnt lgkmcnt(0)
    v_or_b32 v219, v214, v215
    v_accvgpr_write_b32 a75, v219
    ds_read_u16 v208, v6 offset:31936
    ds_read_u16_d16_hi v209, v6 offset:31972
    ds_read_u16 v210, v6 offset:32008
    ds_read_u16_d16_hi v211, v6 offset:32044
    ds_read_u16 v212, v6 offset:32080
    ds_read_u16_d16_hi v213, v6 offset:32116
    ds_read_u16 v214, v6 offset:32152
    ds_read_u16_d16_hi v215, v6 offset:32188
    s_waitcnt lgkmcnt(6)
    v_or_b32 v216, v208, v209
    v_accvgpr_write_b32 a76, v216
    s_waitcnt lgkmcnt(4)
    v_or_b32 v217, v210, v211
    v_accvgpr_write_b32 a77, v217
    s_waitcnt lgkmcnt(2)
    v_or_b32 v218, v212, v213
    v_accvgpr_write_b32 a78, v218
    s_waitcnt lgkmcnt(0)
    v_or_b32 v219, v214, v215
    v_accvgpr_write_b32 a79, v219
    ds_read_u16 v208, v6 offset:32512
    ds_read_u16_d16_hi v209, v6 offset:32548
    ds_read_u16 v210, v6 offset:32584
    ds_read_u16_d16_hi v211, v6 offset:32620
    ds_read_u16 v212, v6 offset:32656
    ds_read_u16_d16_hi v213, v6 offset:32692
    ds_read_u16 v214, v6 offset:32728
    ds_read_u16_d16_hi v215, v6 offset:32764
    s_waitcnt lgkmcnt(6)
    v_or_b32 v216, v208, v209
    v_accvgpr_write_b32 a80, v216
    s_waitcnt lgkmcnt(4)
    v_or_b32 v217, v210, v211
    v_accvgpr_write_b32 a81, v217
    s_waitcnt lgkmcnt(2)
    v_or_b32 v218, v212, v213
    v_accvgpr_write_b32 a82, v218
    s_waitcnt lgkmcnt(0)
    v_or_b32 v219, v214, v215
    v_accvgpr_write_b32 a83, v219
    ds_read_u16 v208, v6 offset:33088
    ds_read_u16_d16_hi v209, v6 offset:33124
    ds_read_u16 v210, v6 offset:33160
    ds_read_u16_d16_hi v211, v6 offset:33196
    ds_read_u16 v212, v6 offset:33232
    ds_read_u16_d16_hi v213, v6 offset:33268
    ds_read_u16 v214, v6 offset:33304
    ds_read_u16_d16_hi v215, v6 offset:33340
    s_waitcnt lgkmcnt(6)
    v_or_b32 v216, v208, v209
    v_accvgpr_write_b32 a84, v216
    s_waitcnt lgkmcnt(4)
    v_or_b32 v217, v210, v211
    v_accvgpr_write_b32 a85, v217
    s_waitcnt lgkmcnt(2)
    v_or_b32 v218, v212, v213
    v_accvgpr_write_b32 a86, v218
    s_waitcnt lgkmcnt(0)
    v_or_b32 v219, v214, v215
    v_accvgpr_write_b32 a87, v219
    ds_read_u16 v208, v6 offset:33664
    ds_read_u16_d16_hi v209, v6 offset:33700
    ds_read_u16 v210, v6 offset:33736
    ds_read_u16_d16_hi v211, v6 offset:33772
    ds_read_u16 v212, v6 offset:33808
    ds_read_u16_d16_hi v213, v6 offset:33844
    ds_read_u16 v214, v6 offset:33880
    ds_read_u16_d16_hi v215, v6 offset:33916
    s_waitcnt lgkmcnt(6)
    v_or_b32 v216, v208, v209
    v_accvgpr_write_b32 a88, v216
    s_waitcnt lgkmcnt(4)
    v_or_b32 v217, v210, v211
    v_accvgpr_write_b32 a89, v217
    s_waitcnt lgkmcnt(2)
    v_or_b32 v218, v212, v213
    v_accvgpr_write_b32 a90, v218
    s_waitcnt lgkmcnt(0)
    v_or_b32 v219, v214, v215
    v_accvgpr_write_b32 a91, v219
    ds_read_u16 v208, v6 offset:34240
    ds_read_u16_d16_hi v209, v6 offset:34276
    ds_read_u16 v210, v6 offset:34312
    ds_read_u16_d16_hi v211, v6 offset:34348
    ds_read_u16 v212, v6 offset:34384
    ds_read_u16_d16_hi v213, v6 offset:34420
    ds_read_u16 v214, v6 offset:34456
    ds_read_u16_d16_hi v215, v6 offset:34492
    s_waitcnt lgkmcnt(6)
    v_or_b32 v216, v208, v209
    v_accvgpr_write_b32 a92, v216
    s_waitcnt lgkmcnt(4)
    v_or_b32 v217, v210, v211
    v_accvgpr_write_b32 a93, v217
    s_waitcnt lgkmcnt(2)
    v_or_b32 v218, v212, v213
    v_accvgpr_write_b32 a94, v218
    s_waitcnt lgkmcnt(0)
    v_or_b32 v219, v214, v215
    v_accvgpr_write_b32 a95, v219
    ds_read_u16 v208, v6 offset:34816
    ds_read_u16_d16_hi v209, v6 offset:34852
    ds_read_u16 v210, v6 offset:34888
    ds_read_u16_d16_hi v211, v6 offset:34924
    ds_read_u16 v212, v6 offset:34960
    ds_read_u16_d16_hi v213, v6 offset:34996
    ds_read_u16 v214, v6 offset:35032
    ds_read_u16_d16_hi v215, v6 offset:35068
    s_waitcnt lgkmcnt(6)
    v_or_b32 v216, v208, v209
    v_accvgpr_write_b32 a96, v216
    s_waitcnt lgkmcnt(4)
    v_or_b32 v217, v210, v211
    v_accvgpr_write_b32 a97, v217
    s_waitcnt lgkmcnt(2)
    v_or_b32 v218, v212, v213
    v_accvgpr_write_b32 a98, v218
    s_waitcnt lgkmcnt(0)
    v_or_b32 v219, v214, v215
    v_accvgpr_write_b32 a99, v219
    ds_read_u16 v208, v6 offset:35392
    ds_read_u16_d16_hi v209, v6 offset:35428
    ds_read_u16 v210, v6 offset:35464
    ds_read_u16_d16_hi v211, v6 offset:35500
    ds_read_u16 v212, v6 offset:35536
    ds_read_u16_d16_hi v213, v6 offset:35572
    ds_read_u16 v214, v6 offset:35608
    ds_read_u16_d16_hi v215, v6 offset:35644
    s_waitcnt lgkmcnt(6)
    v_or_b32 v216, v208, v209
    v_accvgpr_write_b32 a100, v216
    s_waitcnt lgkmcnt(4)
    v_or_b32 v217, v210, v211
    v_accvgpr_write_b32 a101, v217
    s_waitcnt lgkmcnt(2)
    v_or_b32 v218, v212, v213
    v_accvgpr_write_b32 a102, v218
    s_waitcnt lgkmcnt(0)
    v_or_b32 v219, v214, v215
    v_accvgpr_write_b32 a103, v219
    ds_read_u16 v208, v6 offset:35968
    ds_read_u16_d16_hi v209, v6 offset:36004
    ds_read_u16 v210, v6 offset:36040
    ds_read_u16_d16_hi v211, v6 offset:36076
    ds_read_u16 v212, v6 offset:36112
    ds_read_u16_d16_hi v213, v6 offset:36148
    ds_read_u16 v214, v6 offset:36184
    ds_read_u16_d16_hi v215, v6 offset:36220
    s_waitcnt lgkmcnt(6)
    v_or_b32 v216, v208, v209
    v_accvgpr_write_b32 a104, v216
    s_waitcnt lgkmcnt(4)
    v_or_b32 v217, v210, v211
    v_accvgpr_write_b32 a105, v217
    s_waitcnt lgkmcnt(2)
    v_or_b32 v218, v212, v213
    v_accvgpr_write_b32 a106, v218
    s_waitcnt lgkmcnt(0)
    v_or_b32 v219, v214, v215
    v_accvgpr_write_b32 a107, v219
    ds_read_u16 v208, v6 offset:36544
    ds_read_u16_d16_hi v209, v6 offset:36580
    ds_read_u16 v210, v6 offset:36616
    ds_read_u16_d16_hi v211, v6 offset:36652
    ds_read_u16 v212, v6 offset:36688
    ds_read_u16_d16_hi v213, v6 offset:36724
    ds_read_u16 v214, v6 offset:36760
    ds_read_u16_d16_hi v215, v6 offset:36796
    s_waitcnt lgkmcnt(6)
    v_or_b32 v216, v208, v209
    v_accvgpr_write_b32 a108, v216
    s_waitcnt lgkmcnt(4)
    v_or_b32 v217, v210, v211
    v_accvgpr_write_b32 a109, v217
    s_waitcnt lgkmcnt(2)
    v_or_b32 v218, v212, v213
    v_accvgpr_write_b32 a110, v218
    s_waitcnt lgkmcnt(0)
    v_or_b32 v219, v214, v215
    v_accvgpr_write_b32 a111, v219
    ds_read_u16 v208, v6 offset:37120
    ds_read_u16_d16_hi v209, v6 offset:37156
    ds_read_u16 v210, v6 offset:37192
    ds_read_u16_d16_hi v211, v6 offset:37228
    ds_read_u16 v212, v6 offset:37264
    ds_read_u16_d16_hi v213, v6 offset:37300
    ds_read_u16 v214, v6 offset:37336
    ds_read_u16_d16_hi v215, v6 offset:37372
    s_waitcnt lgkmcnt(6)
    v_or_b32 v216, v208, v209
    v_accvgpr_write_b32 a112, v216
    s_waitcnt lgkmcnt(4)
    v_or_b32 v217, v210, v211
    v_accvgpr_write_b32 a113, v217
    s_waitcnt lgkmcnt(2)
    v_or_b32 v218, v212, v213
    v_accvgpr_write_b32 a114, v218
    s_waitcnt lgkmcnt(0)
    v_or_b32 v219, v214, v215
    v_accvgpr_write_b32 a115, v219
    ds_read_u16 v208, v6 offset:37696
    ds_read_u16_d16_hi v209, v6 offset:37732
    ds_read_u16 v210, v6 offset:37768
    ds_read_u16_d16_hi v211, v6 offset:37804
    ds_read_u16 v212, v6 offset:37840
    ds_read_u16_d16_hi v213, v6 offset:37876
    ds_read_u16 v214, v6 offset:37912
    ds_read_u16_d16_hi v215, v6 offset:37948
    s_waitcnt lgkmcnt(6)
    v_or_b32 v216, v208, v209
    v_accvgpr_write_b32 a116, v216
    s_waitcnt lgkmcnt(4)
    v_or_b32 v217, v210, v211
    v_accvgpr_write_b32 a117, v217
    s_waitcnt lgkmcnt(2)
    v_or_b32 v218, v212, v213
    v_accvgpr_write_b32 a118, v218
    s_waitcnt lgkmcnt(0)
    v_or_b32 v219, v214, v215
    v_accvgpr_write_b32 a119, v219
    ds_read_u16 v208, v6 offset:38272
    ds_read_u16_d16_hi v209, v6 offset:38308
    ds_read_u16 v210, v6 offset:38344
    ds_read_u16_d16_hi v211, v6 offset:38380
    ds_read_u16 v212, v6 offset:38416
    ds_read_u16_d16_hi v213, v6 offset:38452
    ds_read_u16 v214, v6 offset:38488
    ds_read_u16_d16_hi v215, v6 offset:38524
    s_waitcnt lgkmcnt(6)
    v_or_b32 v216, v208, v209
    v_accvgpr_write_b32 a120, v216
    s_waitcnt lgkmcnt(4)
    v_or_b32 v217, v210, v211
    v_accvgpr_write_b32 a121, v217
    s_waitcnt lgkmcnt(2)
    v_or_b32 v218, v212, v213
    v_accvgpr_write_b32 a122, v218
    s_waitcnt lgkmcnt(0)
    v_or_b32 v219, v214, v215
    v_accvgpr_write_b32 a123, v219
    ds_read_u16 v208, v6 offset:38848
    ds_read_u16_d16_hi v209, v6 offset:38884
    ds_read_u16 v210, v6 offset:38920
    ds_read_u16_d16_hi v211, v6 offset:38956
    ds_read_u16 v212, v6 offset:38992
    ds_read_u16_d16_hi v213, v6 offset:39028
    ds_read_u16 v214, v6 offset:39064
    ds_read_u16_d16_hi v215, v6 offset:39100
    s_waitcnt lgkmcnt(6)
    v_or_b32 v216, v208, v209
    v_accvgpr_write_b32 a124, v216
    s_waitcnt lgkmcnt(4)
    v_or_b32 v217, v210, v211
    v_accvgpr_write_b32 a125, v217
    s_waitcnt lgkmcnt(2)
    v_or_b32 v218, v212, v213
    v_accvgpr_write_b32 a126, v218
    s_waitcnt lgkmcnt(0)
    v_or_b32 v219, v214, v215
    v_accvgpr_write_b32 a127, v219
    ds_read_u16 v208, v6 offset:39424
    ds_read_u16_d16_hi v209, v6 offset:39460
    ds_read_u16 v210, v6 offset:39496
    ds_read_u16_d16_hi v211, v6 offset:39532
    ds_read_u16 v212, v6 offset:39568
    ds_read_u16_d16_hi v213, v6 offset:39604
    ds_read_u16 v214, v6 offset:39640
    ds_read_u16_d16_hi v215, v6 offset:39676
    s_waitcnt lgkmcnt(6)
    v_or_b32 v216, v208, v209
    v_accvgpr_write_b32 a128, v216
    s_waitcnt lgkmcnt(4)
    v_or_b32 v217, v210, v211
    v_accvgpr_write_b32 a129, v217
    s_waitcnt lgkmcnt(2)
    v_or_b32 v218, v212, v213
    v_accvgpr_write_b32 a130, v218
    s_waitcnt lgkmcnt(0)
    v_or_b32 v219, v214, v215
    v_accvgpr_write_b32 a131, v219
    ds_read_u16 v208, v6 offset:40000
    ds_read_u16_d16_hi v209, v6 offset:40036
    ds_read_u16 v210, v6 offset:40072
    ds_read_u16_d16_hi v211, v6 offset:40108
    ds_read_u16 v212, v6 offset:40144
    ds_read_u16_d16_hi v213, v6 offset:40180
    ds_read_u16 v214, v6 offset:40216
    ds_read_u16_d16_hi v215, v6 offset:40252
    s_waitcnt lgkmcnt(6)
    v_or_b32 v216, v208, v209
    v_accvgpr_write_b32 a132, v216
    s_waitcnt lgkmcnt(4)
    v_or_b32 v217, v210, v211
    v_accvgpr_write_b32 a133, v217
    s_waitcnt lgkmcnt(2)
    v_or_b32 v218, v212, v213
    v_accvgpr_write_b32 a134, v218
    s_waitcnt lgkmcnt(0)
    v_or_b32 v219, v214, v215
    v_accvgpr_write_b32 a135, v219
    ds_read_u16 v208, v6 offset:40576
    ds_read_u16_d16_hi v209, v6 offset:40612
    ds_read_u16 v210, v6 offset:40648
    ds_read_u16_d16_hi v211, v6 offset:40684
    ds_read_u16 v212, v6 offset:40720
    ds_read_u16_d16_hi v213, v6 offset:40756
    ds_read_u16 v214, v6 offset:40792
    ds_read_u16_d16_hi v215, v6 offset:40828
    s_waitcnt lgkmcnt(6)
    v_or_b32 v216, v208, v209
    v_accvgpr_write_b32 a136, v216
    s_waitcnt lgkmcnt(4)
    v_or_b32 v217, v210, v211
    v_accvgpr_write_b32 a137, v217
    s_waitcnt lgkmcnt(2)
    v_or_b32 v218, v212, v213
    v_accvgpr_write_b32 a138, v218
    s_waitcnt lgkmcnt(0)
    v_or_b32 v219, v214, v215
    v_accvgpr_write_b32 a139, v219
    ds_read_u16 v208, v6 offset:41152
    ds_read_u16_d16_hi v209, v6 offset:41188
    ds_read_u16 v210, v6 offset:41224
    ds_read_u16_d16_hi v211, v6 offset:41260
    ds_read_u16 v212, v6 offset:41296
    ds_read_u16_d16_hi v213, v6 offset:41332
    ds_read_u16 v214, v6 offset:41368
    ds_read_u16_d16_hi v215, v6 offset:41404
    s_waitcnt lgkmcnt(6)
    v_or_b32 v216, v208, v209
    v_accvgpr_write_b32 a140, v216
    s_waitcnt lgkmcnt(4)
    v_or_b32 v217, v210, v211
    v_accvgpr_write_b32 a141, v217
    s_waitcnt lgkmcnt(2)
    v_or_b32 v218, v212, v213
    v_accvgpr_write_b32 a142, v218
    s_waitcnt lgkmcnt(0)
    v_or_b32 v219, v214, v215
    v_accvgpr_write_b32 a143, v219
    s_mov_b64 exec, s[60:61]
    s_nop 3
    v_mul_u32_u24 v7, 1152, v4
    v_lshl_add_u32 v7, v5, 4, v7
    s_mov_b32 s31, 0
kv_loop_83:
    s_mul_i32 s28, s20, 36864
    buffer_load_dwordx4 v[208:211], v7, s[8:11], s28 offen offset:0
    buffer_load_dwordx4 v[212:215], v7, s[8:11], s28 offen offset:32
    buffer_load_dwordx4 v[216:219], v7, s[8:11], s28 offen offset:64
    buffer_load_dwordx4 v[220:223], v7, s[8:11], s28 offen offset:96
    buffer_load_dwordx4 v[224:227], v7, s[8:11], s28 offen offset:128
    buffer_load_dwordx4 v[228:231], v7, s[8:11], s28 offen offset:160
    buffer_load_dwordx4 v[232:235], v7, s[8:11], s28 offen offset:192
    buffer_load_dwordx4 v[236:239], v7, s[8:11], s28 offen offset:224
    buffer_load_dwordx4 v[240:243], v7, s[8:11], s28 offen offset:256
    buffer_load_dwordx4 v[244:247], v7, s[8:11], s28 offen offset:288
    buffer_load_dwordx4 v[248:251], v7, s[8:11], s28 offen offset:320
    buffer_load_dwordx4 v[252:255], v7, s[8:11], s28 offen offset:352
    s_waitcnt vmcnt(11)
    v_mfma_f32_32x32x16_bf16 v[32:47], v[64:67], v[208:211], 0
    v_mfma_f32_32x32x16_bf16 v[48:63], v[208:211], a[0:3], 0
    buffer_load_dwordx4 v[208:211], v7, s[8:11], s28 offen offset:384
    s_waitcnt vmcnt(11)
    v_mfma_f32_32x32x16_bf16 v[32:47], v[68:71], v[212:215], v[32:47]
    v_mfma_f32_32x32x16_bf16 v[48:63], v[212:215], a[4:7], v[48:63]
    buffer_load_dwordx4 v[212:215], v7, s[8:11], s28 offen offset:416
    s_waitcnt vmcnt(11)
    v_mfma_f32_32x32x16_bf16 v[32:47], v[72:75], v[216:219], v[32:47]
    v_mfma_f32_32x32x16_bf16 v[48:63], v[216:219], a[8:11], v[48:63]
    buffer_load_dwordx4 v[216:219], v7, s[8:11], s28 offen offset:448
    s_waitcnt vmcnt(11)
    v_mfma_f32_32x32x16_bf16 v[32:47], v[76:79], v[220:223], v[32:47]
    v_mfma_f32_32x32x16_bf16 v[48:63], v[220:223], a[12:15], v[48:63]
    buffer_load_dwordx4 v[220:223], v7, s[8:11], s28 offen offset:480
    s_waitcnt vmcnt(11)
    v_mfma_f32_32x32x16_bf16 v[32:47], v[80:83], v[224:227], v[32:47]
    v_mfma_f32_32x32x16_bf16 v[48:63], v[224:227], a[16:19], v[48:63]
    buffer_load_dwordx4 v[224:227], v7, s[8:11], s28 offen offset:512
    s_waitcnt vmcnt(11)
    v_mfma_f32_32x32x16_bf16 v[32:47], v[84:87], v[228:231], v[32:47]
    v_mfma_f32_32x32x16_bf16 v[48:63], v[228:231], a[20:23], v[48:63]
    buffer_load_dwordx4 v[228:231], v7, s[8:11], s28 offen offset:544
    s_waitcnt vmcnt(11)
    v_mfma_f32_32x32x16_bf16 v[32:47], v[88:91], v[232:235], v[32:47]
    v_mfma_f32_32x32x16_bf16 v[48:63], v[232:235], a[24:27], v[48:63]
    buffer_load_dwordx4 v[232:235], v7, s[8:11], s28 offen offset:576
    s_waitcnt vmcnt(11)
    v_mfma_f32_32x32x16_bf16 v[32:47], v[92:95], v[236:239], v[32:47]
    v_mfma_f32_32x32x16_bf16 v[48:63], v[236:239], a[28:31], v[48:63]
    buffer_load_dwordx4 v[236:239], v7, s[8:11], s28 offen offset:608
    s_waitcnt vmcnt(11)
    v_mfma_f32_32x32x16_bf16 v[32:47], v[96:99], v[240:243], v[32:47]
    v_mfma_f32_32x32x16_bf16 v[48:63], v[240:243], a[32:35], v[48:63]
    buffer_load_dwordx4 v[240:243], v7, s[8:11], s28 offen offset:640
    s_waitcnt vmcnt(11)
    v_mfma_f32_32x32x16_bf16 v[32:47], v[100:103], v[244:247], v[32:47]
    v_mfma_f32_32x32x16_bf16 v[48:63], v[244:247], a[36:39], v[48:63]
    buffer_load_dwordx4 v[244:247], v7, s[8:11], s28 offen offset:672
    s_waitcnt vmcnt(11)
    v_mfma_f32_32x32x16_bf16 v[32:47], v[104:107], v[248:251], v[32:47]
    v_mfma_f32_32x32x16_bf16 v[48:63], v[248:251], a[40:43], v[48:63]
    buffer_load_dwordx4 v[248:251], v7, s[8:11], s28 offen offset:704
    s_waitcnt vmcnt(11)
    v_mfma_f32_32x32x16_bf16 v[32:47], v[108:111], v[252:255], v[32:47]
    v_mfma_f32_32x32x16_bf16 v[48:63], v[252:255], a[44:47], v[48:63]
    buffer_load_dwordx4 v[252:255], v7, s[8:11], s28 offen offset:736
    s_waitcnt vmcnt(11)
    v_mfma_f32_32x32x16_bf16 v[32:47], v[112:115], v[208:211], v[32:47]
    v_mfma_f32_32x32x16_bf16 v[48:63], v[208:211], a[48:51], v[48:63]
    buffer_load_dwordx4 v[208:211], v7, s[8:11], s28 offen offset:768
    s_waitcnt vmcnt(11)
    v_mfma_f32_32x32x16_bf16 v[32:47], v[116:119], v[212:215], v[32:47]
    v_mfma_f32_32x32x16_bf16 v[48:63], v[212:215], a[52:55], v[48:63]
    buffer_load_dwordx4 v[212:215], v7, s[8:11], s28 offen offset:800
    s_waitcnt vmcnt(11)
    v_mfma_f32_32x32x16_bf16 v[32:47], v[120:123], v[216:219], v[32:47]
    v_mfma_f32_32x32x16_bf16 v[48:63], v[216:219], a[56:59], v[48:63]
    buffer_load_dwordx4 v[216:219], v7, s[8:11], s28 offen offset:832
    s_waitcnt vmcnt(11)
    v_mfma_f32_32x32x16_bf16 v[32:47], v[124:127], v[220:223], v[32:47]
    v_mfma_f32_32x32x16_bf16 v[48:63], v[220:223], a[60:63], v[48:63]
    buffer_load_dwordx4 v[220:223], v7, s[8:11], s28 offen offset:864
    s_waitcnt vmcnt(11)
    v_mfma_f32_32x32x16_bf16 v[32:47], v[128:131], v[224:227], v[32:47]
    v_mfma_f32_32x32x16_bf16 v[48:63], v[224:227], a[64:67], v[48:63]
    buffer_load_dwordx4 v[224:227], v7, s[8:11], s28 offen offset:896
    s_waitcnt vmcnt(11)
    v_mfma_f32_32x32x16_bf16 v[32:47], v[132:135], v[228:231], v[32:47]
    v_mfma_f32_32x32x16_bf16 v[48:63], v[228:231], a[68:71], v[48:63]
    buffer_load_dwordx4 v[228:231], v7, s[8:11], s28 offen offset:928
    s_waitcnt vmcnt(11)
    v_mfma_f32_32x32x16_bf16 v[32:47], v[136:139], v[232:235], v[32:47]
    v_mfma_f32_32x32x16_bf16 v[48:63], v[232:235], a[72:75], v[48:63]
    buffer_load_dwordx4 v[232:235], v7, s[8:11], s28 offen offset:960
    s_waitcnt vmcnt(11)
    v_mfma_f32_32x32x16_bf16 v[32:47], v[140:143], v[236:239], v[32:47]
    v_mfma_f32_32x32x16_bf16 v[48:63], v[236:239], a[76:79], v[48:63]
    buffer_load_dwordx4 v[236:239], v7, s[8:11], s28 offen offset:992
    s_waitcnt vmcnt(11)
    v_mfma_f32_32x32x16_bf16 v[32:47], v[144:147], v[240:243], v[32:47]
    v_mfma_f32_32x32x16_bf16 v[48:63], v[240:243], a[80:83], v[48:63]
    buffer_load_dwordx4 v[240:243], v7, s[8:11], s28 offen offset:1024
    s_waitcnt vmcnt(11)
    v_mfma_f32_32x32x16_bf16 v[32:47], v[148:151], v[244:247], v[32:47]
    v_mfma_f32_32x32x16_bf16 v[48:63], v[244:247], a[84:87], v[48:63]
    buffer_load_dwordx4 v[244:247], v7, s[8:11], s28 offen offset:1056
    s_waitcnt vmcnt(11)
    v_mfma_f32_32x32x16_bf16 v[32:47], v[152:155], v[248:251], v[32:47]
    v_mfma_f32_32x32x16_bf16 v[48:63], v[248:251], a[88:91], v[48:63]
    buffer_load_dwordx4 v[248:251], v7, s[8:11], s28 offen offset:1088
    s_waitcnt vmcnt(11)
    v_mfma_f32_32x32x16_bf16 v[32:47], v[156:159], v[252:255], v[32:47]
    v_mfma_f32_32x32x16_bf16 v[48:63], v[252:255], a[92:95], v[48:63]
    buffer_load_dwordx4 v[252:255], v7, s[8:11], s28 offen offset:1120
    s_waitcnt vmcnt(11)
    v_mfma_f32_32x32x16_bf16 v[32:47], v[160:163], v[208:211], v[32:47]
    v_mfma_f32_32x32x16_bf16 v[48:63], v[208:211], a[96:99], v[48:63]
    s_waitcnt vmcnt(10)
    v_mfma_f32_32x32x16_bf16 v[32:47], v[164:167], v[212:215], v[32:47]
    v_mfma_f32_32x32x16_bf16 v[48:63], v[212:215], a[100:103], v[48:63]
    s_waitcnt vmcnt(9)
    v_mfma_f32_32x32x16_bf16 v[32:47], v[168:171], v[216:219], v[32:47]
    v_mfma_f32_32x32x16_bf16 v[48:63], v[216:219], a[104:107], v[48:63]
    s_waitcnt vmcnt(8)
    v_mfma_f32_32x32x16_bf16 v[32:47], v[172:175], v[220:223], v[32:47]
    v_mfma_f32_32x32x16_bf16 v[48:63], v[220:223], a[108:111], v[48:63]
    s_waitcnt vmcnt(7)
    v_mfma_f32_32x32x16_bf16 v[32:47], v[176:179], v[224:227], v[32:47]
    v_mfma_f32_32x32x16_bf16 v[48:63], v[224:227], a[112:115], v[48:63]
    s_waitcnt vmcnt(6)
    v_mfma_f32_32x32x16_bf16 v[32:47], v[180:183], v[228:231], v[32:47]
    v_mfma_f32_32x32x16_bf16 v[48:63], v[228:231], a[116:119], v[48:63]
    s_waitcnt vmcnt(5)
    v_mfma_f32_32x32x16_bf16 v[32:47], v[184:187], v[232:235], v[32:47]
    v_mfma_f32_32x32x16_bf16 v[48:63], v[232:235], a[120:123], v[48:63]
    s_waitcnt vmcnt(4)
    v_mfma_f32_32x32x16_bf16 v[32:47], v[188:191], v[236:239], v[32:47]
    v_mfma_f32_32x32x16_bf16 v[48:63], v[236:239], a[124:127], v[48:63]
    s_waitcnt vmcnt(3)
    v_mfma_f32_32x32x16_bf16 v[32:47], v[192:195], v[240:243], v[32:47]
    v_mfma_f32_32x32x16_bf16 v[48:63], v[240:243], a[128:131], v[48:63]
    s_waitcnt vmcnt(2)
    v_mfma_f32_32x32x16_bf16 v[32:47], v[196:199], v[244:247], v[32:47]
    v_mfma_f32_32x32x16_bf16 v[48:63], v[244:247], a[132:135], v[48:63]
    s_waitcnt vmcnt(1)
    v_mfma_f32_32x32x16_bf16 v[32:47], v[200:203], v[248:251], v[32:47]
    v_mfma_f32_32x32x16_bf16 v[48:63], v[248:251], a[136:139], v[48:63]
    s_waitcnt vmcnt(0)
    v_mfma_f32_32x32x16_bf16 v[32:47], v[204:207], v[252:255], v[32:47]
    v_mfma_f32_32x32x16_bf16 v[48:63], v[252:255], a[140:143], v[48:63]
    v_cmp_eq_u32 vcc, 18, v4
    s_nop 10
    v_cndmask_b32_e64 v48, v48, 1.0, vcc
    v_cndmask_b32_e64 v49, v49, 1.0, vcc
    v_cndmask_b32_e64 v50, v50, 1.0, vcc
    v_cndmask_b32_e64 v51, v51, 1.0, vcc
    v_cndmask_b32_e64 v52, v52, 1.0, vcc
    v_cndmask_b32_e64 v53, v53, 1.0, vcc
    v_cndmask_b32_e64 v54, v54, 1.0, vcc
    v_cndmask_b32_e64 v55, v55, 1.0, vcc
    v_cndmask_b32_e64 v56, v56, 1.0, vcc
    v_cndmask_b32_e64 v57, v57, 1.0, vcc
    v_cndmask_b32_e64 v58, v58, 1.0, vcc
    v_cndmask_b32_e64 v59, v59, 1.0, vcc
    v_cndmask_b32_e64 v60, v60, 1.0, vcc
    v_cndmask_b32_e64 v61, v61, 1.0, vcc
    v_cndmask_b32_e64 v62, v62, 1.0, vcc
    v_cndmask_b32_e64 v63, v63, 1.0, vcc
    v_cvt_pk_bf16_f32 v208, v32, v33
    v_cvt_pk_bf16_f32 v209, v34, v35
    v_cvt_pk_bf16_f32 v210, v36, v37
    v_cvt_pk_bf16_f32 v211, v38, v39
    v_cvt_pk_bf16_f32 v212, v40, v41
    v_cvt_pk_bf16_f32 v213, v42, v43
    v_cvt_pk_bf16_f32 v214, v44, v45
    v_cvt_pk_bf16_f32 v215, v46, v47
    v_cvt_pk_bf16_f32 v216, v48, v49
    v_cvt_pk_bf16_f32 v217, v50, v51
    v_cvt_pk_bf16_f32 v218, v52, v53
    v_cvt_pk_bf16_f32 v219, v54, v55
    v_cvt_pk_bf16_f32 v220, v56, v57
    v_cvt_pk_bf16_f32 v221, v58, v59
    v_cvt_pk_bf16_f32 v222, v60, v61
    v_cvt_pk_bf16_f32 v223, v62, v63
    s_lshl_b32 s28, s20, 11
    s_add_u32 s29, s28, 90177536
    s_add_u32 s30, s28, 90439680
    buffer_store_dwordx4 v[208:211], v0, s[4:7], s29 offen sc1
    buffer_store_dwordx4 v[212:215], v0, s[4:7], s29 offen offset:1024 sc1
    buffer_store_dwordx4 v[216:219], v0, s[4:7], s30 offen sc1
    buffer_store_dwordx4 v[220:223], v0, s[4:7], s30 offen offset:1024 sc1
    s_add_u32 s20, s20, s21
    s_add_u32 s31, s31, 1
    s_cmp_lt_u32 s31, 2
    s_cbranch_scc1 kv_loop_83
    s_waitcnt vmcnt(0)
    s_mov_b32 s30, 0
    v_mov_b32 v30, 52
iw_84:
    global_load_dword v31, v30, s[16:17] sc1
    s_waitcnt vmcnt(0)
    v_readfirstlane_b32 s28, v31
    s_nop 0
    s_cmp_lg_u32 s28, 0
    s_cbranch_scc1 id_85
    s_sleep 2
    s_add_u32 s30, s30, 1
    s_cmp_lt_u32 s30, 0x100000
    s_cbranch_scc1 iw_84
    s_mov_b32 s99, 1
id_85:
    s_mov_b32 s28, 65012868
    s_mov_b64 exec, 1
    v_mov_b32 v30, 1
    v_mov_b32 v31, 0
    buffer_atomic_add v30, v31, s[4:7], s28 offen
    s_mov_b64 exec, -1
L_p2:
    s_nop 2
    s_barrier
    v_lshrrev_b32 v33, 4, v0
    v_and_b32 v34, 15, v33
    v_lshrrev_b32 v35, 4, v33
    s_cmp_lt_u32 s44, 48
    s_cbranch_scc1 L_oproj
    s_cmp_lt_u32 s44, 96
    s_cbranch_scc1 L_attna
    s_cmp_lg_u32 s99, 0
    s_cbranch_scc1 pd_87
    s_mov_b32 s29, 65012864
    s_mov_b32 s30, 0
    v_mov_b32 v30, 0
pw_86:
    buffer_load_dword v31, v30, s[4:7], s29 offen sc1
    s_waitcnt vmcnt(0)
    v_readfirstlane_b32 s28, v31
    s_nop 0
    s_cmp_ge_u32 s28, 24
    s_cbranch_scc1 pd_87
    s_sleep 32
    s_add_u32 s30, s30, 1
    s_cmp_lt_u32 s30, 0x100000
    s_cbranch_scc1 pw_86
    s_mov_b32 s99, 1
pd_87:
    s_cmp_lg_u32 s99, 0
    s_cbranch_scc1 pd_89
    s_mov_b32 s29, 65012868
    s_mov_b32 s30, 0
    v_mov_b32 v30, 0
pw_88:
    buffer_load_dword v31, v30, s[4:7], s29 offen sc1
    s_waitcnt vmcnt(0)
    v_readfirstlane_b32 s28, v31
    s_nop 0
    s_cmp_ge_u32 s28, 32
    s_cbranch_scc1 pd_89
    s_sleep 32
    s_add_u32 s30, s30, 1
    s_cmp_lt_u32 s30, 0x100000
    s_cbranch_scc1 pw_88
    s_mov_b32 s99, 1
pd_89:
    s_mov_b32 s23, 0x3eae1a93
    v_and_b32 v40, 31, v33
    v_lshrrev_b32 v41, 5, v33
    v_mul_u32_u24 v1, 1152, v40
    v_lshl_add_u32 v1, v41, 3, v1
    v_lshrrev_b32 v2, 1, v0
    s_sub_u32 s20, s44, 96
    s_lshl_b32 s20, s20, 2
    s_add_u32 s20, s20, s19
    s_nop 1
L_bl:
    s_lshr_b32 s28, s20, 5
    s_and_b32 s29, s20, 31
    s_mul_i32 s36, s28, 36
    s_mul_i32 s29, s29, 73728
    s_add_u32 s36, s36, s29
    s_add_u32 s28, s36, 83886080
    s_add_u32 s29, s28, 0
    buffer_load_dwordx2 v[8:9], v1, s[4:7], s29 offen sc1
    buffer_load_dwordx2 v[10:11], v1, s[4:7], s29 offen offset:16 sc1
    v_mov_b64 v[16:17], 0
    s_mov_b32 exec_hi, 0
    buffer_load_dword v16, v1, s[4:7], s29 offen offset:32 sc1
    s_mov_b32 exec_hi, -1
    s_add_u32 s29, s28, 36864
    buffer_load_dwordx2 v[12:13], v1, s[4:7], s29 offen sc1
    buffer_load_dwordx2 v[14:15], v1, s[4:7], s29 offen offset:16 sc1
    v_mov_b64 v[18:19], 0
    s_mov_b32 exec_hi, 0
    buffer_load_dword v18, v1, s[4:7], s29 offen offset:32 sc1
    s_mov_b32 exec_hi, -1
    v_mov_b32 v20, 0xf149f2ca
    v_mov_b64 v[32:33], 0
    v_mov_b64 v[34:35], 0
    v_mov_b64 v[36:37], 0
    v_mov_b64 v[38:39], 0
    v_mov_b64 v[40:41], 0
    v_mov_b64 v[42:43], 0
    v_mov_b64 v[44:45], 0
    v_mov_b64 v[46:47], 0
    v_mov_b32 v21, 0xf149f2ca
    v_mov_b64 v[48:49], 0
    v_mov_b64 v[50:51], 0
    v_mov_b64 v[52:53], 0
    v_mov_b64 v[54:55], 0
    v_mov_b64 v[56:57], 0
    v_mov_b64 v[58:59], 0
    v_mov_b64 v[60:61], 0
    v_mov_b64 v[62:63], 0
    s_mov_b32 s37, 0
    s_add_u32 s29, s37, 90177536
    s_add_u32 s30, s37, 90439680
    buffer_load_dwordx4 v[192:195], v0, s[4:7], s29 offen offset:0 sc1
    buffer_load_dwordx2 v[208:209], v0, s[4:7], s29 offen offset:1024 sc1
    buffer_load_dwordx4 v[216:219], v0, s[4:7], s30 offen offset:0 sc1
    buffer_load_dwordx4 v[220:223], v0, s[4:7], s30 offen offset:1024 sc1
    buffer_load_dwordx4 v[196:199], v0, s[4:7], s29 offen offset:2048 sc1
    buffer_load_dwordx2 v[210:211], v0, s[4:7], s29 offen offset:3072 sc1
    buffer_load_dwordx4 v[224:227], v0, s[4:7], s30 offen offset:2048 sc1
    buffer_load_dwordx4 v[228:231], v0, s[4:7], s30 offen offset:3072 sc1
    s_add_u32 s29, s29, 4096
    s_add_u32 s30, s30, 4096
    buffer_load_dwordx4 v[200:203], v0, s[4:7], s29 offen offset:0 sc1
    buffer_load_dwordx2 v[212:213], v0, s[4:7], s29 offen offset:1024 sc1
    buffer_load_dwordx4 v[232:235], v0, s[4:7], s30 offen offset:0 sc1
    buffer_load_dwordx4 v[236:239], v0, s[4:7], s30 offen offset:1024 sc1
    buffer_load_dwordx4 v[204:207], v0, s[4:7], s29 offen offset:2048 sc1
    buffer_load_dwordx2 v[214:215], v0, s[4:7], s29 offen offset:3072 sc1
    buffer_load_dwordx4 v[240:243], v0, s[4:7], s30 offen offset:2048 sc1
    buffer_load_dwordx4 v[244:247], v0, s[4:7], s30 offen offset:3072 sc1
    s_mov_b32 s38, 0
    s_waitcnt vmcnt(0)
ab_loop_90:
    s_add_u32 s37, s37, 8192
    s_add_u32 s29, s37, 90177536
    s_add_u32 s30, s37, 90439680
    buffer_load_dwordx4 a[0:3], v0, s[4:7], s29 offen offset:0 sc1
    buffer_load_dwordx2 a[16:17], v0, s[4:7], s29 offen offset:1024 sc1
    buffer_load_dwordx4 a[24:27], v0, s[4:7], s30 offen offset:0 sc1
    buffer_load_dwordx4 a[28:31], v0, s[4:7], s30 offen offset:1024 sc1
    buffer_load_dwordx4 a[4:7], v0, s[4:7], s29 offen offset:2048 sc1
    buffer_load_dwordx2 a[18:19], v0, s[4:7], s29 offen offset:3072 sc1
    buffer_load_dwordx4 a[32:35], v0, s[4:7], s30 offen offset:2048 sc1
    buffer_load_dwordx4 a[36:39], v0, s[4:7], s30 offen offset:3072 sc1
    s_add_u32 s29, s29, 4096
    s_add_u32 s30, s30, 4096
    buffer_load_dwordx4 a[8:11], v0, s[4:7], s29 offen offset:0 sc1
    buffer_load_dwordx2 a[20:21], v0, s[4:7], s29 offen offset:1024 sc1
    buffer_load_dwordx4 a[40:43], v0, s[4:7], s30 offen offset:0 sc1
    buffer_load_dwordx4 a[44:47], v0, s[4:7], s30 offen offset:1024 sc1
    buffer_load_dwordx4 a[12:15], v0, s[4:7], s29 offen offset:2048 sc1
    buffer_load_dwordx2 a[22:23], v0, s[4:7], s29 offen offset:3072 sc1
    buffer_load_dwordx4 a[48:51], v0, s[4:7], s30 offen offset:2048 sc1
    buffer_load_dwordx4 a[52:55], v0, s[4:7], s30 offen offset:3072 sc1
    v_mfma_f32_32x32x16_bf16 v[64:79], v[192:195], v[8:11], 0
    s_nop 9
    v_mfma_f32_32x32x8_bf16 v[64:79], v[208:209], v[16:17], v[64:79]
    v_mfma_f32_32x32x16_bf16 v[80:95], v[196:199], v[8:11], 0
    s_nop 9
    v_mfma_f32_32x32x8_bf16 v[80:95], v[210:211], v[16:17], v[80:95]
    v_mfma_f32_32x32x16_bf16 v[96:111], v[200:203], v[8:11], 0
    s_nop 9
    v_mfma_f32_32x32x8_bf16 v[96:111], v[212:213], v[16:17], v[96:111]
    v_mfma_f32_32x32x16_bf16 v[112:127], v[204:207], v[8:11], 0
    s_nop 9
    v_mfma_f32_32x32x8_bf16 v[112:127], v[214:215], v[16:17], v[112:127]
    v_mfma_f32_32x32x16_bf16 v[128:143], v[192:195], v[12:15], 0
    s_nop 9
    v_mfma_f32_32x32x8_bf16 v[128:143], v[208:209], v[18:19], v[128:143]
    v_mfma_f32_32x32x16_bf16 v[144:159], v[196:199], v[12:15], 0
    s_nop 9
    v_mfma_f32_32x32x8_bf16 v[144:159], v[210:211], v[18:19], v[144:159]
    v_mfma_f32_32x32x16_bf16 v[160:175], v[200:203], v[12:15], 0
    s_nop 9
    v_mfma_f32_32x32x8_bf16 v[160:175], v[212:213], v[18:19], v[160:175]
    v_mfma_f32_32x32x16_bf16 v[176:191], v[204:207], v[12:15], 0
    s_nop 9
    v_mfma_f32_32x32x8_bf16 v[176:191], v[214:215], v[18:19], v[176:191]
    v_max3_f32 v22, v64, v65, v66
    v_max3_f32 v23, v67, v68, v69
    v_max3_f32 v22, v22, v70, v71
    v_max3_f32 v23, v23, v72, v73
    v_max3_f32 v22, v22, v74, v75
    v_max3_f32 v23, v23, v76, v77
    v_max3_f32 v22, v22, v78, v79
    v_max3_f32 v23, v23, v80, v81
    v_max3_f32 v22, v22, v82, v83
    v_max3_f32 v23, v23, v84, v85
    v_max3_f32 v22, v22, v86, v87
    v_max3_f32 v23, v23, v88, v89
    v_max3_f32 v22, v22, v90, v91
    v_max3_f32 v23, v23, v92, v93
    v_max3_f32 v22, v22, v94, v95
    v_max3_f32 v23, v23, v96, v97
    v_max3_f32 v22, v22, v98, v99
    v_max3_f32 v23, v23, v100, v101
    v_max3_f32 v22, v22, v102, v103
    v_max3_f32 v23, v23, v104, v105
    v_max3_f32 v22, v22, v106, v107
    v_max3_f32 v23, v23, v108, v109
    v_max3_f32 v22, v22, v110, v111
    v_max3_f32 v23, v23, v112, v113
    v_max3_f32 v22, v22, v114, v115
    v_max3_f32 v23, v23, v116, v117
    v_max3_f32 v22, v22, v118, v119
    v_max3_f32 v23, v23, v120, v121
    v_max3_f32 v22, v22, v122, v123
    v_max3_f32 v23, v23, v124, v125
    v_max3_f32 v22, v22, v126, v127
    v_max_f32 v22, v22, v23
    v_mov_b32 v23, v22
    s_nop 1
    v_permlane32_swap_b32 v22, v23
    v_max_f32 v22, v22, v23
    v_mul_f32 v22, s23, v22
    v_max_f32 v22, v22, v20
    v_sub_f32 v23, v20, v22
    v_exp_f32 v23, v23
    v_mov_b32 v20, v22
    v_mul_f32 v32, v32, v23
    v_mul_f32 v33, v33, v23
    v_mul_f32 v34, v34, v23
    v_mul_f32 v35, v35, v23
    v_mul_f32 v36, v36, v23
    v_mul_f32 v37, v37, v23
    v_mul_f32 v38, v38, v23
    v_mul_f32 v39, v39, v23
    v_mul_f32 v40, v40, v23
    v_mul_f32 v41, v41, v23
    v_mul_f32 v42, v42, v23
    v_mul_f32 v43, v43, v23
    v_mul_f32 v44, v44, v23
    v_mul_f32 v45, v45, v23
    v_mul_f32 v46, v46, v23
    v_mul_f32 v47, v47, v23
    v_fma_f32 v64, v64, s23, -v22
    v_fma_f32 v65, v65, s23, -v22
    v_fma_f32 v66, v66, s23, -v22
    v_fma_f32 v67, v67, s23, -v22
    v_fma_f32 v68, v68, s23, -v22
    v_fma_f32 v69, v69, s23, -v22
    v_fma_f32 v70, v70, s23, -v22
    v_fma_f32 v71, v71, s23, -v22
    v_fma_f32 v72, v72, s23, -v22
    v_fma_f32 v73, v73, s23, -v22
    v_fma_f32 v74, v74, s23, -v22
    v_fma_f32 v75, v75, s23, -v22
    v_fma_f32 v76, v76, s23, -v22
    v_fma_f32 v77, v77, s23, -v22
    v_fma_f32 v78, v78, s23, -v22
    v_fma_f32 v79, v79, s23, -v22
    v_fma_f32 v80, v80, s23, -v22
    v_fma_f32 v81, v81, s23, -v22
    v_fma_f32 v82, v82, s23, -v22
    v_fma_f32 v83, v83, s23, -v22
    v_fma_f32 v84, v84, s23, -v22
    v_fma_f32 v85, v85, s23, -v22
    v_fma_f32 v86, v86, s23, -v22
    v_fma_f32 v87, v87, s23, -v22
    v_fma_f32 v88, v88, s23, -v22
    v_fma_f32 v89, v89, s23, -v22
    v_fma_f32 v90, v90, s23, -v22
    v_fma_f32 v91, v91, s23, -v22
    v_fma_f32 v92, v92, s23, -v22
    v_fma_f32 v93, v93, s23, -v22
    v_fma_f32 v94, v94, s23, -v22
    v_fma_f32 v95, v95, s23, -v22
    v_fma_f32 v96, v96, s23, -v22
    v_fma_f32 v97, v97, s23, -v22
    v_fma_f32 v98, v98, s23, -v22
    v_fma_f32 v99, v99, s23, -v22
    v_fma_f32 v100, v100, s23, -v22
    v_fma_f32 v101, v101, s23, -v22
    v_fma_f32 v102, v102, s23, -v22
    v_fma_f32 v103, v103, s23, -v22
    v_fma_f32 v104, v104, s23, -v22
    v_fma_f32 v105, v105, s23, -v22
    v_fma_f32 v106, v106, s23, -v22
    v_fma_f32 v107, v107, s23, -v22
    v_fma_f32 v108, v108, s23, -v22
    v_fma_f32 v109, v109, s23, -v22
    v_fma_f32 v110, v110, s23, -v22
    v_fma_f32 v111, v111, s23, -v22
    v_fma_f32 v112, v112, s23, -v22
    v_fma_f32 v113, v113, s23, -v22
    v_fma_f32 v114, v114, s23, -v22
    v_fma_f32 v115, v115, s23, -v22
    v_fma_f32 v116, v116, s23, -v22
    v_fma_f32 v117, v117, s23, -v22
    v_fma_f32 v118, v118, s23, -v22
    v_fma_f32 v119, v119, s23, -v22
    v_fma_f32 v120, v120, s23, -v22
    v_fma_f32 v121, v121, s23, -v22
    v_fma_f32 v122, v122, s23, -v22
    v_fma_f32 v123, v123, s23, -v22
    v_fma_f32 v124, v124, s23, -v22
    v_fma_f32 v125, v125, s23, -v22
    v_fma_f32 v126, v126, s23, -v22
    v_fma_f32 v127, v127, s23, -v22
    v_exp_f32 v64, v64
    v_exp_f32 v65, v65
    v_exp_f32 v66, v66
    v_exp_f32 v67, v67
    v_exp_f32 v68, v68
    v_exp_f32 v69, v69
    v_exp_f32 v70, v70
    v_exp_f32 v71, v71
    v_exp_f32 v72, v72
    v_exp_f32 v73, v73
    v_exp_f32 v74, v74
    v_exp_f32 v75, v75
    v_exp_f32 v76, v76
    v_exp_f32 v77, v77
    v_exp_f32 v78, v78
    v_exp_f32 v79, v79
    v_exp_f32 v80, v80
    v_exp_f32 v81, v81
    v_exp_f32 v82, v82
    v_exp_f32 v83, v83
    v_exp_f32 v84, v84
    v_exp_f32 v85, v85
    v_exp_f32 v86, v86
    v_exp_f32 v87, v87
    v_exp_f32 v88, v88
    v_exp_f32 v89, v89
    v_exp_f32 v90, v90
    v_exp_f32 v91, v91
    v_exp_f32 v92, v92
    v_exp_f32 v93, v93
    v_exp_f32 v94, v94
    v_exp_f32 v95, v95
    v_exp_f32 v96, v96
    v_exp_f32 v97, v97
    v_exp_f32 v98, v98
    v_exp_f32 v99, v99
    v_exp_f32 v100, v100
    v_exp_f32 v101, v101
    v_exp_f32 v102, v102
    v_exp_f32 v103, v103
    v_exp_f32 v104, v104
    v_exp_f32 v105, v105
    v_exp_f32 v106, v106
    v_exp_f32 v107, v107
    v_exp_f32 v108, v108
    v_exp_f32 v109, v109
    v_exp_f32 v110, v110
    v_exp_f32 v111, v111
    v_exp_f32 v112, v112
    v_exp_f32 v113, v113
    v_exp_f32 v114, v114
    v_exp_f32 v115, v115
    v_exp_f32 v116, v116
    v_exp_f32 v117, v117
    v_exp_f32 v118, v118
    v_exp_f32 v119, v119
    v_exp_f32 v120, v120
    v_exp_f32 v121, v121
    v_exp_f32 v122, v122
    v_exp_f32 v123, v123
    v_exp_f32 v124, v124
    v_exp_f32 v125, v125
    v_exp_f32 v126, v126
    v_exp_f32 v127, v127
    v_cvt_pk_bf16_f32 v64, v64, v65
    v_cvt_pk_bf16_f32 v65, v66, v67
    v_cvt_pk_bf16_f32 v66, v68, v69
    v_cvt_pk_bf16_f32 v67, v70, v71
    v_cvt_pk_bf16_f32 v68, v72, v73
    v_cvt_pk_bf16_f32 v69, v74, v75
    v_cvt_pk_bf16_f32 v70, v76, v77
    v_cvt_pk_bf16_f32 v71, v78, v79
    v_cvt_pk_bf16_f32 v72, v80, v81
    v_cvt_pk_bf16_f32 v73, v82, v83
    v_cvt_pk_bf16_f32 v74, v84, v85
    v_cvt_pk_bf16_f32 v75, v86, v87
    v_cvt_pk_bf16_f32 v76, v88, v89
    v_cvt_pk_bf16_f32 v77, v90, v91
    v_cvt_pk_bf16_f32 v78, v92, v93
    v_cvt_pk_bf16_f32 v79, v94, v95
    v_cvt_pk_bf16_f32 v80, v96, v97
    v_cvt_pk_bf16_f32 v81, v98, v99
    v_cvt_pk_bf16_f32 v82, v100, v101
    v_cvt_pk_bf16_f32 v83, v102, v103
    v_cvt_pk_bf16_f32 v84, v104, v105
    v_cvt_pk_bf16_f32 v85, v106, v107
    v_cvt_pk_bf16_f32 v86, v108, v109
    v_cvt_pk_bf16_f32 v87, v110, v111
    v_cvt_pk_bf16_f32 v88, v112, v113
    v_cvt_pk_bf16_f32 v89, v114, v115
    v_cvt_pk_bf16_f32 v90, v116, v117
    v_cvt_pk_bf16_f32 v91, v118, v119
    v_cvt_pk_bf16_f32 v92, v120, v121
    v_cvt_pk_bf16_f32 v93, v122, v123
    v_cvt_pk_bf16_f32 v94, v124, v125
    v_cvt_pk_bf16_f32 v95, v126, v127
    v_max3_f32 v26, v128, v129, v130
    v_max3_f32 v27, v131, v132, v133
    v_max3_f32 v26, v26, v134, v135
    v_max3_f32 v27, v27, v136, v137
    v_max3_f32 v26, v26, v138, v139
    v_max3_f32 v27, v27, v140, v141
    v_max3_f32 v26, v26, v142, v143
    v_max3_f32 v27, v27, v144, v145
    v_max3_f32 v26, v26, v146, v147
    v_max3_f32 v27, v27, v148, v149
    v_max3_f32 v26, v26, v150, v151
    v_max3_f32 v27, v27, v152, v153
    v_max3_f32 v26, v26, v154, v155
    v_max3_f32 v27, v27, v156, v157
    v_max3_f32 v26, v26, v158, v159
    v_max3_f32 v27, v27, v160, v161
    v_max3_f32 v26, v26, v162, v163
    v_max3_f32 v27, v27, v164, v165
    v_max3_f32 v26, v26, v166, v167
    v_max3_f32 v27, v27, v168, v169
    v_max3_f32 v26, v26, v170, v171
    v_max3_f32 v27, v27, v172, v173
    v_max3_f32 v26, v26, v174, v175
    v_max3_f32 v27, v27, v176, v177
    v_max3_f32 v26, v26, v178, v179
    v_max3_f32 v27, v27, v180, v181
    v_max3_f32 v26, v26, v182, v183
    v_max3_f32 v27, v27, v184, v185
    v_max3_f32 v26, v26, v186, v187
    v_max3_f32 v27, v27, v188, v189
    v_max3_f32 v26, v26, v190, v191
    v_max_f32 v26, v26, v27
    v_mov_b32 v27, v26
    s_nop 1
    v_permlane32_swap_b32 v26, v27
    v_max_f32 v26, v26, v27
    v_mul_f32 v26, s23, v26
    v_max_f32 v26, v26, v21
    v_sub_f32 v27, v21, v26
    v_exp_f32 v27, v27
    v_mov_b32 v21, v26
    v_mul_f32 v48, v48, v27
    v_mul_f32 v49, v49, v27
    v_mul_f32 v50, v50, v27
    v_mul_f32 v51, v51, v27
    v_mul_f32 v52, v52, v27
    v_mul_f32 v53, v53, v27
    v_mul_f32 v54, v54, v27
    v_mul_f32 v55, v55, v27
    v_mul_f32 v56, v56, v27
    v_mul_f32 v57, v57, v27
    v_mul_f32 v58, v58, v27
    v_mul_f32 v59, v59, v27
    v_mul_f32 v60, v60, v27
    v_mul_f32 v61, v61, v27
    v_mul_f32 v62, v62, v27
    v_mul_f32 v63, v63, v27
    v_fma_f32 v128, v128, s23, -v26
    v_fma_f32 v129, v129, s23, -v26
    v_fma_f32 v130, v130, s23, -v26
    v_fma_f32 v131, v131, s23, -v26
    v_fma_f32 v132, v132, s23, -v26
    v_fma_f32 v133, v133, s23, -v26
    v_fma_f32 v134, v134, s23, -v26
    v_fma_f32 v135, v135, s23, -v26
    v_fma_f32 v136, v136, s23, -v26
    v_fma_f32 v137, v137, s23, -v26
    v_fma_f32 v138, v138, s23, -v26
    v_fma_f32 v139, v139, s23, -v26
    v_fma_f32 v140, v140, s23, -v26
    v_fma_f32 v141, v141, s23, -v26
    v_fma_f32 v142, v142, s23, -v26
    v_fma_f32 v143, v143, s23, -v26
    v_fma_f32 v144, v144, s23, -v26
    v_fma_f32 v145, v145, s23, -v26
    v_fma_f32 v146, v146, s23, -v26
    v_fma_f32 v147, v147, s23, -v26
    v_fma_f32 v148, v148, s23, -v26
    v_fma_f32 v149, v149, s23, -v26
    v_fma_f32 v150, v150, s23, -v26
    v_fma_f32 v151, v151, s23, -v26
    v_fma_f32 v152, v152, s23, -v26
    v_fma_f32 v153, v153, s23, -v26
    v_fma_f32 v154, v154, s23, -v26
    v_fma_f32 v155, v155, s23, -v26
    v_fma_f32 v156, v156, s23, -v26
    v_fma_f32 v157, v157, s23, -v26
    v_fma_f32 v158, v158, s23, -v26
    v_fma_f32 v159, v159, s23, -v26
    v_fma_f32 v160, v160, s23, -v26
    v_fma_f32 v161, v161, s23, -v26
    v_fma_f32 v162, v162, s23, -v26
    v_fma_f32 v163, v163, s23, -v26
    v_fma_f32 v164, v164, s23, -v26
    v_fma_f32 v165, v165, s23, -v26
    v_fma_f32 v166, v166, s23, -v26
    v_fma_f32 v167, v167, s23, -v26
    v_fma_f32 v168, v168, s23, -v26
    v_fma_f32 v169, v169, s23, -v26
    v_fma_f32 v170, v170, s23, -v26
    v_fma_f32 v171, v171, s23, -v26
    v_fma_f32 v172, v172, s23, -v26
    v_fma_f32 v173, v173, s23, -v26
    v_fma_f32 v174, v174, s23, -v26
    v_fma_f32 v175, v175, s23, -v26
    v_fma_f32 v176, v176, s23, -v26
    v_fma_f32 v177, v177, s23, -v26
    v_fma_f32 v178, v178, s23, -v26
    v_fma_f32 v179, v179, s23, -v26
    v_fma_f32 v180, v180, s23, -v26
    v_fma_f32 v181, v181, s23, -v26
    v_fma_f32 v182, v182, s23, -v26
    v_fma_f32 v183, v183, s23, -v26
    v_fma_f32 v184, v184, s23, -v26
    v_fma_f32 v185, v185, s23, -v26
    v_fma_f32 v186, v186, s23, -v26
    v_fma_f32 v187, v187, s23, -v26
    v_fma_f32 v188, v188, s23, -v26
    v_fma_f32 v189, v189, s23, -v26
    v_fma_f32 v190, v190, s23, -v26
    v_fma_f32 v191, v191, s23, -v26
    v_exp_f32 v128, v128
    v_exp_f32 v129, v129
    v_exp_f32 v130, v130
    v_exp_f32 v131, v131
    v_exp_f32 v132, v132
    v_exp_f32 v133, v133
    v_exp_f32 v134, v134
    v_exp_f32 v135, v135
    v_exp_f32 v136, v136
    v_exp_f32 v137, v137
    v_exp_f32 v138, v138
    v_exp_f32 v139, v139
    v_exp_f32 v140, v140
    v_exp_f32 v141, v141
    v_exp_f32 v142, v142
    v_exp_f32 v143, v143
    v_exp_f32 v144, v144
    v_exp_f32 v145, v145
    v_exp_f32 v146, v146
    v_exp_f32 v147, v147
    v_exp_f32 v148, v148
    v_exp_f32 v149, v149
    v_exp_f32 v150, v150
    v_exp_f32 v151, v151
    v_exp_f32 v152, v152
    v_exp_f32 v153, v153
    v_exp_f32 v154, v154
    v_exp_f32 v155, v155
    v_exp_f32 v156, v156
    v_exp_f32 v157, v157
    v_exp_f32 v158, v158
    v_exp_f32 v159, v159
    v_exp_f32 v160, v160
    v_exp_f32 v161, v161
    v_exp_f32 v162, v162
    v_exp_f32 v163, v163
    v_exp_f32 v164, v164
    v_exp_f32 v165, v165
    v_exp_f32 v166, v166
    v_exp_f32 v167, v167
    v_exp_f32 v168, v168
    v_exp_f32 v169, v169
    v_exp_f32 v170, v170
    v_exp_f32 v171, v171
    v_exp_f32 v172, v172
    v_exp_f32 v173, v173
    v_exp_f32 v174, v174
    v_exp_f32 v175, v175
    v_exp_f32 v176, v176
    v_exp_f32 v177, v177
    v_exp_f32 v178, v178
    v_exp_f32 v179, v179
    v_exp_f32 v180, v180
    v_exp_f32 v181, v181
    v_exp_f32 v182, v182
    v_exp_f32 v183, v183
    v_exp_f32 v184, v184
    v_exp_f32 v185, v185
    v_exp_f32 v186, v186
    v_exp_f32 v187, v187
    v_exp_f32 v188, v188
    v_exp_f32 v189, v189
    v_exp_f32 v190, v190
    v_exp_f32 v191, v191
    v_cvt_pk_bf16_f32 v128, v128, v129
    v_cvt_pk_bf16_f32 v129, v130, v131
    v_cvt_pk_bf16_f32 v130, v132, v133
    v_cvt_pk_bf16_f32 v131, v134, v135
    v_cvt_pk_bf16_f32 v132, v136, v137
    v_cvt_pk_bf16_f32 v133, v138, v139
    v_cvt_pk_bf16_f32 v134, v140, v141
    v_cvt_pk_bf16_f32 v135, v142, v143
    v_cvt_pk_bf16_f32 v136, v144, v145
    v_cvt_pk_bf16_f32 v137, v146, v147
    v_cvt_pk_bf16_f32 v138, v148, v149
    v_cvt_pk_bf16_f32 v139, v150, v151
    v_cvt_pk_bf16_f32 v140, v152, v153
    v_cvt_pk_bf16_f32 v141, v154, v155
    v_cvt_pk_bf16_f32 v142, v156, v157
    v_cvt_pk_bf16_f32 v143, v158, v159
    v_cvt_pk_bf16_f32 v144, v160, v161
    v_cvt_pk_bf16_f32 v145, v162, v163
    v_cvt_pk_bf16_f32 v146, v164, v165
    v_cvt_pk_bf16_f32 v147, v166, v167
    v_cvt_pk_bf16_f32 v148, v168, v169
    v_cvt_pk_bf16_f32 v149, v170, v171
    v_cvt_pk_bf16_f32 v150, v172, v173
    v_cvt_pk_bf16_f32 v151, v174, v175
    v_cvt_pk_bf16_f32 v152, v176, v177
    v_cvt_pk_bf16_f32 v153, v178, v179
    v_cvt_pk_bf16_f32 v154, v180, v181
    v_cvt_pk_bf16_f32 v155, v182, v183
    v_cvt_pk_bf16_f32 v156, v184, v185
    v_cvt_pk_bf16_f32 v157, v186, v187
    v_cvt_pk_bf16_f32 v158, v188, v189
    v_cvt_pk_bf16_f32 v159, v190, v191
    v_mfma_f32_32x32x16_bf16 v[32:47], v[216:219], v[64:67], v[32:47]
    v_mfma_f32_32x32x16_bf16 v[32:47], v[220:223], v[68:71], v[32:47]
    v_mfma_f32_32x32x16_bf16 v[32:47], v[224:227], v[72:75], v[32:47]
    v_mfma_f32_32x32x16_bf16 v[32:47], v[228:231], v[76:79], v[32:47]
    v_mfma_f32_32x32x16_bf16 v[32:47], v[232:235], v[80:83], v[32:47]
    v_mfma_f32_32x32x16_bf16 v[32:47], v[236:239], v[84:87], v[32:47]
    v_mfma_f32_32x32x16_bf16 v[32:47], v[240:243], v[88:91], v[32:47]
    v_mfma_f32_32x32x16_bf16 v[32:47], v[244:247], v[92:95], v[32:47]
    v_mfma_f32_32x32x16_bf16 v[48:63], v[216:219], v[128:131], v[48:63]
    v_mfma_f32_32x32x16_bf16 v[48:63], v[220:223], v[132:135], v[48:63]
    v_mfma_f32_32x32x16_bf16 v[48:63], v[224:227], v[136:139], v[48:63]
    v_mfma_f32_32x32x16_bf16 v[48:63], v[228:231], v[140:143], v[48:63]
    v_mfma_f32_32x32x16_bf16 v[48:63], v[232:235], v[144:147], v[48:63]
    v_mfma_f32_32x32x16_bf16 v[48:63], v[236:239], v[148:151], v[48:63]
    v_mfma_f32_32x32x16_bf16 v[48:63], v[240:243], v[152:155], v[48:63]
    v_mfma_f32_32x32x16_bf16 v[48:63], v[244:247], v[156:159], v[48:63]
    s_waitcnt vmcnt(0)
    s_nop 10
    s_add_u32 s37, s37, 8192
    s_add_u32 s29, s37, 90177536
    s_add_u32 s30, s37, 90439680
    buffer_load_dwordx4 v[192:195], v0, s[4:7], s29 offen offset:0 sc1
    buffer_load_dwordx2 v[208:209], v0, s[4:7], s29 offen offset:1024 sc1
    buffer_load_dwordx4 v[216:219], v0, s[4:7], s30 offen offset:0 sc1
    buffer_load_dwordx4 v[220:223], v0, s[4:7], s30 offen offset:1024 sc1
    buffer_load_dwordx4 v[196:199], v0, s[4:7], s29 offen offset:2048 sc1
    buffer_load_dwordx2 v[210:211], v0, s[4:7], s29 offen offset:3072 sc1
    buffer_load_dwordx4 v[224:227], v0, s[4:7], s30 offen offset:2048 sc1
    buffer_load_dwordx4 v[228:231], v0, s[4:7], s30 offen offset:3072 sc1
    s_add_u32 s29, s29, 4096
    s_add_u32 s30, s30, 4096
    buffer_load_dwordx4 v[200:203], v0, s[4:7], s29 offen offset:0 sc1
    buffer_load_dwordx2 v[212:213], v0, s[4:7], s29 offen offset:1024 sc1
    buffer_load_dwordx4 v[232:235], v0, s[4:7], s30 offen offset:0 sc1
    buffer_load_dwordx4 v[236:239], v0, s[4:7], s30 offen offset:1024 sc1
    buffer_load_dwordx4 v[204:207], v0, s[4:7], s29 offen offset:2048 sc1
    buffer_load_dwordx2 v[214:215], v0, s[4:7], s29 offen offset:3072 sc1
    buffer_load_dwordx4 v[240:243], v0, s[4:7], s30 offen offset:2048 sc1
    buffer_load_dwordx4 v[244:247], v0, s[4:7], s30 offen offset:3072 sc1
    v_mfma_f32_32x32x16_bf16 v[64:79], a[0:3], v[8:11], 0
    s_nop 9
    v_mfma_f32_32x32x8_bf16 v[64:79], a[16:17], v[16:17], v[64:79]
    v_mfma_f32_32x32x16_bf16 v[80:95], a[4:7], v[8:11], 0
    s_nop 9
    v_mfma_f32_32x32x8_bf16 v[80:95], a[18:19], v[16:17], v[80:95]
    v_mfma_f32_32x32x16_bf16 v[96:111], a[8:11], v[8:11], 0
    s_nop 9
    v_mfma_f32_32x32x8_bf16 v[96:111], a[20:21], v[16:17], v[96:111]
    v_mfma_f32_32x32x16_bf16 v[112:127], a[12:15], v[8:11], 0
    s_nop 9
    v_mfma_f32_32x32x8_bf16 v[112:127], a[22:23], v[16:17], v[112:127]
    v_mfma_f32_32x32x16_bf16 v[128:143], a[0:3], v[12:15], 0
    s_nop 9
    v_mfma_f32_32x32x8_bf16 v[128:143], a[16:17], v[18:19], v[128:143]
    v_mfma_f32_32x32x16_bf16 v[144:159], a[4:7], v[12:15], 0
    s_nop 9
    v_mfma_f32_32x32x8_bf16 v[144:159], a[18:19], v[18:19], v[144:159]
    v_mfma_f32_32x32x16_bf16 v[160:175], a[8:11], v[12:15], 0
    s_nop 9
    v_mfma_f32_32x32x8_bf16 v[160:175], a[20:21], v[18:19], v[160:175]
    v_mfma_f32_32x32x16_bf16 v[176:191], a[12:15], v[12:15], 0
    s_nop 9
    v_mfma_f32_32x32x8_bf16 v[176:191], a[22:23], v[18:19], v[176:191]
    v_max3_f32 v22, v64, v65, v66
    v_max3_f32 v23, v67, v68, v69
    v_max3_f32 v22, v22, v70, v71
    v_max3_f32 v23, v23, v72, v73
    v_max3_f32 v22, v22, v74, v75
    v_max3_f32 v23, v23, v76, v77
    v_max3_f32 v22, v22, v78, v79
    v_max3_f32 v23, v23, v80, v81
    v_max3_f32 v22, v22, v82, v83
    v_max3_f32 v23, v23, v84, v85
    v_max3_f32 v22, v22, v86, v87
    v_max3_f32 v23, v23, v88, v89
    v_max3_f32 v22, v22, v90, v91
    v_max3_f32 v23, v23, v92, v93
    v_max3_f32 v22, v22, v94, v95
    v_max3_f32 v23, v23, v96, v97
    v_max3_f32 v22, v22, v98, v99
    v_max3_f32 v23, v23, v100, v101
    v_max3_f32 v22, v22, v102, v103
    v_max3_f32 v23, v23, v104, v105
    v_max3_f32 v22, v22, v106, v107
    v_max3_f32 v23, v23, v108, v109
    v_max3_f32 v22, v22, v110, v111
    v_max3_f32 v23, v23, v112, v113
    v_max3_f32 v22, v22, v114, v115
    v_max3_f32 v23, v23, v116, v117
    v_max3_f32 v22, v22, v118, v119
    v_max3_f32 v23, v23, v120, v121
    v_max3_f32 v22, v22, v122, v123
    v_max3_f32 v23, v23, v124, v125
    v_max3_f32 v22, v22, v126, v127
    v_max_f32 v22, v22, v23
    v_mov_b32 v23, v22
    s_nop 1
    v_permlane32_swap_b32 v22, v23
    v_max_f32 v22, v22, v23
    v_mul_f32 v22, s23, v22
    v_max_f32 v22, v22, v20
    v_sub_f32 v23, v20, v22
    v_exp_f32 v23, v23
    v_mov_b32 v20, v22
    v_mul_f32 v32, v32, v23
    v_mul_f32 v33, v33, v23
    v_mul_f32 v34, v34, v23
    v_mul_f32 v35, v35, v23
    v_mul_f32 v36, v36, v23
    v_mul_f32 v37, v37, v23
    v_mul_f32 v38, v38, v23
    v_mul_f32 v39, v39, v23
    v_mul_f32 v40, v40, v23
    v_mul_f32 v41, v41, v23
    v_mul_f32 v42, v42, v23
    v_mul_f32 v43, v43, v23
    v_mul_f32 v44, v44, v23
    v_mul_f32 v45, v45, v23
    v_mul_f32 v46, v46, v23
    v_mul_f32 v47, v47, v23
    v_fma_f32 v64, v64, s23, -v22
    v_fma_f32 v65, v65, s23, -v22
    v_fma_f32 v66, v66, s23, -v22
    v_fma_f32 v67, v67, s23, -v22
    v_fma_f32 v68, v68, s23, -v22
    v_fma_f32 v69, v69, s23, -v22
    v_fma_f32 v70, v70, s23, -v22
    v_fma_f32 v71, v71, s23, -v22
    v_fma_f32 v72, v72, s23, -v22
    v_fma_f32 v73, v73, s23, -v22
    v_fma_f32 v74, v74, s23, -v22
    v_fma_f32 v75, v75, s23, -v22
    v_fma_f32 v76, v76, s23, -v22
    v_fma_f32 v77, v77, s23, -v22
    v_fma_f32 v78, v78, s23, -v22
    v_fma_f32 v79, v79, s23, -v22
    v_fma_f32 v80, v80, s23, -v22
    v_fma_f32 v81, v81, s23, -v22
    v_fma_f32 v82, v82, s23, -v22
    v_fma_f32 v83, v83, s23, -v22
    v_fma_f32 v84, v84, s23, -v22
    v_fma_f32 v85, v85, s23, -v22
    v_fma_f32 v86, v86, s23, -v22
    v_fma_f32 v87, v87, s23, -v22
    v_fma_f32 v88, v88, s23, -v22
    v_fma_f32 v89, v89, s23, -v22
    v_fma_f32 v90, v90, s23, -v22
    v_fma_f32 v91, v91, s23, -v22
    v_fma_f32 v92, v92, s23, -v22
    v_fma_f32 v93, v93, s23, -v22
    v_fma_f32 v94, v94, s23, -v22
    v_fma_f32 v95, v95, s23, -v22
    v_fma_f32 v96, v96, s23, -v22
    v_fma_f32 v97, v97, s23, -v22
    v_fma_f32 v98, v98, s23, -v22
    v_fma_f32 v99, v99, s23, -v22
    v_fma_f32 v100, v100, s23, -v22
    v_fma_f32 v101, v101, s23, -v22
    v_fma_f32 v102, v102, s23, -v22
    v_fma_f32 v103, v103, s23, -v22
    v_fma_f32 v104, v104, s23, -v22
    v_fma_f32 v105, v105, s23, -v22
    v_fma_f32 v106, v106, s23, -v22
    v_fma_f32 v107, v107, s23, -v22
    v_fma_f32 v108, v108, s23, -v22
    v_fma_f32 v109, v109, s23, -v22
    v_fma_f32 v110, v110, s23, -v22
    v_fma_f32 v111, v111, s23, -v22
    v_fma_f32 v112, v112, s23, -v22
    v_fma_f32 v113, v113, s23, -v22
    v_fma_f32 v114, v114, s23, -v22
    v_fma_f32 v115, v115, s23, -v22
    v_fma_f32 v116, v116, s23, -v22
    v_fma_f32 v117, v117, s23, -v22
    v_fma_f32 v118, v118, s23, -v22
    v_fma_f32 v119, v119, s23, -v22
    v_fma_f32 v120, v120, s23, -v22
    v_fma_f32 v121, v121, s23, -v22
    v_fma_f32 v122, v122, s23, -v22
    v_fma_f32 v123, v123, s23, -v22
    v_fma_f32 v124, v124, s23, -v22
    v_fma_f32 v125, v125, s23, -v22
    v_fma_f32 v126, v126, s23, -v22
    v_fma_f32 v127, v127, s23, -v22
    v_exp_f32 v64, v64
    v_exp_f32 v65, v65
    v_exp_f32 v66, v66
    v_exp_f32 v67, v67
    v_exp_f32 v68, v68
    v_exp_f32 v69, v69
    v_exp_f32 v70, v70
    v_exp_f32 v71, v71
    v_exp_f32 v72, v72
    v_exp_f32 v73, v73
    v_exp_f32 v74, v74
    v_exp_f32 v75, v75
    v_exp_f32 v76, v76
    v_exp_f32 v77, v77
    v_exp_f32 v78, v78
    v_exp_f32 v79, v79
    v_exp_f32 v80, v80
    v_exp_f32 v81, v81
    v_exp_f32 v82, v82
    v_exp_f32 v83, v83
    v_exp_f32 v84, v84
    v_exp_f32 v85, v85
    v_exp_f32 v86, v86
    v_exp_f32 v87, v87
    v_exp_f32 v88, v88
    v_exp_f32 v89, v89
    v_exp_f32 v90, v90
    v_exp_f32 v91, v91
    v_exp_f32 v92, v92
    v_exp_f32 v93, v93
    v_exp_f32 v94, v94
    v_exp_f32 v95, v95
    v_exp_f32 v96, v96
    v_exp_f32 v97, v97
    v_exp_f32 v98, v98
    v_exp_f32 v99, v99
    v_exp_f32 v100, v100
    v_exp_f32 v101, v101
    v_exp_f32 v102, v102
    v_exp_f32 v103, v103
    v_exp_f32 v104, v104
    v_exp_f32 v105, v105
    v_exp_f32 v106, v106
    v_exp_f32 v107, v107
    v_exp_f32 v108, v108
    v_exp_f32 v109, v109
    v_exp_f32 v110, v110
    v_exp_f32 v111, v111
    v_exp_f32 v112, v112
    v_exp_f32 v113, v113
    v_exp_f32 v114, v114
    v_exp_f32 v115, v115
    v_exp_f32 v116, v116
    v_exp_f32 v117, v117
    v_exp_f32 v118, v118
    v_exp_f32 v119, v119
    v_exp_f32 v120, v120
    v_exp_f32 v121, v121
    v_exp_f32 v122, v122
    v_exp_f32 v123, v123
    v_exp_f32 v124, v124
    v_exp_f32 v125, v125
    v_exp_f32 v126, v126
    v_exp_f32 v127, v127
    v_cvt_pk_bf16_f32 v64, v64, v65
    v_cvt_pk_bf16_f32 v65, v66, v67
    v_cvt_pk_bf16_f32 v66, v68, v69
    v_cvt_pk_bf16_f32 v67, v70, v71
    v_cvt_pk_bf16_f32 v68, v72, v73
    v_cvt_pk_bf16_f32 v69, v74, v75
    v_cvt_pk_bf16_f32 v70, v76, v77
    v_cvt_pk_bf16_f32 v71, v78, v79
    v_cvt_pk_bf16_f32 v72, v80, v81
    v_cvt_pk_bf16_f32 v73, v82, v83
    v_cvt_pk_bf16_f32 v74, v84, v85
    v_cvt_pk_bf16_f32 v75, v86, v87
    v_cvt_pk_bf16_f32 v76, v88, v89
    v_cvt_pk_bf16_f32 v77, v90, v91
    v_cvt_pk_bf16_f32 v78, v92, v93
    v_cvt_pk_bf16_f32 v79, v94, v95
    v_cvt_pk_bf16_f32 v80, v96, v97
    v_cvt_pk_bf16_f32 v81, v98, v99
    v_cvt_pk_bf16_f32 v82, v100, v101
    v_cvt_pk_bf16_f32 v83, v102, v103
    v_cvt_pk_bf16_f32 v84, v104, v105
    v_cvt_pk_bf16_f32 v85, v106, v107
    v_cvt_pk_bf16_f32 v86, v108, v109
    v_cvt_pk_bf16_f32 v87, v110, v111
    v_cvt_pk_bf16_f32 v88, v112, v113
    v_cvt_pk_bf16_f32 v89, v114, v115
    v_cvt_pk_bf16_f32 v90, v116, v117
    v_cvt_pk_bf16_f32 v91, v118, v119
    v_cvt_pk_bf16_f32 v92, v120, v121
    v_cvt_pk_bf16_f32 v93, v122, v123
    v_cvt_pk_bf16_f32 v94, v124, v125
    v_cvt_pk_bf16_f32 v95, v126, v127
    v_max3_f32 v26, v128, v129, v130
    v_max3_f32 v27, v131, v132, v133
    v_max3_f32 v26, v26, v134, v135
    v_max3_f32 v27, v27, v136, v137
    v_max3_f32 v26, v26, v138, v139
    v_max3_f32 v27, v27, v140, v141
    v_max3_f32 v26, v26, v142, v143
    v_max3_f32 v27, v27, v144, v145
    v_max3_f32 v26, v26, v146, v147
    v_max3_f32 v27, v27, v148, v149
    v_max3_f32 v26, v26, v150, v151
    v_max3_f32 v27, v27, v152, v153
    v_max3_f32 v26, v26, v154, v155
    v_max3_f32 v27, v27, v156, v157
    v_max3_f32 v26, v26, v158, v159
    v_max3_f32 v27, v27, v160, v161
    v_max3_f32 v26, v26, v162, v163
    v_max3_f32 v27, v27, v164, v165
    v_max3_f32 v26, v26, v166, v167
    v_max3_f32 v27, v27, v168, v169
    v_max3_f32 v26, v26, v170, v171
    v_max3_f32 v27, v27, v172, v173
    v_max3_f32 v26, v26, v174, v175
    v_max3_f32 v27, v27, v176, v177
    v_max3_f32 v26, v26, v178, v179
    v_max3_f32 v27, v27, v180, v181
    v_max3_f32 v26, v26, v182, v183
    v_max3_f32 v27, v27, v184, v185
    v_max3_f32 v26, v26, v186, v187
    v_max3_f32 v27, v27, v188, v189
    v_max3_f32 v26, v26, v190, v191
    v_max_f32 v26, v26, v27
    v_mov_b32 v27, v26
    s_nop 1
    v_permlane32_swap_b32 v26, v27
    v_max_f32 v26, v26, v27
    v_mul_f32 v26, s23, v26
    v_max_f32 v26, v26, v21
    v_sub_f32 v27, v21, v26
    v_exp_f32 v27, v27
    v_mov_b32 v21, v26
    v_mul_f32 v48, v48, v27
    v_mul_f32 v49, v49, v27
    v_mul_f32 v50, v50, v27
    v_mul_f32 v51, v51, v27
    v_mul_f32 v52, v52, v27
    v_mul_f32 v53, v53, v27
    v_mul_f32 v54, v54, v27
    v_mul_f32 v55, v55, v27
    v_mul_f32 v56, v56, v27
    v_mul_f32 v57, v57, v27
    v_mul_f32 v58, v58, v27
    v_mul_f32 v59, v59, v27
    v_mul_f32 v60, v60, v27
    v_mul_f32 v61, v61, v27
    v_mul_f32 v62, v62, v27
    v_mul_f32 v63, v63, v27
    v_fma_f32 v128, v128, s23, -v26
    v_fma_f32 v129, v129, s23, -v26
    v_fma_f32 v130, v130, s23, -v26
    v_fma_f32 v131, v131, s23, -v26
    v_fma_f32 v132, v132, s23, -v26
    v_fma_f32 v133, v133, s23, -v26
    v_fma_f32 v134, v134, s23, -v26
    v_fma_f32 v135, v135, s23, -v26
    v_fma_f32 v136, v136, s23, -v26
    v_fma_f32 v137, v137, s23, -v26
    v_fma_f32 v138, v138, s23, -v26
    v_fma_f32 v139, v139, s23, -v26
    v_fma_f32 v140, v140, s23, -v26
    v_fma_f32 v141, v141, s23, -v26
    v_fma_f32 v142, v142, s23, -v26
    v_fma_f32 v143, v143, s23, -v26
    v_fma_f32 v144, v144, s23, -v26
    v_fma_f32 v145, v145, s23, -v26
    v_fma_f32 v146, v146, s23, -v26
    v_fma_f32 v147, v147, s23, -v26
    v_fma_f32 v148, v148, s23, -v26
    v_fma_f32 v149, v149, s23, -v26
    v_fma_f32 v150, v150, s23, -v26
    v_fma_f32 v151, v151, s23, -v26
    v_fma_f32 v152, v152, s23, -v26
    v_fma_f32 v153, v153, s23, -v26
    v_fma_f32 v154, v154, s23, -v26
    v_fma_f32 v155, v155, s23, -v26
    v_fma_f32 v156, v156, s23, -v26
    v_fma_f32 v157, v157, s23, -v26
    v_fma_f32 v158, v158, s23, -v26
    v_fma_f32 v159, v159, s23, -v26
    v_fma_f32 v160, v160, s23, -v26
    v_fma_f32 v161, v161, s23, -v26
    v_fma_f32 v162, v162, s23, -v26
    v_fma_f32 v163, v163, s23, -v26
    v_fma_f32 v164, v164, s23, -v26
    v_fma_f32 v165, v165, s23, -v26
    v_fma_f32 v166, v166, s23, -v26
    v_fma_f32 v167, v167, s23, -v26
    v_fma_f32 v168, v168, s23, -v26
    v_fma_f32 v169, v169, s23, -v26
    v_fma_f32 v170, v170, s23, -v26
    v_fma_f32 v171, v171, s23, -v26
    v_fma_f32 v172, v172, s23, -v26
    v_fma_f32 v173, v173, s23, -v26
    v_fma_f32 v174, v174, s23, -v26
    v_fma_f32 v175, v175, s23, -v26
    v_fma_f32 v176, v176, s23, -v26
    v_fma_f32 v177, v177, s23, -v26
    v_fma_f32 v178, v178, s23, -v26
    v_fma_f32 v179, v179, s23, -v26
    v_fma_f32 v180, v180, s23, -v26
    v_fma_f32 v181, v181, s23, -v26
    v_fma_f32 v182, v182, s23, -v26
    v_fma_f32 v183, v183, s23, -v26
    v_fma_f32 v184, v184, s23, -v26
    v_fma_f32 v185, v185, s23, -v26
    v_fma_f32 v186, v186, s23, -v26
    v_fma_f32 v187, v187, s23, -v26
    v_fma_f32 v188, v188, s23, -v26
    v_fma_f32 v189, v189, s23, -v26
    v_fma_f32 v190, v190, s23, -v26
    v_fma_f32 v191, v191, s23, -v26
    v_exp_f32 v128, v128
    v_exp_f32 v129, v129
    v_exp_f32 v130, v130
    v_exp_f32 v131, v131
    v_exp_f32 v132, v132
    v_exp_f32 v133, v133
    v_exp_f32 v134, v134
    v_exp_f32 v135, v135
    v_exp_f32 v136, v136
    v_exp_f32 v137, v137
    v_exp_f32 v138, v138
    v_exp_f32 v139, v139
    v_exp_f32 v140, v140
    v_exp_f32 v141, v141
    v_exp_f32 v142, v142
    v_exp_f32 v143, v143
    v_exp_f32 v144, v144
    v_exp_f32 v145, v145
    v_exp_f32 v146, v146
    v_exp_f32 v147, v147
    v_exp_f32 v148, v148
    v_exp_f32 v149, v149
    v_exp_f32 v150, v150
    v_exp_f32 v151, v151
    v_exp_f32 v152, v152
    v_exp_f32 v153, v153
    v_exp_f32 v154, v154
    v_exp_f32 v155, v155
    v_exp_f32 v156, v156
    v_exp_f32 v157, v157
    v_exp_f32 v158, v158
    v_exp_f32 v159, v159
    v_exp_f32 v160, v160
    v_exp_f32 v161, v161
    v_exp_f32 v162, v162
    v_exp_f32 v163, v163
    v_exp_f32 v164, v164
    v_exp_f32 v165, v165
    v_exp_f32 v166, v166
    v_exp_f32 v167, v167
    v_exp_f32 v168, v168
    v_exp_f32 v169, v169
    v_exp_f32 v170, v170
    v_exp_f32 v171, v171
    v_exp_f32 v172, v172
    v_exp_f32 v173, v173
    v_exp_f32 v174, v174
    v_exp_f32 v175, v175
    v_exp_f32 v176, v176
    v_exp_f32 v177, v177
    v_exp_f32 v178, v178
    v_exp_f32 v179, v179
    v_exp_f32 v180, v180
    v_exp_f32 v181, v181
    v_exp_f32 v182, v182
    v_exp_f32 v183, v183
    v_exp_f32 v184, v184
    v_exp_f32 v185, v185
    v_exp_f32 v186, v186
    v_exp_f32 v187, v187
    v_exp_f32 v188, v188
    v_exp_f32 v189, v189
    v_exp_f32 v190, v190
    v_exp_f32 v191, v191
    v_cvt_pk_bf16_f32 v128, v128, v129
    v_cvt_pk_bf16_f32 v129, v130, v131
    v_cvt_pk_bf16_f32 v130, v132, v133
    v_cvt_pk_bf16_f32 v131, v134, v135
    v_cvt_pk_bf16_f32 v132, v136, v137
    v_cvt_pk_bf16_f32 v133, v138, v139
    v_cvt_pk_bf16_f32 v134, v140, v141
    v_cvt_pk_bf16_f32 v135, v142, v143
    v_cvt_pk_bf16_f32 v136, v144, v145
    v_cvt_pk_bf16_f32 v137, v146, v147
    v_cvt_pk_bf16_f32 v138, v148, v149
    v_cvt_pk_bf16_f32 v139, v150, v151
    v_cvt_pk_bf16_f32 v140, v152, v153
    v_cvt_pk_bf16_f32 v141, v154, v155
    v_cvt_pk_bf16_f32 v142, v156, v157
    v_cvt_pk_bf16_f32 v143, v158, v159
    v_cvt_pk_bf16_f32 v144, v160, v161
    v_cvt_pk_bf16_f32 v145, v162, v163
    v_cvt_pk_bf16_f32 v146, v164, v165
    v_cvt_pk_bf16_f32 v147, v166, v167
    v_cvt_pk_bf16_f32 v148, v168, v169
    v_cvt_pk_bf16_f32 v149, v170, v171
    v_cvt_pk_bf16_f32 v150, v172, v173
    v_cvt_pk_bf16_f32 v151, v174, v175
    v_cvt_pk_bf16_f32 v152, v176, v177
    v_cvt_pk_bf16_f32 v153, v178, v179
    v_cvt_pk_bf16_f32 v154, v180, v181
    v_cvt_pk_bf16_f32 v155, v182, v183
    v_cvt_pk_bf16_f32 v156, v184, v185
    v_cvt_pk_bf16_f32 v157, v186, v187
    v_cvt_pk_bf16_f32 v158, v188, v189
    v_cvt_pk_bf16_f32 v159, v190, v191
    v_mfma_f32_32x32x16_bf16 v[32:47], a[24:27], v[64:67], v[32:47]
    v_mfma_f32_32x32x16_bf16 v[32:47], a[28:31], v[68:71], v[32:47]
    v_mfma_f32_32x32x16_bf16 v[32:47], a[32:35], v[72:75], v[32:47]
    v_mfma_f32_32x32x16_bf16 v[32:47], a[36:39], v[76:79], v[32:47]
    v_mfma_f32_32x32x16_bf16 v[32:47], a[40:43], v[80:83], v[32:47]
    v_mfma_f32_32x32x16_bf16 v[32:47], a[44:47], v[84:87], v[32:47]
    v_mfma_f32_32x32x16_bf16 v[32:47], a[48:51], v[88:91], v[32:47]
    v_mfma_f32_32x32x16_bf16 v[32:47], a[52:55], v[92:95], v[32:47]
    v_mfma_f32_32x32x16_bf16 v[48:63], a[24:27], v[128:131], v[48:63]
    v_mfma_f32_32x32x16_bf16 v[48:63], a[28:31], v[132:135], v[48:63]
    v_mfma_f32_32x32x16_bf16 v[48:63], a[32:35], v[136:139], v[48:63]
    v_mfma_f32_32x32x16_bf16 v[48:63], a[36:39], v[140:143], v[48:63]
    v_mfma_f32_32x32x16_bf16 v[48:63], a[40:43], v[144:147], v[48:63]
    v_mfma_f32_32x32x16_bf16 v[48:63], a[44:47], v[148:151], v[48:63]
    v_mfma_f32_32x32x16_bf16 v[48:63], a[48:51], v[152:155], v[48:63]
    v_mfma_f32_32x32x16_bf16 v[48:63], a[52:55], v[156:159], v[48:63]
    s_waitcnt vmcnt(0)
    s_nop 10
    s_add_u32 s38, s38, 2
    s_cmp_lt_u32 s38, 16
    s_cbranch_scc1 ab_loop_90
    s_add_u32 s28, s36, 87031808
    v_mov_b32 v22, v42
    v_mov_b32 v23, v42
    s_nop 1
    v_permlane32_swap_b32 v22, v23
    v_rcp_f32 v22, v22
    s_nop 0
    v_mul_f32 v32, v32, v22
    v_mul_f32 v33, v33, v22
    v_mul_f32 v34, v34, v22
    v_mul_f32 v35, v35, v22
    v_mul_f32 v36, v36, v22
    v_mul_f32 v37, v37, v22
    v_mul_f32 v38, v38, v22
    v_mul_f32 v39, v39, v22
    v_mul_f32 v40, v40, v22
    v_mul_f32 v41, v41, v22
    v_cvt_pk_bf16_f32 v24, v32, v33
    v_cvt_pk_bf16_f32 v25, v34, v35
    v_cvt_pk_bf16_f32 v26, v36, v37
    v_cvt_pk_bf16_f32 v27, v38, v39
    v_cvt_pk_bf16_f32 v28, v40, v41
    s_add_u32 s29, s28, 0
    buffer_store_dwordx2 v[24:25], v1, s[4:7], s29 offen sc1
    buffer_store_dwordx2 v[26:27], v1, s[4:7], s29 offen offset:16 sc1
    s_mov_b32 exec_hi, 0
    buffer_store_dword v28, v1, s[4:7], s29 offen offset:32 sc1
    s_mov_b32 exec_hi, -1
    v_mov_b32 v22, v58
    v_mov_b32 v23, v58
    s_nop 1
    v_permlane32_swap_b32 v22, v23
    v_rcp_f32 v22, v22
    s_nop 0
    v_mul_f32 v48, v48, v22
    v_mul_f32 v49, v49, v22
    v_mul_f32 v50, v50, v22
    v_mul_f32 v51, v51, v22
    v_mul_f32 v52, v52, v22
    v_mul_f32 v53, v53, v22
    v_mul_f32 v54, v54, v22
    v_mul_f32 v55, v55, v22
    v_mul_f32 v56, v56, v22
    v_mul_f32 v57, v57, v22
    v_cvt_pk_bf16_f32 v24, v48, v49
    v_cvt_pk_bf16_f32 v25, v50, v51
    v_cvt_pk_bf16_f32 v26, v52, v53
    v_cvt_pk_bf16_f32 v27, v54, v55
    v_cvt_pk_bf16_f32 v28, v56, v57
    s_add_u32 s29, s28, 36864
    buffer_store_dwordx2 v[24:25], v1, s[4:7], s29 offen sc1
    buffer_store_dwordx2 v[26:27], v1, s[4:7], s29 offen offset:16 sc1
    s_mov_b32 exec_hi, 0
    buffer_store_dword v28, v1, s[4:7], s29 offen offset:32 sc1
    s_mov_b32 exec_hi, -1
    s_waitcnt vmcnt(0)
    s_and_b32 s28, s20, 31
    s_lshl_b32 s28, s28, 2
    s_add_u32 s28, s28, 65013248
    s_mov_b64 exec, 1
    v_mov_b32 v30, 1
    v_mov_b32 v31, 0
    buffer_atomic_add v30, v31, s[4:7], s28 offen
    s_mov_b64 exec, -1
    s_add_u32 s20, s20, 512
    s_nop 1
    s_cmp_lt_u32 s20, 1024
    s_cbranch_scc1 L_bl
    s_barrier
    s_cmp_ge_u32 s44, 120
    s_cbranch_scc1 L_attna
    s_sub_u32 s36, s44, 96
    v_lshrrev_b32 v33, 4, v0
    v_and_b32 v34, 15, v33
    v_lshrrev_b32 v35, 4, v33
    s_mul_hi_u32 s20, s36, 1431655766
    s_mul_i32 s28, s20, 3
    s_sub_u32 s37, s36, s28
    s_add_u32 s28, s46, 87031808
    s_addc_u32 s29, s47, 0
    s_mov_b32 s8, s28
    s_and_b32 s9, s29, 0xffff
    s_mov_b32 s10, 2359296
    s_mov_b32 s11, 0x20000
    s_mov_b32 s12, s92
    s_and_b32 s13, s93, 0xffff
    s_mov_b32 s14, 663552
    s_mov_b32 s15, 0x20000
    s_mov_b32 s40, s94
    s_and_b32 s41, s95, 0xffff
    s_mov_b32 s42, 4718592
    s_mov_b32 s43, 0x20000
    s_mul_i32 s24, s37, 384
    s_mov_b32 s25, 1152
    s_mov_b32 s21, 8
    s_mov_b32 s22, 8
    s_mov_b32 s35, 2304
    s_mul_i32 s26, s19, 96
    s_add_u32 s26, s26, s24
    s_add_u32 s26, s26, 1152
    v_lshrrev_b32 v40, 5, v33
    v_and_b32 v41, 31, v33
    s_and_b32 s28, s19, 1
    s_lshl_b32 s28, s28, 2
    v_add_u32 v42, 0, v40
    v_and_b32 v43, 3, v42
    v_or_b32 v43, s28, v43
    v_lshlrev_b32 v43, 1, v43
    v_xor_b32 v43, v43, v41
    v_lshlrev_b32 v43, 4, v43
    v_mul_lo_u32 v42, v42, s25
    v_add_u32 v52, v42, v43
    v_add_u32 v42, 2, v40
    v_and_b32 v43, 3, v42
    v_or_b32 v43, s28, v43
    v_lshlrev_b32 v43, 1, v43
    v_xor_b32 v43, v43, v41
    v_lshlrev_b32 v43, 4, v43
    v_mul_lo_u32 v42, v42, s25
    v_add_u32 v53, v42, v43
    v_add_u32 v42, 4, v40
    v_and_b32 v43, 3, v42
    v_or_b32 v43, s28, v43
    v_lshlrev_b32 v43, 1, v43
    v_xor_b32 v43, v43, v41
    v_lshlrev_b32 v43, 4, v43
    v_mul_lo_u32 v42, v42, s25
    v_add_u32 v54, v42, v43
    v_add_u32 v42, 6, v40
    v_and_b32 v43, 3, v42
    v_or_b32 v43, s28, v43
    v_lshlrev_b32 v43, 1, v43
    v_xor_b32 v43, v43, v41
    v_lshlrev_b32 v43, 4, v43
    v_mul_lo_u32 v42, v42, s25
    v_add_u32 v55, v42, v43
    v_lshrrev_b32 v40, 2, v34
    v_and_b32 v41, 3, v34
    v_and_b32 v42, 1, v35
    v_lshl_or_b32 v42, v42, 2, v40
    v_lshl_add_u32 v43, v35, 3, v40
    v_lshlrev_b32 v43, 9, v43
    v_lshl_add_u32 v43, v41, 3, v43
    s_mul_i32 s28, s19, 3
    s_add_u32 s29, s28, 0
    v_xor_b32 v44, s29, v42
    v_lshl_add_u32 v56, v44, 5, v43
    s_add_u32 s29, s28, 1
    v_xor_b32 v44, s29, v42
    v_lshl_add_u32 v57, v44, 5, v43
    s_add_u32 s29, s28, 2
    v_xor_b32 v44, s29, v42
    v_lshl_add_u32 v58, v44, 5, v43
    s_lshl_b32 s28, s19, 3
    s_add_u32 s28, s28, 0
    s_mul_i32 s28, s28, s25
    s_add_u32 s28, s28, s24
    s_lshl_b32 s29, s19, 12
    s_add_u32 s29, s29, 0
    s_add_u32 m0, s29, 0
    s_nop 0
    buffer_load_dwordx4 v52, s[12:15], s28 offen lds
    s_add_u32 m0, s29, 1024
    s_nop 0
    buffer_load_dwordx4 v53, s[12:15], s28 offen lds
    s_add_u32 m0, s29, 2048
    s_nop 0
    buffer_load_dwordx4 v54, s[12:15], s28 offen lds
    s_add_u32 m0, s29, 3072
    s_nop 0
    buffer_load_dwordx4 v55, s[12:15], s28 offen lds
    s_lshl_b32 s28, s19, 3
    s_add_u32 s28, s28, 32
    s_mul_i32 s28, s28, s25
    s_add_u32 s28, s28, s24
    s_lshl_b32 s29, s19, 12
    s_add_u32 s29, s29, 16384
    s_add_u32 m0, s29, 0
    s_nop 0
    buffer_load_dwordx4 v52, s[12:15], s28 offen lds
    s_add_u32 m0, s29, 1024
    s_nop 0
    buffer_load_dwordx4 v53, s[12:15], s28 offen lds
    s_add_u32 m0, s29, 2048
    s_nop 0
    buffer_load_dwordx4 v54, s[12:15], s28 offen lds
    s_add_u32 m0, s29, 3072
    s_nop 0
    buffer_load_dwordx4 v55, s[12:15], s28 offen lds
    s_lshl_b32 s28, s19, 3
    s_add_u32 s28, s28, 64
    s_mul_i32 s28, s28, s25
    s_add_u32 s28, s28, s24
    s_lshl_b32 s29, s19, 12
    s_add_u32 s29, s29, 32768
    s_add_u32 m0, s29, 0
    s_nop 0
    buffer_load_dwordx4 v52, s[12:15], s28 offen lds
    s_add_u32 m0, s29, 1024
    s_nop 0
    buffer_load_dwordx4 v53, s[12:15], s28 offen lds
    s_add_u32 m0, s29, 2048
    s_nop 0
    buffer_load_dwordx4 v54, s[12:15], s28 offen lds
    s_add_u32 m0, s29, 3072
    s_nop 0
    buffer_load_dwordx4 v55, s[12:15], s28 offen lds
    s_lshl_b32 s28, s19, 3
    s_add_u32 s28, s28, 96
    s_mul_i32 s28, s28, s25
    s_add_u32 s28, s28, s24
    s_lshl_b32 s29, s19, 12
    s_add_u32 s29, s29, 49152
    s_add_u32 m0, s29, 0
    s_nop 0
    buffer_load_dwordx4 v52, s[12:15], s28 offen lds
    s_add_u32 m0, s29, 1024
    s_nop 0
    buffer_load_dwordx4 v53, s[12:15], s28 offen lds
    s_add_u32 m0, s29, 2048
    s_nop 0
    buffer_load_dwordx4 v54, s[12:15], s28 offen lds
    s_add_u32 m0, s29, 3072
    s_nop 0
    buffer_load_dwordx4 v55, s[12:15], s28 offen lds
    s_lshl_b32 s28, s19, 3
    s_add_u32 s28, s28, 128
    s_mul_i32 s28, s28, s25
    s_add_u32 s28, s28, s24
    s_lshl_b32 s29, s19, 12
    s_add_u32 s29, s29, 65536
    s_add_u32 m0, s29, 0
    s_nop 0
    buffer_load_dwordx4 v52, s[12:15], s28 offen lds
    s_add_u32 m0, s29, 1024
    s_nop 0
    buffer_load_dwordx4 v53, s[12:15], s28 offen lds
    s_add_u32 m0, s29, 2048
    s_nop 0
    buffer_load_dwordx4 v54, s[12:15], s28 offen lds
    s_add_u32 m0, s29, 3072
    s_nop 0
    buffer_load_dwordx4 v55, s[12:15], s28 offen lds
    s_lshl_b32 s28, s19, 3
    s_add_u32 s28, s28, 160
    s_mul_i32 s28, s28, s25
    s_add_u32 s28, s28, s24
    s_lshl_b32 s29, s19, 12
    s_add_u32 s29, s29, 81920
    s_add_u32 m0, s29, 0
    s_nop 0
    buffer_load_dwordx4 v52, s[12:15], s28 offen lds
    s_add_u32 m0, s29, 1024
    s_nop 0
    buffer_load_dwordx4 v53, s[12:15], s28 offen lds
    s_add_u32 m0, s29, 2048
    s_nop 0
    buffer_load_dwordx4 v54, s[12:15], s28 offen lds
    s_add_u32 m0, s29, 3072
    s_nop 0
    buffer_load_dwordx4 v55, s[12:15], s28 offen lds
    s_lshl_b32 s28, s19, 3
    s_add_u32 s28, s28, 192
    s_mul_i32 s28, s28, s25
    s_add_u32 s28, s28, s24
    s_lshl_b32 s29, s19, 12
    s_add_u32 s29, s29, 98304
    s_add_u32 m0, s29, 0
    s_nop 0
    buffer_load_dwordx4 v52, s[12:15], s28 offen lds
    s_add_u32 m0, s29, 1024
    s_nop 0
    buffer_load_dwordx4 v53, s[12:15], s28 offen lds
    s_add_u32 m0, s29, 2048
    s_nop 0
    buffer_load_dwordx4 v54, s[12:15], s28 offen lds
    s_add_u32 m0, s29, 3072
    s_nop 0
    buffer_load_dwordx4 v55, s[12:15], s28 offen lds
    s_lshl_b32 s28, s19, 3
    s_add_u32 s28, s28, 224
    s_mul_i32 s28, s28, s25
    s_add_u32 s28, s28, s24
    s_lshl_b32 s29, s19, 12
    s_add_u32 s29, s29, 114688
    s_add_u32 m0, s29, 0
    s_nop 0
    buffer_load_dwordx4 v52, s[12:15], s28 offen lds
    s_add_u32 m0, s29, 1024
    s_nop 0
    buffer_load_dwordx4 v53, s[12:15], s28 offen lds
    s_add_u32 m0, s29, 2048
    s_nop 0
    buffer_load_dwordx4 v54, s[12:15], s28 offen lds
    s_add_u32 m0, s29, 3072
    s_nop 0
    buffer_load_dwordx4 v55, s[12:15], s28 offen lds
    s_lshl_b32 s28, s19, 3
    s_add_u32 s28, s28, 256
    s_mul_i32 s28, s28, s25
    s_add_u32 s28, s28, s24
    s_lshl_b32 s29, s19, 12
    s_add_u32 s29, s29, 131072
    s_add_u32 m0, s29, 0
    s_nop 0
    buffer_load_dwordx4 v52, s[12:15], s28 offen lds
    s_add_u32 m0, s29, 1024
    s_nop 0
    buffer_load_dwordx4 v53, s[12:15], s28 offen lds
    s_add_u32 m0, s29, 2048
    s_nop 0
    buffer_load_dwordx4 v54, s[12:15], s28 offen lds
    s_add_u32 m0, s29, 3072
    s_nop 0
    buffer_load_dwordx4 v55, s[12:15], s28 offen lds
    s_lshl_b32 s28, s19, 3
    s_add_u32 s28, s28, 288
    s_mul_i32 s28, s28, s25
    s_add_u32 s28, s28, s24
    s_lshl_b32 s29, s19, 12
    s_add_u32 s29, s29, 147456
    s_add_u32 m0, s29, 0
    s_nop 0
    buffer_load_dwordx4 v52, s[12:15], s28 offen lds
    s_add_u32 m0, s29, 1024
    s_nop 0
    buffer_load_dwordx4 v53, s[12:15], s28 offen lds
    s_add_u32 m0, s29, 2048
    s_nop 0
    buffer_load_dwordx4 v54, s[12:15], s28 offen lds
    s_add_u32 m0, s29, 3072
    s_nop 0
    buffer_load_dwordx4 v55, s[12:15], s28 offen lds
    s_waitcnt vmcnt(36)
    s_barrier
    v_add_u32 v44, 0, v56
    ds_read_b64_tr_b16 a[0:1], v44
    ds_read_b64_tr_b16 a[2:3], v44 offset:2048
    v_add_u32 v44, 0, v57
    ds_read_b64_tr_b16 a[72:73], v44
    ds_read_b64_tr_b16 a[74:75], v44 offset:2048
    v_add_u32 v44, 0, v58
    ds_read_b64_tr_b16 a[144:145], v44
    ds_read_b64_tr_b16 a[146:147], v44 offset:2048
    s_waitcnt lgkmcnt(0)
    s_barrier
    s_lshl_b32 s28, s19, 3
    s_add_u32 s28, s28, 320
    s_mul_i32 s28, s28, s25
    s_add_u32 s28, s28, s24
    s_lshl_b32 s29, s19, 12
    s_add_u32 s29, s29, 0
    s_add_u32 m0, s29, 0
    s_nop 0
    buffer_load_dwordx4 v52, s[12:15], s28 offen lds
    s_add_u32 m0, s29, 1024
    s_nop 0
    buffer_load_dwordx4 v53, s[12:15], s28 offen lds
    s_add_u32 m0, s29, 2048
    s_nop 0
    buffer_load_dwordx4 v54, s[12:15], s28 offen lds
    s_add_u32 m0, s29, 3072
    s_nop 0
    buffer_load_dwordx4 v55, s[12:15], s28 offen lds
    s_waitcnt vmcnt(36)
    s_barrier
    v_add_u32 v44, 16384, v56
    ds_read_b64_tr_b16 a[4:5], v44
    ds_read_b64_tr_b16 a[6:7], v44 offset:2048
    v_add_u32 v44, 16384, v57
    ds_read_b64_tr_b16 a[76:77], v44
    ds_read_b64_tr_b16 a[78:79], v44 offset:2048
    v_add_u32 v44, 16384, v58
    ds_read_b64_tr_b16 a[148:149], v44
    ds_read_b64_tr_b16 a[150:151], v44 offset:2048
    s_waitcnt lgkmcnt(0)
    s_barrier
    s_lshl_b32 s28, s19, 3
    s_add_u32 s28, s28, 352
    s_mul_i32 s28, s28, s25
    s_add_u32 s28, s28, s24
    s_lshl_b32 s29, s19, 12
    s_add_u32 s29, s29, 16384
    s_add_u32 m0, s29, 0
    s_nop 0
    buffer_load_dwordx4 v52, s[12:15], s28 offen lds
    s_add_u32 m0, s29, 1024
    s_nop 0
    buffer_load_dwordx4 v53, s[12:15], s28 offen lds
    s_add_u32 m0, s29, 2048
    s_nop 0
    buffer_load_dwordx4 v54, s[12:15], s28 offen lds
    s_add_u32 m0, s29, 3072
    s_nop 0
    buffer_load_dwordx4 v55, s[12:15], s28 offen lds
    s_waitcnt vmcnt(36)
    s_barrier
    v_add_u32 v44, 32768, v56
    ds_read_b64_tr_b16 a[8:9], v44
    ds_read_b64_tr_b16 a[10:11], v44 offset:2048
    v_add_u32 v44, 32768, v57
    ds_read_b64_tr_b16 a[80:81], v44
    ds_read_b64_tr_b16 a[82:83], v44 offset:2048
    v_add_u32 v44, 32768, v58
    ds_read_b64_tr_b16 a[152:153], v44
    ds_read_b64_tr_b16 a[154:155], v44 offset:2048
    s_waitcnt lgkmcnt(0)
    s_barrier
    s_lshl_b32 s28, s19, 3
    s_add_u32 s28, s28, 384
    s_mul_i32 s28, s28, s25
    s_add_u32 s28, s28, s24
    s_lshl_b32 s29, s19, 12
    s_add_u32 s29, s29, 32768
    s_add_u32 m0, s29, 0
    s_nop 0
    buffer_load_dwordx4 v52, s[12:15], s28 offen lds
    s_add_u32 m0, s29, 1024
    s_nop 0
    buffer_load_dwordx4 v53, s[12:15], s28 offen lds
    s_add_u32 m0, s29, 2048
    s_nop 0
    buffer_load_dwordx4 v54, s[12:15], s28 offen lds
    s_add_u32 m0, s29, 3072
    s_nop 0
    buffer_load_dwordx4 v55, s[12:15], s28 offen lds
    s_waitcnt vmcnt(36)
    s_barrier
    v_add_u32 v44, 49152, v56
    ds_read_b64_tr_b16 a[12:13], v44
    ds_read_b64_tr_b16 a[14:15], v44 offset:2048
    v_add_u32 v44, 49152, v57
    ds_read_b64_tr_b16 a[84:85], v44
    ds_read_b64_tr_b16 a[86:87], v44 offset:2048
    v_add_u32 v44, 49152, v58
    ds_read_b64_tr_b16 a[156:157], v44
    ds_read_b64_tr_b16 a[158:159], v44 offset:2048
    s_waitcnt lgkmcnt(0)
    s_barrier
    s_lshl_b32 s28, s19, 3
    s_add_u32 s28, s28, 416
    s_mul_i32 s28, s28, s25
    s_add_u32 s28, s28, s24
    s_lshl_b32 s29, s19, 12
    s_add_u32 s29, s29, 49152
    s_add_u32 m0, s29, 0
    s_nop 0
    buffer_load_dwordx4 v52, s[12:15], s28 offen lds
    s_add_u32 m0, s29, 1024
    s_nop 0
    buffer_load_dwordx4 v53, s[12:15], s28 offen lds
    s_add_u32 m0, s29, 2048
    s_nop 0
    buffer_load_dwordx4 v54, s[12:15], s28 offen lds
    s_add_u32 m0, s29, 3072
    s_nop 0
    buffer_load_dwordx4 v55, s[12:15], s28 offen lds
    s_waitcnt vmcnt(36)
    s_barrier
    v_add_u32 v44, 65536, v56
    ds_read_b64_tr_b16 a[16:17], v44
    ds_read_b64_tr_b16 a[18:19], v44 offset:2048
    v_add_u32 v44, 65536, v57
    ds_read_b64_tr_b16 a[88:89], v44
    ds_read_b64_tr_b16 a[90:91], v44 offset:2048
    v_add_u32 v44, 65536, v58
    ds_read_b64_tr_b16 a[160:161], v44
    ds_read_b64_tr_b16 a[162:163], v44 offset:2048
    s_waitcnt lgkmcnt(0)
    s_barrier
    s_lshl_b32 s28, s19, 3
    s_add_u32 s28, s28, 448
    s_mul_i32 s28, s28, s25
    s_add_u32 s28, s28, s24
    s_lshl_b32 s29, s19, 12
    s_add_u32 s29, s29, 65536
    s_add_u32 m0, s29, 0
    s_nop 0
    buffer_load_dwordx4 v52, s[12:15], s28 offen lds
    s_add_u32 m0, s29, 1024
    s_nop 0
    buffer_load_dwordx4 v53, s[12:15], s28 offen lds
    s_add_u32 m0, s29, 2048
    s_nop 0
    buffer_load_dwordx4 v54, s[12:15], s28 offen lds
    s_add_u32 m0, s29, 3072
    s_nop 0
    buffer_load_dwordx4 v55, s[12:15], s28 offen lds
    s_waitcnt vmcnt(36)
    s_barrier
    v_add_u32 v44, 81920, v56
    ds_read_b64_tr_b16 a[20:21], v44
    ds_read_b64_tr_b16 a[22:23], v44 offset:2048
    v_add_u32 v44, 81920, v57
    ds_read_b64_tr_b16 a[92:93], v44
    ds_read_b64_tr_b16 a[94:95], v44 offset:2048
    v_add_u32 v44, 81920, v58
    ds_read_b64_tr_b16 a[164:165], v44
    ds_read_b64_tr_b16 a[166:167], v44 offset:2048
    s_waitcnt lgkmcnt(0)
    s_barrier
    s_lshl_b32 s28, s19, 3
    s_add_u32 s28, s28, 480
    s_mul_i32 s28, s28, s25
    s_add_u32 s28, s28, s24
    s_lshl_b32 s29, s19, 12
    s_add_u32 s29, s29, 81920
    s_add_u32 m0, s29, 0
    s_nop 0
    buffer_load_dwordx4 v52, s[12:15], s28 offen lds
    s_add_u32 m0, s29, 1024
    s_nop 0
    buffer_load_dwordx4 v53, s[12:15], s28 offen lds
    s_add_u32 m0, s29, 2048
    s_nop 0
    buffer_load_dwordx4 v54, s[12:15], s28 offen lds
    s_add_u32 m0, s29, 3072
    s_nop 0
    buffer_load_dwordx4 v55, s[12:15], s28 offen lds
    s_waitcnt vmcnt(36)
    s_barrier
    v_add_u32 v44, 98304, v56
    ds_read_b64_tr_b16 a[24:25], v44
    ds_read_b64_tr_b16 a[26:27], v44 offset:2048
    v_add_u32 v44, 98304, v57
    ds_read_b64_tr_b16 a[96:97], v44
    ds_read_b64_tr_b16 a[98:99], v44 offset:2048
    v_add_u32 v44, 98304, v58
    ds_read_b64_tr_b16 a[168:169], v44
    ds_read_b64_tr_b16 a[170:171], v44 offset:2048
    s_waitcnt lgkmcnt(0)
    s_barrier
    s_lshl_b32 s28, s19, 3
    s_add_u32 s28, s28, 512
    s_mul_i32 s28, s28, s25
    s_add_u32 s28, s28, s24
    s_lshl_b32 s29, s19, 12
    s_add_u32 s29, s29, 98304
    s_add_u32 m0, s29, 0
    s_nop 0
    buffer_load_dwordx4 v52, s[12:15], s28 offen lds
    s_add_u32 m0, s29, 1024
    s_nop 0
    buffer_load_dwordx4 v53, s[12:15], s28 offen lds
    s_add_u32 m0, s29, 2048
    s_nop 0
    buffer_load_dwordx4 v54, s[12:15], s28 offen lds
    s_add_u32 m0, s29, 3072
    s_nop 0
    buffer_load_dwordx4 v55, s[12:15], s28 offen lds
    s_waitcnt vmcnt(36)
    s_barrier
    v_add_u32 v44, 114688, v56
    ds_read_b64_tr_b16 a[28:29], v44
    ds_read_b64_tr_b16 a[30:31], v44 offset:2048
    v_add_u32 v44, 114688, v57
    ds_read_b64_tr_b16 a[100:101], v44
    ds_read_b64_tr_b16 a[102:103], v44 offset:2048
    v_add_u32 v44, 114688, v58
    ds_read_b64_tr_b16 a[172:173], v44
    ds_read_b64_tr_b16 a[174:175], v44 offset:2048
    s_waitcnt lgkmcnt(0)
    s_barrier
    s_lshl_b32 s28, s19, 3
    s_add_u32 s28, s28, 544
    s_mul_i32 s28, s28, s25
    s_add_u32 s28, s28, s24
    s_lshl_b32 s29, s19, 12
    s_add_u32 s29, s29, 114688
    s_add_u32 m0, s29, 0
    s_nop 0
    buffer_load_dwordx4 v52, s[12:15], s28 offen lds
    s_add_u32 m0, s29, 1024
    s_nop 0
    buffer_load_dwordx4 v53, s[12:15], s28 offen lds
    s_add_u32 m0, s29, 2048
    s_nop 0
    buffer_load_dwordx4 v54, s[12:15], s28 offen lds
    s_add_u32 m0, s29, 3072
    s_nop 0
    buffer_load_dwordx4 v55, s[12:15], s28 offen lds
    s_waitcnt vmcnt(36)
    s_barrier
    v_add_u32 v44, 131072, v56
    ds_read_b64_tr_b16 a[32:33], v44
    ds_read_b64_tr_b16 a[34:35], v44 offset:2048
    v_add_u32 v44, 131072, v57
    ds_read_b64_tr_b16 a[104:105], v44
    ds_read_b64_tr_b16 a[106:107], v44 offset:2048
    v_add_u32 v44, 131072, v58
    ds_read_b64_tr_b16 a[176:177], v44
    ds_read_b64_tr_b16 a[178:179], v44 offset:2048
    s_waitcnt lgkmcnt(0)
    s_barrier
    s_waitcnt vmcnt(32)
    s_barrier
    v_add_u32 v44, 147456, v56
    ds_read_b64_tr_b16 a[36:37], v44
    ds_read_b64_tr_b16 a[38:39], v44 offset:2048
    v_add_u32 v44, 147456, v57
    ds_read_b64_tr_b16 a[108:109], v44
    ds_read_b64_tr_b16 a[110:111], v44 offset:2048
    v_add_u32 v44, 147456, v58
    ds_read_b64_tr_b16 a[180:181], v44
    ds_read_b64_tr_b16 a[182:183], v44 offset:2048
    s_waitcnt lgkmcnt(0)
    s_barrier
    s_waitcnt vmcnt(28)
    s_barrier
    v_add_u32 v44, 0, v56
    ds_read_b64_tr_b16 a[40:41], v44
    ds_read_b64_tr_b16 a[42:43], v44 offset:2048
    v_add_u32 v44, 0, v57
    ds_read_b64_tr_b16 a[112:113], v44
    ds_read_b64_tr_b16 a[114:115], v44 offset:2048
    v_add_u32 v44, 0, v58
    ds_read_b64_tr_b16 a[184:185], v44
    ds_read_b64_tr_b16 a[186:187], v44 offset:2048
    s_waitcnt lgkmcnt(0)
    s_barrier
    s_waitcnt vmcnt(24)
    s_barrier
    v_add_u32 v44, 16384, v56
    ds_read_b64_tr_b16 a[44:45], v44
    ds_read_b64_tr_b16 a[46:47], v44 offset:2048
    v_add_u32 v44, 16384, v57
    ds_read_b64_tr_b16 a[116:117], v44
    ds_read_b64_tr_b16 a[118:119], v44 offset:2048
    v_add_u32 v44, 16384, v58
    ds_read_b64_tr_b16 a[188:189], v44
    ds_read_b64_tr_b16 a[190:191], v44 offset:2048
    s_waitcnt lgkmcnt(0)
    s_barrier
    s_waitcnt vmcnt(20)
    s_barrier
    v_add_u32 v44, 32768, v56
    ds_read_b64_tr_b16 a[48:49], v44
    ds_read_b64_tr_b16 a[50:51], v44 offset:2048
    v_add_u32 v44, 32768, v57
    ds_read_b64_tr_b16 a[120:121], v44
    ds_read_b64_tr_b16 a[122:123], v44 offset:2048
    v_add_u32 v44, 32768, v58
    ds_read_b64_tr_b16 a[192:193], v44
    ds_read_b64_tr_b16 a[194:195], v44 offset:2048
    s_waitcnt lgkmcnt(0)
    s_barrier
    s_waitcnt vmcnt(16)
    s_barrier
    v_add_u32 v44, 49152, v56
    ds_read_b64_tr_b16 a[52:53], v44
    ds_read_b64_tr_b16 a[54:55], v44 offset:2048
    v_add_u32 v44, 49152, v57
    ds_read_b64_tr_b16 a[124:125], v44
    ds_read_b64_tr_b16 a[126:127], v44 offset:2048
    v_add_u32 v44, 49152, v58
    ds_read_b64_tr_b16 a[196:197], v44
    ds_read_b64_tr_b16 a[198:199], v44 offset:2048
    s_waitcnt lgkmcnt(0)
    s_barrier
    s_waitcnt vmcnt(12)
    s_barrier
    v_add_u32 v44, 65536, v56
    ds_read_b64_tr_b16 a[56:57], v44
    ds_read_b64_tr_b16 a[58:59], v44 offset:2048
    v_add_u32 v44, 65536, v57
    ds_read_b64_tr_b16 a[128:129], v44
    ds_read_b64_tr_b16 a[130:131], v44 offset:2048
    v_add_u32 v44, 65536, v58
    ds_read_b64_tr_b16 a[200:201], v44
    ds_read_b64_tr_b16 a[202:203], v44 offset:2048
    s_waitcnt lgkmcnt(0)
    s_barrier
    s_waitcnt vmcnt(8)
    s_barrier
    v_add_u32 v44, 81920, v56
    ds_read_b64_tr_b16 a[60:61], v44
    ds_read_b64_tr_b16 a[62:63], v44 offset:2048
    v_add_u32 v44, 81920, v57
    ds_read_b64_tr_b16 a[132:133], v44
    ds_read_b64_tr_b16 a[134:135], v44 offset:2048
    v_add_u32 v44, 81920, v58
    ds_read_b64_tr_b16 a[204:205], v44
    ds_read_b64_tr_b16 a[206:207], v44 offset:2048
    s_waitcnt lgkmcnt(0)
    s_barrier
    s_waitcnt vmcnt(4)
    s_barrier
    v_add_u32 v44, 98304, v56
    ds_read_b64_tr_b16 a[64:65], v44
    ds_read_b64_tr_b16 a[66:67], v44 offset:2048
    v_add_u32 v44, 98304, v57
    ds_read_b64_tr_b16 a[136:137], v44
    ds_read_b64_tr_b16 a[138:139], v44 offset:2048
    v_add_u32 v44, 98304, v58
    ds_read_b64_tr_b16 a[208:209], v44
    ds_read_b64_tr_b16 a[210:211], v44 offset:2048
    s_waitcnt lgkmcnt(0)
    s_barrier
    s_waitcnt vmcnt(0)
    s_barrier
    v_add_u32 v44, 114688, v56
    ds_read_b64_tr_b16 a[68:69], v44
    ds_read_b64_tr_b16 a[70:71], v44 offset:2048
    v_add_u32 v44, 114688, v57
    ds_read_b64_tr_b16 a[140:141], v44
    ds_read_b64_tr_b16 a[142:143], v44 offset:2048
    v_add_u32 v44, 114688, v58
    ds_read_b64_tr_b16 a[212:213], v44
    ds_read_b64_tr_b16 a[214:215], v44 offset:2048
    s_waitcnt lgkmcnt(0)
    s_barrier
    v_lshrrev_b32 v40, 2, v33
    v_lshrrev_b32 v41, 4, v33
    v_lshrrev_b32 v43, 1, v41
    v_xor_b32 v42, v41, v43
    v_and_b32 v42, 1, v42
    v_lshl_or_b32 v42, v42, 1, v43
    v_and_b32 v43, 3, v33
    v_xor_b32 v42, v42, v43
    v_mul_u32_u24 v1, 1152, v40
    v_lshl_add_u32 v1, v42, 4, v1
    v_lshrrev_b32 v41, 2, v34
    v_lshrrev_b32 v43, 1, v41
    v_xor_b32 v42, v41, v43
    v_and_b32 v42, 1, v42
    v_lshl_or_b32 v42, v42, 1, v43
    v_xor_b32 v42, v42, v35
    v_lshlrev_b32 v2, 6, v34
    v_lshl_add_u32 v2, v42, 4, v2
    v_mul_u32_u24 v4, 2304, v34
    v_lshl_add_u32 v4, v35, 3, v4
    s_mov_b32 s23, 0
    s_mov_b32 s34, 0
    s_mov_b32 s33, -1
    s_lshr_b32 s28, s20, 1
    s_lshl_b32 s28, s28, 2
    s_add_u32 s28, s28, 65013248
    s_mov_b32 s45, s28
    s_cmp_lg_u32 s99, 0
    s_cbranch_scc1 pd_92
    s_mov_b32 s29, s45
    s_mov_b32 s30, 0
    v_mov_b32 v48, 0
pw_91:
    buffer_load_dword v49, v48, s[4:7], s29 offen sc1
    s_waitcnt vmcnt(0)
    v_readfirstlane_b32 s28, v49
    s_nop 0
    s_cmp_ge_u32 s28, 32
    s_cbranch_scc1 pd_92
    s_sleep 32
    s_add_u32 s30, s30, 1
    s_cmp_lt_u32 s30, 0x100000
    s_cbranch_scc1 pw_91
    s_mov_b32 s99, 1
pd_92:
    s_mul_i32 s28, s20, 36864
    s_lshr_b32 s29, s19, 1
    s_mul_i32 s29, s29, 18432
    s_add_u32 s28, s28, s29
    s_and_b32 s29, s19, 1
    s_mul_i32 s29, s29, 576
    s_add_u32 s28, s28, s29
    s_mul_i32 s29, s19, 9216
    s_add_u32 s29, s29, s34
    s_add_u32 m0, s29, 0
    s_add_u32 s30, s28, 0
    buffer_load_dwordx4 v1, s[8:11], s30 offen sc1 lds
    s_add_u32 m0, s29, 1024
    s_add_u32 s30, s28, 64
    buffer_load_dwordx4 v1, s[8:11], s30 offen sc1 lds
    s_add_u32 m0, s29, 2048
    s_add_u32 s30, s28, 128
    buffer_load_dwordx4 v1, s[8:11], s30 offen sc1 lds
    s_add_u32 m0, s29, 3072
    s_add_u32 s30, s28, 192
    buffer_load_dwordx4 v1, s[8:11], s30 offen sc1 lds
    s_add_u32 m0, s29, 4096
    s_add_u32 s30, s28, 256
    buffer_load_dwordx4 v1, s[8:11], s30 offen sc1 lds
    s_add_u32 m0, s29, 5120
    s_add_u32 s30, s28, 320
    buffer_load_dwordx4 v1, s[8:11], s30 offen sc1 lds
    s_add_u32 m0, s29, 6144
    s_add_u32 s30, s28, 384
    buffer_load_dwordx4 v1, s[8:11], s30 offen sc1 lds
    s_add_u32 m0, s29, 7168
    s_add_u32 s30, s28, 448
    buffer_load_dwordx4 v1, s[8:11], s30 offen sc1 lds
    s_add_u32 m0, s29, 8192
    s_add_u32 s30, s28, 512
    buffer_load_dwordx4 v1, s[8:11], s30 offen sc1 lds
    s_waitcnt vmcnt(0)
g_loop_93:
    s_waitcnt vmcnt(6)
    s_barrier
    s_add_u32 s31, s23, 1
    s_cmp_ge_u32 s31, s22
    s_cbranch_scc1 nopf_94
    s_add_u32 s32, s20, s21
    s_sub_u32 s31, 36864, s34
    s_add_u32 s31, s31, 0
    s_mov_b32 s39, s31
    s_lshr_b32 s28, s32, 1
    s_lshl_b32 s28, s28, 2
    s_add_u32 s28, s28, 65013248
    s_mov_b32 s45, s28
    s_cmp_lg_u32 s99, 0
    s_cbranch_scc1 pd_96
    s_mov_b32 s29, s45
    s_mov_b32 s30, 0
    v_mov_b32 v48, 0
pw_95:
    buffer_load_dword v49, v48, s[4:7], s29 offen sc1
    s_waitcnt vmcnt(0)
    v_readfirstlane_b32 s28, v49
    s_nop 0
    s_cmp_ge_u32 s28, 32
    s_cbranch_scc1 pd_96
    s_sleep 32
    s_add_u32 s30, s30, 1
    s_cmp_lt_u32 s30, 0x100000
    s_cbranch_scc1 pw_95
    s_mov_b32 s99, 1
pd_96:
    s_mov_b32 s31, s39
    s_mul_i32 s28, s32, 36864
    s_lshr_b32 s29, s19, 1
    s_mul_i32 s29, s29, 18432
    s_add_u32 s28, s28, s29
    s_and_b32 s29, s19, 1
    s_mul_i32 s29, s29, 576
    s_add_u32 s28, s28, s29
    s_mul_i32 s29, s19, 9216
    s_add_u32 s29, s29, s31
    s_add_u32 m0, s29, 0
    s_add_u32 s30, s28, 0
    buffer_load_dwordx4 v1, s[8:11], s30 offen sc1 lds
    s_add_u32 m0, s29, 1024
    s_add_u32 s30, s28, 64
    buffer_load_dwordx4 v1, s[8:11], s30 offen sc1 lds
    s_add_u32 m0, s29, 2048
    s_add_u32 s30, s28, 128
    buffer_load_dwordx4 v1, s[8:11], s30 offen sc1 lds
    s_add_u32 m0, s29, 3072
    s_add_u32 s30, s28, 192
    buffer_load_dwordx4 v1, s[8:11], s30 offen sc1 lds
    s_add_u32 m0, s29, 4096
    s_add_u32 s30, s28, 256
    buffer_load_dwordx4 v1, s[8:11], s30 offen sc1 lds
    s_add_u32 m0, s29, 5120
    s_add_u32 s30, s28, 320
    buffer_load_dwordx4 v1, s[8:11], s30 offen sc1 lds
    s_add_u32 m0, s29, 6144
    s_add_u32 s30, s28, 384
    buffer_load_dwordx4 v1, s[8:11], s30 offen sc1 lds
    s_add_u32 m0, s29, 7168
    s_add_u32 s30, s28, 448
    buffer_load_dwordx4 v1, s[8:11], s30 offen sc1 lds
    s_add_u32 m0, s29, 8192
    s_add_u32 s30, s28, 512
    buffer_load_dwordx4 v1, s[8:11], s30 offen sc1 lds
nopf_94:
    v_add_u32 v3, s34, v2
    ds_read_b128 v[32:35], v3 offset:0
    ds_read_b128 v[36:39], v3 offset:18432
    ds_read_b128 v[40:43], v3 offset:1024
    ds_read_b128 v[44:47], v3 offset:19456
    s_waitcnt lgkmcnt(3)
    v_mfma_f32_16x16x32_bf16 v[64:67], a[0:3], v[32:35], 0
    s_waitcnt lgkmcnt(2)
    v_mfma_f32_16x16x32_bf16 v[68:71], a[0:3], v[36:39], 0
    v_mfma_f32_16x16x32_bf16 v[72:75], a[72:75], v[32:35], 0
    v_mfma_f32_16x16x32_bf16 v[76:79], a[72:75], v[36:39], 0
    v_mfma_f32_16x16x32_bf16 v[80:83], a[144:147], v[32:35], 0
    v_mfma_f32_16x16x32_bf16 v[84:87], a[144:147], v[36:39], 0
    ds_read_b128 v[32:35], v3 offset:2048
    ds_read_b128 v[36:39], v3 offset:20480
    s_waitcnt lgkmcnt(3)
    v_mfma_f32_16x16x32_bf16 v[64:67], a[4:7], v[40:43], v[64:67]
    s_waitcnt lgkmcnt(2)
    v_mfma_f32_16x16x32_bf16 v[68:71], a[4:7], v[44:47], v[68:71]
    v_mfma_f32_16x16x32_bf16 v[72:75], a[76:79], v[40:43], v[72:75]
    v_mfma_f32_16x16x32_bf16 v[76:79], a[76:79], v[44:47], v[76:79]
    v_mfma_f32_16x16x32_bf16 v[80:83], a[148:151], v[40:43], v[80:83]
    v_mfma_f32_16x16x32_bf16 v[84:87], a[148:151], v[44:47], v[84:87]
    ds_read_b128 v[40:43], v3 offset:3072
    ds_read_b128 v[44:47], v3 offset:21504
    s_waitcnt lgkmcnt(3)
    v_mfma_f32_16x16x32_bf16 v[64:67], a[8:11], v[32:35], v[64:67]
    s_waitcnt lgkmcnt(2)
    v_mfma_f32_16x16x32_bf16 v[68:71], a[8:11], v[36:39], v[68:71]
    v_mfma_f32_16x16x32_bf16 v[72:75], a[80:83], v[32:35], v[72:75]
    v_mfma_f32_16x16x32_bf16 v[76:79], a[80:83], v[36:39], v[76:79]
    v_mfma_f32_16x16x32_bf16 v[80:83], a[152:155], v[32:35], v[80:83]
    v_mfma_f32_16x16x32_bf16 v[84:87], a[152:155], v[36:39], v[84:87]
    ds_read_b128 v[32:35], v3 offset:4096
    ds_read_b128 v[36:39], v3 offset:22528
    s_waitcnt lgkmcnt(3)
    v_mfma_f32_16x16x32_bf16 v[64:67], a[12:15], v[40:43], v[64:67]
    s_waitcnt lgkmcnt(2)
    v_mfma_f32_16x16x32_bf16 v[68:71], a[12:15], v[44:47], v[68:71]
    v_mfma_f32_16x16x32_bf16 v[72:75], a[84:87], v[40:43], v[72:75]
    v_mfma_f32_16x16x32_bf16 v[76:79], a[84:87], v[44:47], v[76:79]
    v_mfma_f32_16x16x32_bf16 v[80:83], a[156:159], v[40:43], v[80:83]
    v_mfma_f32_16x16x32_bf16 v[84:87], a[156:159], v[44:47], v[84:87]
    ds_read_b128 v[40:43], v3 offset:5120
    ds_read_b128 v[44:47], v3 offset:23552
    s_waitcnt lgkmcnt(3)
    v_mfma_f32_16x16x32_bf16 v[64:67], a[16:19], v[32:35], v[64:67]
    s_waitcnt lgkmcnt(2)
    v_mfma_f32_16x16x32_bf16 v[68:71], a[16:19], v[36:39], v[68:71]
    v_mfma_f32_16x16x32_bf16 v[72:75], a[88:91], v[32:35], v[72:75]
    v_mfma_f32_16x16x32_bf16 v[76:79], a[88:91], v[36:39], v[76:79]
    v_mfma_f32_16x16x32_bf16 v[80:83], a[160:163], v[32:35], v[80:83]
    v_mfma_f32_16x16x32_bf16 v[84:87], a[160:163], v[36:39], v[84:87]
    ds_read_b128 v[32:35], v3 offset:6144
    ds_read_b128 v[36:39], v3 offset:24576
    s_waitcnt lgkmcnt(3)
    v_mfma_f32_16x16x32_bf16 v[64:67], a[20:23], v[40:43], v[64:67]
    s_waitcnt lgkmcnt(2)
    v_mfma_f32_16x16x32_bf16 v[68:71], a[20:23], v[44:47], v[68:71]
    v_mfma_f32_16x16x32_bf16 v[72:75], a[92:95], v[40:43], v[72:75]
    v_mfma_f32_16x16x32_bf16 v[76:79], a[92:95], v[44:47], v[76:79]
    v_mfma_f32_16x16x32_bf16 v[80:83], a[164:167], v[40:43], v[80:83]
    v_mfma_f32_16x16x32_bf16 v[84:87], a[164:167], v[44:47], v[84:87]
    ds_read_b128 v[40:43], v3 offset:7168
    ds_read_b128 v[44:47], v3 offset:25600
    s_waitcnt lgkmcnt(3)
    v_mfma_f32_16x16x32_bf16 v[64:67], a[24:27], v[32:35], v[64:67]
    s_waitcnt lgkmcnt(2)
    v_mfma_f32_16x16x32_bf16 v[68:71], a[24:27], v[36:39], v[68:71]
    v_mfma_f32_16x16x32_bf16 v[72:75], a[96:99], v[32:35], v[72:75]
    v_mfma_f32_16x16x32_bf16 v[76:79], a[96:99], v[36:39], v[76:79]
    v_mfma_f32_16x16x32_bf16 v[80:83], a[168:171], v[32:35], v[80:83]
    v_mfma_f32_16x16x32_bf16 v[84:87], a[168:171], v[36:39], v[84:87]
    ds_read_b128 v[32:35], v3 offset:8192
    ds_read_b128 v[36:39], v3 offset:26624
    s_waitcnt lgkmcnt(3)
    v_mfma_f32_16x16x32_bf16 v[64:67], a[28:31], v[40:43], v[64:67]
    s_waitcnt lgkmcnt(2)
    v_mfma_f32_16x16x32_bf16 v[68:71], a[28:31], v[44:47], v[68:71]
    v_mfma_f32_16x16x32_bf16 v[72:75], a[100:103], v[40:43], v[72:75]
    v_mfma_f32_16x16x32_bf16 v[76:79], a[100:103], v[44:47], v[76:79]
    v_mfma_f32_16x16x32_bf16 v[80:83], a[172:175], v[40:43], v[80:83]
    v_mfma_f32_16x16x32_bf16 v[84:87], a[172:175], v[44:47], v[84:87]
    ds_read_b128 v[40:43], v3 offset:9216
    ds_read_b128 v[44:47], v3 offset:27648
    s_waitcnt lgkmcnt(3)
    v_mfma_f32_16x16x32_bf16 v[64:67], a[32:35], v[32:35], v[64:67]
    s_waitcnt lgkmcnt(2)
    v_mfma_f32_16x16x32_bf16 v[68:71], a[32:35], v[36:39], v[68:71]
    v_mfma_f32_16x16x32_bf16 v[72:75], a[104:107], v[32:35], v[72:75]
    v_mfma_f32_16x16x32_bf16 v[76:79], a[104:107], v[36:39], v[76:79]
    v_mfma_f32_16x16x32_bf16 v[80:83], a[176:179], v[32:35], v[80:83]
    v_mfma_f32_16x16x32_bf16 v[84:87], a[176:179], v[36:39], v[84:87]
    ds_read_b128 v[32:35], v3 offset:10240
    ds_read_b128 v[36:39], v3 offset:28672
    s_waitcnt lgkmcnt(3)
    v_mfma_f32_16x16x32_bf16 v[64:67], a[36:39], v[40:43], v[64:67]
    s_waitcnt lgkmcnt(2)
    v_mfma_f32_16x16x32_bf16 v[68:71], a[36:39], v[44:47], v[68:71]
    v_mfma_f32_16x16x32_bf16 v[72:75], a[108:111], v[40:43], v[72:75]
    v_mfma_f32_16x16x32_bf16 v[76:79], a[108:111], v[44:47], v[76:79]
    v_mfma_f32_16x16x32_bf16 v[80:83], a[180:183], v[40:43], v[80:83]
    v_mfma_f32_16x16x32_bf16 v[84:87], a[180:183], v[44:47], v[84:87]
    ds_read_b128 v[40:43], v3 offset:11264
    ds_read_b128 v[44:47], v3 offset:29696
    s_waitcnt lgkmcnt(3)
    v_mfma_f32_16x16x32_bf16 v[64:67], a[40:43], v[32:35], v[64:67]
    s_waitcnt lgkmcnt(2)
    v_mfma_f32_16x16x32_bf16 v[68:71], a[40:43], v[36:39], v[68:71]
    v_mfma_f32_16x16x32_bf16 v[72:75], a[112:115], v[32:35], v[72:75]
    v_mfma_f32_16x16x32_bf16 v[76:79], a[112:115], v[36:39], v[76:79]
    v_mfma_f32_16x16x32_bf16 v[80:83], a[184:187], v[32:35], v[80:83]
    v_mfma_f32_16x16x32_bf16 v[84:87], a[184:187], v[36:39], v[84:87]
    ds_read_b128 v[32:35], v3 offset:12288
    ds_read_b128 v[36:39], v3 offset:30720
    s_waitcnt lgkmcnt(3)
    v_mfma_f32_16x16x32_bf16 v[64:67], a[44:47], v[40:43], v[64:67]
    s_waitcnt lgkmcnt(2)
    v_mfma_f32_16x16x32_bf16 v[68:71], a[44:47], v[44:47], v[68:71]
    v_mfma_f32_16x16x32_bf16 v[72:75], a[116:119], v[40:43], v[72:75]
    v_mfma_f32_16x16x32_bf16 v[76:79], a[116:119], v[44:47], v[76:79]
    v_mfma_f32_16x16x32_bf16 v[80:83], a[188:191], v[40:43], v[80:83]
    v_mfma_f32_16x16x32_bf16 v[84:87], a[188:191], v[44:47], v[84:87]
    ds_read_b128 v[40:43], v3 offset:13312
    ds_read_b128 v[44:47], v3 offset:31744
    s_waitcnt lgkmcnt(3)
    v_mfma_f32_16x16x32_bf16 v[64:67], a[48:51], v[32:35], v[64:67]
    s_waitcnt lgkmcnt(2)
    v_mfma_f32_16x16x32_bf16 v[68:71], a[48:51], v[36:39], v[68:71]
    v_mfma_f32_16x16x32_bf16 v[72:75], a[120:123], v[32:35], v[72:75]
    v_mfma_f32_16x16x32_bf16 v[76:79], a[120:123], v[36:39], v[76:79]
    v_mfma_f32_16x16x32_bf16 v[80:83], a[192:195], v[32:35], v[80:83]
    v_mfma_f32_16x16x32_bf16 v[84:87], a[192:195], v[36:39], v[84:87]
    ds_read_b128 v[32:35], v3 offset:14336
    ds_read_b128 v[36:39], v3 offset:32768
    s_waitcnt lgkmcnt(3)
    v_mfma_f32_16x16x32_bf16 v[64:67], a[52:55], v[40:43], v[64:67]
    s_waitcnt lgkmcnt(2)
    v_mfma_f32_16x16x32_bf16 v[68:71], a[52:55], v[44:47], v[68:71]
    v_mfma_f32_16x16x32_bf16 v[72:75], a[124:127], v[40:43], v[72:75]
    v_mfma_f32_16x16x32_bf16 v[76:79], a[124:127], v[44:47], v[76:79]
    v_mfma_f32_16x16x32_bf16 v[80:83], a[196:199], v[40:43], v[80:83]
    v_mfma_f32_16x16x32_bf16 v[84:87], a[196:199], v[44:47], v[84:87]
    ds_read_b128 v[40:43], v3 offset:15360
    ds_read_b128 v[44:47], v3 offset:33792
    s_waitcnt lgkmcnt(3)
    v_mfma_f32_16x16x32_bf16 v[64:67], a[56:59], v[32:35], v[64:67]
    s_waitcnt lgkmcnt(2)
    v_mfma_f32_16x16x32_bf16 v[68:71], a[56:59], v[36:39], v[68:71]
    v_mfma_f32_16x16x32_bf16 v[72:75], a[128:131], v[32:35], v[72:75]
    v_mfma_f32_16x16x32_bf16 v[76:79], a[128:131], v[36:39], v[76:79]
    v_mfma_f32_16x16x32_bf16 v[80:83], a[200:203], v[32:35], v[80:83]
    v_mfma_f32_16x16x32_bf16 v[84:87], a[200:203], v[36:39], v[84:87]
    ds_read_b128 v[32:35], v3 offset:16384
    ds_read_b128 v[36:39], v3 offset:34816
    s_waitcnt lgkmcnt(3)
    v_mfma_f32_16x16x32_bf16 v[64:67], a[60:63], v[40:43], v[64:67]
    s_waitcnt lgkmcnt(2)
    v_mfma_f32_16x16x32_bf16 v[68:71], a[60:63], v[44:47], v[68:71]
    v_mfma_f32_16x16x32_bf16 v[72:75], a[132:135], v[40:43], v[72:75]
    v_mfma_f32_16x16x32_bf16 v[76:79], a[132:135], v[44:47], v[76:79]
    v_mfma_f32_16x16x32_bf16 v[80:83], a[204:207], v[40:43], v[80:83]
    v_mfma_f32_16x16x32_bf16 v[84:87], a[204:207], v[44:47], v[84:87]
    ds_read_b128 v[40:43], v3 offset:17408
    ds_read_b128 v[44:47], v3 offset:35840
    s_waitcnt lgkmcnt(3)
    v_mfma_f32_16x16x32_bf16 v[64:67], a[64:67], v[32:35], v[64:67]
    s_waitcnt lgkmcnt(2)
    v_mfma_f32_16x16x32_bf16 v[68:71], a[64:67], v[36:39], v[68:71]
    v_mfma_f32_16x16x32_bf16 v[72:75], a[136:139], v[32:35], v[72:75]
    v_mfma_f32_16x16x32_bf16 v[76:79], a[136:139], v[36:39], v[76:79]
    v_mfma_f32_16x16x32_bf16 v[80:83], a[208:211], v[32:35], v[80:83]
    v_mfma_f32_16x16x32_bf16 v[84:87], a[208:211], v[36:39], v[84:87]
    s_waitcnt lgkmcnt(1)
    v_mfma_f32_16x16x32_bf16 v[64:67], a[68:71], v[40:43], v[64:67]
    s_waitcnt lgkmcnt(0)
    v_mfma_f32_16x16x32_bf16 v[68:71], a[68:71], v[44:47], v[68:71]
    v_mfma_f32_16x16x32_bf16 v[72:75], a[140:143], v[40:43], v[72:75]
    v_mfma_f32_16x16x32_bf16 v[76:79], a[140:143], v[44:47], v[76:79]
    v_mfma_f32_16x16x32_bf16 v[80:83], a[212:215], v[40:43], v[80:83]
    v_mfma_f32_16x16x32_bf16 v[84:87], a[212:215], v[44:47], v[84:87]
    s_lshl_b32 s28, s20, 5
    s_add_u32 s28, s28, 0
    s_mul_i32 s28, s28, s35
    s_add_u32 s28, s28, s26
    v_cvt_pk_bf16_f32 v48, v64, v65
    v_cvt_pk_bf16_f32 v49, v66, v67
    buffer_store_dwordx2 v[48:49], v4, s[40:43], s28 offen offset:0
    v_cvt_pk_bf16_f32 v50, v72, v73
    v_cvt_pk_bf16_f32 v51, v74, v75
    buffer_store_dwordx2 v[50:51], v4, s[40:43], s28 offen offset:32
    v_cvt_pk_bf16_f32 v52, v80, v81
    v_cvt_pk_bf16_f32 v53, v82, v83
    buffer_store_dwordx2 v[52:53], v4, s[40:43], s28 offen offset:64
    s_lshl_b32 s28, s20, 5
    s_add_u32 s28, s28, 16
    s_mul_i32 s28, s28, s35
    s_add_u32 s28, s28, s26
    v_cvt_pk_bf16_f32 v54, v68, v69
    v_cvt_pk_bf16_f32 v55, v70, v71
    buffer_store_dwordx2 v[54:55], v4, s[40:43], s28 offen offset:0
    v_cvt_pk_bf16_f32 v48, v76, v77
    v_cvt_pk_bf16_f32 v49, v78, v79
    buffer_store_dwordx2 v[48:49], v4, s[40:43], s28 offen offset:32
    v_cvt_pk_bf16_f32 v50, v84, v85
    v_cvt_pk_bf16_f32 v51, v86, v87
    buffer_store_dwordx2 v[50:51], v4, s[40:43], s28 offen offset:64
    s_add_u32 s20, s20, s21
    s_sub_u32 s28, 36864, s34
    s_add_u32 s34, s28, 0
    s_add_u32 s23, s23, 1
    s_cmp_lt_u32 s23, s22
    s_cbranch_scc1 g_loop_93
    s_waitcnt vmcnt(0)
    s_barrier
    s_barrier
    v_lshrrev_b32 v33, 4, v0
    v_and_b32 v34, 15, v33
    v_lshrrev_b32 v35, 4, v33
L_attna:
    v_lshrrev_b32 v33, 4, v0
    v_and_b32 v34, 15, v33
    v_lshrrev_b32 v35, 4, v33
    s_mov_b32 s23, 0x3e0293ee
    s_mov_b32 s68, 0x3f803f80
    s_mov_b32 s69, 0x3f803f80
    v_lshl_add_u32 v40, v35, 2, 0
    v_cmp_le_u32 s[60:61], v40, v34
    v_lshl_add_u32 v40, v35, 2, 1
    v_cmp_le_u32 s[62:63], v40, v34
    v_lshl_add_u32 v40, v35, 2, 2
    v_cmp_le_u32 s[64:65], v40, v34
    v_lshl_add_u32 v40, v35, 2, 3
    v_cmp_le_u32 s[66:67], v40, v34
    s_nop 4
L_al:
    s_mov_b64 exec, 1
    v_mov_b32 v30, 1
    v_mov_b32 v31, 0
    s_mov_b32 s28, 65012992
    buffer_atomic_add v30, v31, s[4:7], s28 offen sc0
    s_waitcnt vmcnt(0)
    s_mov_b64 exec, -1
    v_readfirstlane_b32 s20, v30
    s_nop 0
    s_cmp_ge_u32 s20, 2048
    s_cbranch_scc1 L_aend
    s_lshr_b32 s36, s20, 5
    s_lshl_b32 s37, s36, 2
    s_add_u32 s38, s37, 65011968
    s_cmp_lg_u32 s99, 0
    s_cbranch_scc1 pd_98
    s_mov_b32 s29, s38
    s_mov_b32 s30, 0
    v_mov_b32 v30, 0
pw_97:
    buffer_load_dword v31, v30, s[4:7], s29 offen sc1
    s_waitcnt vmcnt(0)
    v_readfirstlane_b32 s28, v31
    s_nop 0
    s_cmp_ge_u32 s28, 16
    s_cbranch_scc1 pd_98
    s_sleep 32
    s_add_u32 s30, s30, 1
    s_cmp_lt_u32 s30, 0x100000
    s_cbranch_scc1 pw_97
    s_mov_b32 s99, 1
pd_98:
    s_add_u32 s38, s37, 65011712
    s_cmp_lg_u32 s99, 0
    s_cbranch_scc1 pd_100
    s_mov_b32 s29, s38
    s_mov_b32 s30, 0
    v_mov_b32 v30, 0
pw_99:
    buffer_load_dword v31, v30, s[4:7], s29 offen sc1
    s_waitcnt vmcnt(0)
    v_readfirstlane_b32 s28, v31
    s_nop 0
    s_cmp_ge_u32 s28, 32
    s_cbranch_scc1 pd_100
    s_sleep 32
    s_add_u32 s30, s30, 1
    s_cmp_lt_u32 s30, 0x100000
    s_cbranch_scc1 pw_99
    s_mov_b32 s99, 1
pd_100:
    s_lshl_b32 s28, s20, 13
    s_add_u32 s29, s28, 33554432
    s_add_u32 s30, s29, 4096
    buffer_load_dwordx4 v[32:35], v0, s[4:7], s29 offen offset:0 sc1
    buffer_load_dwordx4 v[36:39], v0, s[4:7], s29 offen offset:1024 sc1
    buffer_load_dwordx4 v[40:43], v0, s[4:7], s29 offen offset:2048 sc1
    buffer_load_dwordx4 v[44:47], v0, s[4:7], s29 offen offset:3072 sc1
    buffer_load_dwordx4 v[48:51], v0, s[4:7], s30 offen offset:0 sc1
    buffer_load_dwordx4 v[52:55], v0, s[4:7], s30 offen offset:1024 sc1
    buffer_load_dwordx4 v[56:59], v0, s[4:7], s30 offen offset:2048 sc1
    buffer_load_dwordx4 v[60:63], v0, s[4:7], s30 offen offset:3072 sc1
    s_add_u32 s29, s28, 0
    s_add_u32 s30, s29, 4096
    buffer_load_dwordx4 v[64:67], v0, s[4:7], s29 offen offset:0 sc1
    buffer_load_dwordx4 v[68:71], v0, s[4:7], s29 offen offset:1024 sc1
    buffer_load_dwordx4 v[72:75], v0, s[4:7], s29 offen offset:2048 sc1
    buffer_load_dwordx4 v[76:79], v0, s[4:7], s29 offen offset:3072 sc1
    buffer_load_dwordx4 v[80:83], v0, s[4:7], s30 offen offset:0 sc1
    buffer_load_dwordx4 v[84:87], v0, s[4:7], s30 offen offset:1024 sc1
    buffer_load_dwordx4 v[88:91], v0, s[4:7], s30 offen offset:2048 sc1
    buffer_load_dwordx4 v[92:95], v0, s[4:7], s30 offen offset:3072 sc1
    s_add_u32 s29, s28, 16777216
    s_add_u32 s30, s29, 4096
    buffer_load_dwordx4 v[112:115], v0, s[4:7], s29 offen offset:0 sc1
    buffer_load_dwordx4 v[116:119], v0, s[4:7], s29 offen offset:1024 sc1
    buffer_load_dwordx4 v[120:123], v0, s[4:7], s29 offen offset:2048 sc1
    buffer_load_dwordx4 v[124:127], v0, s[4:7], s29 offen offset:3072 sc1
    buffer_load_dwordx4 v[128:131], v0, s[4:7], s30 offen offset:0 sc1
    buffer_load_dwordx4 v[132:135], v0, s[4:7], s30 offen offset:1024 sc1
    buffer_load_dwordx4 v[136:139], v0, s[4:7], s30 offen offset:2048 sc1
    buffer_load_dwordx4 v[140:143], v0, s[4:7], s30 offen offset:3072 sc1
    s_and_b32 s38, s20, 31
    s_lshl_b32 s38, s38, 8
    s_add_u32 s38, s38, 65015808
    s_add_u32 s39, s36, 1
    s_cmp_lg_u32 s99, 0
    s_cbranch_scc1 pd_102
    s_mov_b32 s29, s38
    s_mov_b32 s30, 0
    v_mov_b32 v29, 0
pw_101:
    buffer_load_dword v30, v29, s[4:7], s29 offen sc1
    s_waitcnt vmcnt(0)
    v_readfirstlane_b32 s28, v30
    s_nop 0
    s_cmp_ge_u32 s28, s39
    s_cbranch_scc1 pd_102
    s_sub_u32 s28, s39, s28
    s_cmp_le_u32 s28, 1
    s_cbranch_scc1 pn_103
    s_min_u32 s28, s28, 9
    s_sub_u32 s28, s28, 1
ps_104:
    s_sleep 60
    s_sub_u32 s28, s28, 1
    s_cmp_gt_u32 s28, 0
    s_cbranch_scc1 ps_104
pn_103:
    s_sleep 6
    s_add_u32 s30, s30, 1
    s_cmp_lt_u32 s30, 0x40000
    s_cbranch_scc1 pw_101
    s_mov_b32 s99, 1
pd_102:
    s_lshl_b32 s28, s20, 13
    s_lshr_b32 s31, s28, 1
    s_add_u32 s29, s31, 50331648
    buffer_load_dwordx4 v[96:99], v0, s[4:7], s29 offen offset:0 sc1
    buffer_load_dwordx4 v[100:103], v0, s[4:7], s29 offen offset:1024 sc1
    buffer_load_dwordx4 v[104:107], v0, s[4:7], s29 offen offset:2048 sc1
    buffer_load_dwordx4 v[108:111], v0, s[4:7], s29 offen offset:3072 sc1
    s_lshr_b32 s31, s28, 2
    s_add_u32 s29, s31, 58785792
    v_lshrrev_b32 v31, 1, v0
    buffer_load_dwordx2 v[144:145], v31, s[4:7], s29 offen offset:0 sc1
    buffer_load_dwordx2 v[146:147], v31, s[4:7], s29 offen offset:512 sc1
    buffer_load_dwordx2 v[148:149], v31, s[4:7], s29 offen offset:1024 sc1
    buffer_load_dwordx2 v[150:151], v31, s[4:7], s29 offen offset:1536 sc1
    v_mfma_f32_16x16x32_bf16 v[152:155], v[64:67], v[32:35], 0
    v_mfma_f32_16x16x32_bf16 v[156:159], v[64:67], v[36:39], 0
    v_mfma_f32_16x16x32_bf16 v[160:163], v[68:71], v[36:39], 0
    s_waitcnt vmcnt(7)
    v_mfma_f32_16x16x32_bf16 v[164:167], v[96:99], v[32:35], 0
    v_mfma_f32_16x16x32_bf16 v[168:171], v[96:99], v[36:39], 0
    v_mfma_f32_16x16x32_bf16 v[152:155], v[72:75], v[40:43], v[152:155]
    v_mfma_f32_16x16x32_bf16 v[156:159], v[72:75], v[44:47], v[156:159]
    v_mfma_f32_16x16x32_bf16 v[160:163], v[76:79], v[44:47], v[160:163]
    s_waitcnt vmcnt(6)
    v_mfma_f32_16x16x32_bf16 v[164:167], v[100:103], v[40:43], v[164:167]
    v_mfma_f32_16x16x32_bf16 v[168:171], v[100:103], v[44:47], v[168:171]
    v_mfma_f32_16x16x32_bf16 v[152:155], v[80:83], v[48:51], v[152:155]
    v_mfma_f32_16x16x32_bf16 v[156:159], v[80:83], v[52:55], v[156:159]
    v_mfma_f32_16x16x32_bf16 v[160:163], v[84:87], v[52:55], v[160:163]
    s_waitcnt vmcnt(5)
    v_mfma_f32_16x16x32_bf16 v[164:167], v[104:107], v[48:51], v[164:167]
    v_mfma_f32_16x16x32_bf16 v[168:171], v[104:107], v[52:55], v[168:171]
    v_mfma_f32_16x16x32_bf16 v[152:155], v[88:91], v[56:59], v[152:155]
    v_mfma_f32_16x16x32_bf16 v[156:159], v[88:91], v[60:63], v[156:159]
    v_mfma_f32_16x16x32_bf16 v[160:163], v[92:95], v[60:63], v[160:163]
    s_waitcnt vmcnt(4)
    v_mfma_f32_16x16x32_bf16 v[164:167], v[108:111], v[56:59], v[164:167]
    v_mfma_f32_16x16x32_bf16 v[168:171], v[108:111], v[60:63], v[168:171]
    v_mov_b32 v172, 0xf149f2ca
    v_cndmask_b32_e64 v152, v172, v152, s[60:61]
    v_cndmask_b32_e64 v160, v172, v160, s[60:61]
    v_cndmask_b32_e64 v153, v172, v153, s[62:63]
    v_cndmask_b32_e64 v161, v172, v161, s[62:63]
    v_cndmask_b32_e64 v154, v172, v154, s[64:65]
    v_cndmask_b32_e64 v162, v172, v162, s[64:65]
    v_cndmask_b32_e64 v155, v172, v155, s[66:67]
    v_cndmask_b32_e64 v163, v172, v163, s[66:67]
    v_max3_f32 v173, v152, v153, v154
    v_max3_f32 v173, v173, v155, v164
    v_max_f32 v173, v173, v165
    v_max3_f32 v174, v156, v157, v158
    v_max3_f32 v174, v174, v159, v160
    v_max3_f32 v174, v174, v161, v162
    v_max3_f32 v174, v174, v163, v168
    v_max_f32 v174, v174, v169
    v_mov_b32 v175, v173
    v_mov_b32 v176, v174
    s_nop 0
    v_permlane16_swap_b32 v173, v175
    v_permlane16_swap_b32 v174, v176
    v_max_f32 v173, v173, v175
    v_max_f32 v174, v174, v176
    v_mov_b32 v175, v173
    v_mov_b32 v176, v174
    s_nop 0
    v_permlane32_swap_b32 v173, v175
    v_permlane32_swap_b32 v174, v176
    v_max_f32 v173, v173, v175
    v_max_f32 v174, v174, v176
    v_mul_f32 v173, s23, v173
    v_mul_f32 v174, s23, v174
    v_fma_f32 v152, v152, s23, -v173
    v_fma_f32 v153, v153, s23, -v173
    v_fma_f32 v154, v154, s23, -v173
    v_fma_f32 v155, v155, s23, -v173
    v_fma_f32 v164, v164, s23, -v173
    v_fma_f32 v165, v165, s23, -v173
    v_fma_f32 v156, v156, s23, -v174
    v_fma_f32 v157, v157, s23, -v174
    v_fma_f32 v158, v158, s23, -v174
    v_fma_f32 v159, v159, s23, -v174
    v_fma_f32 v160, v160, s23, -v174
    v_fma_f32 v161, v161, s23, -v174
    v_fma_f32 v162, v162, s23, -v174
    v_fma_f32 v163, v163, s23, -v174
    v_fma_f32 v168, v168, s23, -v174
    v_fma_f32 v169, v169, s23, -v174
    v_exp_f32 v152, v152
    v_exp_f32 v153, v153
    v_exp_f32 v154, v154
    v_exp_f32 v155, v155
    v_exp_f32 v164, v164
    v_exp_f32 v165, v165
    v_exp_f32 v156, v156
    v_exp_f32 v157, v157
    v_exp_f32 v158, v158
    v_exp_f32 v159, v159
    v_exp_f32 v160, v160
    v_exp_f32 v161, v161
    v_exp_f32 v162, v162
    v_exp_f32 v163, v163
    v_exp_f32 v168, v168
    v_exp_f32 v169, v169
    v_cvt_pk_bf16_f32 v176, v152, v153
    v_cvt_pk_bf16_f32 v177, v154, v155
    v_mov_b64 v[178:179], 0
    v_cvt_pk_bf16_f32 v180, v156, v157
    v_cvt_pk_bf16_f32 v181, v158, v159
    v_cvt_pk_bf16_f32 v182, v160, v161
    v_cvt_pk_bf16_f32 v183, v162, v163
    v_cvt_pk_bf16_f32 v184, v164, v165
    v_mov_b32 v185, 0
    v_mov_b32 v186, 0
    v_mov_b32 v187, v184
    v_cvt_pk_bf16_f32 v188, v168, v169
    v_mov_b32 v189, 0
    v_mov_b32 v190, 0
    v_mov_b32 v191, v188
    v_mov_b64 v[192:193], s[68:69]
    v_mov_b64 v[194:195], s[68:69]
    s_nop 1
    v_mfma_f32_16x16x32_bf16 v[196:199], v[192:195], v[176:179], 0
    v_mfma_f32_16x16x32_bf16 v[200:203], v[192:195], v[180:183], 0
    v_mfma_f32_16x16x16_bf16 v[196:199], v[192:193], v[184:185], v[196:199]
    v_mfma_f32_16x16x16_bf16 v[200:203], v[192:193], v[188:189], v[200:203]
    v_mfma_f32_16x16x32_bf16 v[32:35], v[112:115], v[176:179], 0
    v_mfma_f32_16x16x32_bf16 v[36:39], v[112:115], v[180:183], 0
    v_mfma_f32_16x16x32_bf16 v[40:43], v[116:119], v[176:179], 0
    v_mfma_f32_16x16x32_bf16 v[44:47], v[116:119], v[180:183], 0
    v_mfma_f32_16x16x32_bf16 v[48:51], v[120:123], v[176:179], 0
    v_mfma_f32_16x16x32_bf16 v[52:55], v[120:123], v[180:183], 0
    v_mfma_f32_16x16x32_bf16 v[56:59], v[124:127], v[176:179], 0
    v_mfma_f32_16x16x32_bf16 v[60:63], v[124:127], v[180:183], 0
    v_mfma_f32_16x16x32_bf16 v[64:67], v[128:131], v[176:179], 0
    v_mfma_f32_16x16x32_bf16 v[68:71], v[128:131], v[180:183], 0
    v_mfma_f32_16x16x32_bf16 v[72:75], v[132:135], v[176:179], 0
    v_mfma_f32_16x16x32_bf16 v[76:79], v[132:135], v[180:183], 0
    v_mfma_f32_16x16x32_bf16 v[80:83], v[136:139], v[176:179], 0
    v_mfma_f32_16x16x32_bf16 v[84:87], v[136:139], v[180:183], 0
    v_mfma_f32_16x16x32_bf16 v[88:91], v[140:143], v[176:179], 0
    v_mfma_f32_16x16x32_bf16 v[92:95], v[140:143], v[180:183], 0
    s_waitcnt vmcnt(3)
    v_mfma_f32_16x16x16_bf16 v[32:35], v[144:145], v[184:185], v[32:35]
    v_mfma_f32_16x16x16_bf16 v[36:39], v[144:145], v[188:189], v[36:39]
    v_mfma_f32_16x16x16_bf16 v[40:43], v[144:145], v[186:187], v[40:43]
    v_mfma_f32_16x16x16_bf16 v[44:47], v[144:145], v[190:191], v[44:47]
    s_waitcnt vmcnt(2)
    v_mfma_f32_16x16x16_bf16 v[48:51], v[146:147], v[184:185], v[48:51]
    v_mfma_f32_16x16x16_bf16 v[52:55], v[146:147], v[188:189], v[52:55]
    v_mfma_f32_16x16x16_bf16 v[56:59], v[146:147], v[186:187], v[56:59]
    v_mfma_f32_16x16x16_bf16 v[60:63], v[146:147], v[190:191], v[60:63]
    s_waitcnt vmcnt(1)
    v_mfma_f32_16x16x16_bf16 v[64:67], v[148:149], v[184:185], v[64:67]
    v_mfma_f32_16x16x16_bf16 v[68:71], v[148:149], v[188:189], v[68:71]
    v_mfma_f32_16x16x16_bf16 v[72:75], v[148:149], v[186:187], v[72:75]
    v_mfma_f32_16x16x16_bf16 v[76:79], v[148:149], v[190:191], v[76:79]
    s_waitcnt vmcnt(0)
    v_mfma_f32_16x16x16_bf16 v[80:83], v[150:151], v[184:185], v[80:83]
    v_mfma_f32_16x16x16_bf16 v[84:87], v[150:151], v[188:189], v[84:87]
    v_mfma_f32_16x16x16_bf16 v[88:91], v[150:151], v[186:187], v[88:91]
    v_mfma_f32_16x16x16_bf16 v[92:95], v[150:151], v[190:191], v[92:95]
    v_rcp_f32 v196, v196
    v_rcp_f32 v200, v200
    s_lshr_b32 s28, s20, 5
    s_and_b32 s29, s20, 31
    s_lshl_b32 s28, s28, 6
    s_add_u32 s28, s28, s29
    s_lshl_b32 s28, s28, 12
    s_add_u32 s28, s28, 67108864
    s_add_u32 s29, s28, 131072
    v_mul_f32 v32, v32, v196
    v_mul_f32 v40, v40, v196
    v_mul_f32 v33, v33, v196
    v_mul_f32 v41, v41, v196
    v_mul_f32 v34, v34, v196
    v_mul_f32 v42, v42, v196
    v_mul_f32 v35, v35, v196
    v_mul_f32 v43, v43, v196
    v_cvt_pk_bf16_f32 v204, v32, v33
    v_cvt_pk_bf16_f32 v205, v34, v35
    v_cvt_pk_bf16_f32 v206, v40, v41
    v_cvt_pk_bf16_f32 v207, v42, v43
    buffer_store_dwordx4 v[204:207], v0, s[4:7], s28 offen offset:0 sc1
    v_mul_f32 v48, v48, v196
    v_mul_f32 v56, v56, v196
    v_mul_f32 v49, v49, v196
    v_mul_f32 v57, v57, v196
    v_mul_f32 v50, v50, v196
    v_mul_f32 v58, v58, v196
    v_mul_f32 v51, v51, v196
    v_mul_f32 v59, v59, v196
    v_cvt_pk_bf16_f32 v208, v48, v49
    v_cvt_pk_bf16_f32 v209, v50, v51
    v_cvt_pk_bf16_f32 v210, v56, v57
    v_cvt_pk_bf16_f32 v211, v58, v59
    buffer_store_dwordx4 v[208:211], v0, s[4:7], s28 offen offset:1024 sc1
    v_mul_f32 v64, v64, v196
    v_mul_f32 v72, v72, v196
    v_mul_f32 v65, v65, v196
    v_mul_f32 v73, v73, v196
    v_mul_f32 v66, v66, v196
    v_mul_f32 v74, v74, v196
    v_mul_f32 v67, v67, v196
    v_mul_f32 v75, v75, v196
    v_cvt_pk_bf16_f32 v204, v64, v65
    v_cvt_pk_bf16_f32 v205, v66, v67
    v_cvt_pk_bf16_f32 v206, v72, v73
    v_cvt_pk_bf16_f32 v207, v74, v75
    buffer_store_dwordx4 v[204:207], v0, s[4:7], s28 offen offset:2048 sc1
    v_mul_f32 v80, v80, v196
    v_mul_f32 v88, v88, v196
    v_mul_f32 v81, v81, v196
    v_mul_f32 v89, v89, v196
    v_mul_f32 v82, v82, v196
    v_mul_f32 v90, v90, v196
    v_mul_f32 v83, v83, v196
    v_mul_f32 v91, v91, v196
    v_cvt_pk_bf16_f32 v208, v80, v81
    v_cvt_pk_bf16_f32 v209, v82, v83
    v_cvt_pk_bf16_f32 v210, v88, v89
    v_cvt_pk_bf16_f32 v211, v90, v91
    buffer_store_dwordx4 v[208:211], v0, s[4:7], s28 offen offset:3072 sc1
    v_mul_f32 v36, v36, v200
    v_mul_f32 v44, v44, v200
    v_mul_f32 v37, v37, v200
    v_mul_f32 v45, v45, v200
    v_mul_f32 v38, v38, v200
    v_mul_f32 v46, v46, v200
    v_mul_f32 v39, v39, v200
    v_mul_f32 v47, v47, v200
    v_cvt_pk_bf16_f32 v204, v36, v37
    v_cvt_pk_bf16_f32 v205, v38, v39
    v_cvt_pk_bf16_f32 v206, v44, v45
    v_cvt_pk_bf16_f32 v207, v46, v47
    buffer_store_dwordx4 v[204:207], v0, s[4:7], s29 offen offset:0 sc1
    v_mul_f32 v52, v52, v200
    v_mul_f32 v60, v60, v200
    v_mul_f32 v53, v53, v200
    v_mul_f32 v61, v61, v200
    v_mul_f32 v54, v54, v200
    v_mul_f32 v62, v62, v200
    v_mul_f32 v55, v55, v200
    v_mul_f32 v63, v63, v200
    v_cvt_pk_bf16_f32 v208, v52, v53
    v_cvt_pk_bf16_f32 v209, v54, v55
    v_cvt_pk_bf16_f32 v210, v60, v61
    v_cvt_pk_bf16_f32 v211, v62, v63
    buffer_store_dwordx4 v[208:211], v0, s[4:7], s29 offen offset:1024 sc1
    v_mul_f32 v68, v68, v200
    v_mul_f32 v76, v76, v200
    v_mul_f32 v69, v69, v200
    v_mul_f32 v77, v77, v200
    v_mul_f32 v70, v70, v200
    v_mul_f32 v78, v78, v200
    v_mul_f32 v71, v71, v200
    v_mul_f32 v79, v79, v200
    v_cvt_pk_bf16_f32 v204, v68, v69
    v_cvt_pk_bf16_f32 v205, v70, v71
    v_cvt_pk_bf16_f32 v206, v76, v77
    v_cvt_pk_bf16_f32 v207, v78, v79
    buffer_store_dwordx4 v[204:207], v0, s[4:7], s29 offen offset:2048 sc1
    v_mul_f32 v84, v84, v200
    v_mul_f32 v92, v92, v200
    v_mul_f32 v85, v85, v200
    v_mul_f32 v93, v93, v200
    v_mul_f32 v86, v86, v200
    v_mul_f32 v94, v94, v200
    v_mul_f32 v87, v87, v200
    v_mul_f32 v95, v95, v200
    v_cvt_pk_bf16_f32 v208, v84, v85
    v_cvt_pk_bf16_f32 v209, v86, v87
    v_cvt_pk_bf16_f32 v210, v92, v93
    v_cvt_pk_bf16_f32 v211, v94, v95
    buffer_store_dwordx4 v[208:211], v0, s[4:7], s29 offen offset:3072 sc1
    s_waitcnt vmcnt(0)
    s_lshr_b32 s28, s20, 5
    s_lshl_b32 s28, s28, 2
    s_add_u32 s28, s28, 65012224
    s_mov_b64 exec, 1
    v_mov_b32 v30, 1
    v_mov_b32 v31, 0
    buffer_atomic_add v30, v31, s[4:7], s28 offen
    s_mov_b64 exec, -1
    s_nop 2
    s_branch L_al
L_aend:
    s_branch L_end
L_oproj:
    s_mov_b32 s12, s82
    s_and_b32 s13, s83, 0xffff
    s_mov_b32 s14, 4718592
    s_mov_b32 s15, 0x20000
    s_mov_b32 s40, s94
    s_and_b32 s41, s95, 0xffff
    s_mov_b32 s42, 4718592
    s_mov_b32 s43, 0x20000
    s_mul_hi_u32 s20, s44, 357913942
    s_mul_i32 s28, s20, 12
    s_sub_u32 s28, s44, s28
    s_mul_i32 s24, s28, 96
    v_lshl_add_u32 v40, v35, 2, 0
    v_mul_u32_u24 v40, 2304, v40
    v_lshl_add_u32 v4, v34, 1, v40
    v_lshl_add_u32 v40, v35, 2, 1
    v_mul_u32_u24 v40, 2304, v40
    v_lshl_add_u32 v5, v34, 1, v40
    v_lshl_add_u32 v40, v35, 2, 2
    v_mul_u32_u24 v40, 2304, v40
    v_lshl_add_u32 v6, v34, 1, v40
    v_lshl_add_u32 v40, v35, 2, 3
    v_mul_u32_u24 v40, 2304, v40
    v_lshl_add_u32 v7, v34, 1, v40
    s_mov_b32 s70, 0x55555555
    s_mov_b32 s71, 0x55555555
    v_lshrrev_b32 v40, 3, v33
    v_and_b32 v41, 7, v33
    s_lshl_b32 s28, s19, 5
    s_add_u32 s28, s28, 0
    v_add_u32 v42, s28, v40
    v_bfe_u32 v43, v42, 1, 2
    v_lshlrev_b32 v43, 1, v43
    v_xor_b32 v43, v43, v41
    v_mul_u32_u24 v42, 1152, v42
    v_lshl_add_u32 v52, v43, 4, v42
    s_lshl_b32 s28, s19, 5
    s_add_u32 s28, s28, 8
    v_add_u32 v42, s28, v40
    v_bfe_u32 v43, v42, 1, 2
    v_lshlrev_b32 v43, 1, v43
    v_xor_b32 v43, v43, v41
    v_mul_u32_u24 v42, 1152, v42
    v_lshl_add_u32 v53, v43, 4, v42
    s_lshl_b32 s28, s19, 5
    s_add_u32 s28, s28, 16
    v_add_u32 v42, s28, v40
    v_bfe_u32 v43, v42, 1, 2
    v_lshlrev_b32 v43, 1, v43
    v_xor_b32 v43, v43, v41
    v_mul_u32_u24 v42, 1152, v42
    v_lshl_add_u32 v54, v43, 4, v42
    s_lshl_b32 s28, s19, 5
    s_add_u32 s28, s28, 24
    v_add_u32 v42, s28, v40
    v_bfe_u32 v43, v42, 1, 2
    v_lshlrev_b32 v43, 1, v43
    v_xor_b32 v43, v43, v41
    v_mul_u32_u24 v42, 1152, v42
    v_lshl_add_u32 v55, v43, 4, v42
    v_lshrrev_b32 v40, 2, v34
    v_and_b32 v41, 3, v34
    v_lshl_add_u32 v42, v35, 2, v40
    v_bfe_u32 v43, v42, 1, 2
    v_lshlrev_b32 v44, 7, v42
    v_lshl_add_u32 v44, v41, 3, v44
    v_xor_b32 v45, 0, v43
    v_lshl_add_u32 v56, v45, 5, v44
    v_xor_b32 v45, 1, v43
    v_lshl_add_u32 v57, v45, 5, v44
    v_xor_b32 v45, 2, v43
    v_lshl_add_u32 v58, v45, 5, v44
    s_mov_b32 s28, 0
    s_add_u32 s28, s28, s24
    s_lshl_b32 s29, s19, 12
    s_add_u32 s29, s29, 0
    s_add_u32 m0, s29, 0
    s_nop 0
    buffer_load_dwordx4 v52, s[12:15], s28 offen lds
    s_add_u32 m0, s29, 1024
    s_nop 0
    buffer_load_dwordx4 v53, s[12:15], s28 offen lds
    s_add_u32 m0, s29, 2048
    s_nop 0
    buffer_load_dwordx4 v54, s[12:15], s28 offen lds
    s_add_u32 m0, s29, 3072
    s_nop 0
    buffer_load_dwordx4 v55, s[12:15], s28 offen lds
    s_mov_b32 s28, 147456
    s_add_u32 s28, s28, s24
    s_lshl_b32 s29, s19, 12
    s_add_u32 s29, s29, 16384
    s_add_u32 m0, s29, 0
    s_nop 0
    buffer_load_dwordx4 v52, s[12:15], s28 offen lds
    s_add_u32 m0, s29, 1024
    s_nop 0
    buffer_load_dwordx4 v53, s[12:15], s28 offen lds
    s_add_u32 m0, s29, 2048
    s_nop 0
    buffer_load_dwordx4 v54, s[12:15], s28 offen lds
    s_add_u32 m0, s29, 3072
    s_nop 0
    buffer_load_dwordx4 v55, s[12:15], s28 offen lds
    s_mov_b32 s28, 294912
    s_add_u32 s28, s28, s24
    s_lshl_b32 s29, s19, 12
    s_add_u32 s29, s29, 32768
    s_add_u32 m0, s29, 0
    s_nop 0
    buffer_load_dwordx4 v52, s[12:15], s28 offen lds
    s_add_u32 m0, s29, 1024
    s_nop 0
    buffer_load_dwordx4 v53, s[12:15], s28 offen lds
    s_add_u32 m0, s29, 2048
    s_nop 0
    buffer_load_dwordx4 v54, s[12:15], s28 offen lds
    s_add_u32 m0, s29, 3072
    s_nop 0
    buffer_load_dwordx4 v55, s[12:15], s28 offen lds
    s_mov_b32 s28, 442368
    s_add_u32 s28, s28, s24
    s_lshl_b32 s29, s19, 12
    s_add_u32 s29, s29, 49152
    s_add_u32 m0, s29, 0
    s_nop 0
    buffer_load_dwordx4 v52, s[12:15], s28 offen lds
    s_add_u32 m0, s29, 1024
    s_nop 0
    buffer_load_dwordx4 v53, s[12:15], s28 offen lds
    s_add_u32 m0, s29, 2048
    s_nop 0
    buffer_load_dwordx4 v54, s[12:15], s28 offen lds
    s_add_u32 m0, s29, 3072
    s_nop 0
    buffer_load_dwordx4 v55, s[12:15], s28 offen lds
    s_mov_b32 s28, 589824
    s_add_u32 s28, s28, s24
    s_lshl_b32 s29, s19, 12
    s_add_u32 s29, s29, 65536
    s_add_u32 m0, s29, 0
    s_nop 0
    buffer_load_dwordx4 v52, s[12:15], s28 offen lds
    s_add_u32 m0, s29, 1024
    s_nop 0
    buffer_load_dwordx4 v53, s[12:15], s28 offen lds
    s_add_u32 m0, s29, 2048
    s_nop 0
    buffer_load_dwordx4 v54, s[12:15], s28 offen lds
    s_add_u32 m0, s29, 3072
    s_nop 0
    buffer_load_dwordx4 v55, s[12:15], s28 offen lds
    s_mov_b32 s28, 737280
    s_add_u32 s28, s28, s24
    s_lshl_b32 s29, s19, 12
    s_add_u32 s29, s29, 81920
    s_add_u32 m0, s29, 0
    s_nop 0
    buffer_load_dwordx4 v52, s[12:15], s28 offen lds
    s_add_u32 m0, s29, 1024
    s_nop 0
    buffer_load_dwordx4 v53, s[12:15], s28 offen lds
    s_add_u32 m0, s29, 2048
    s_nop 0
    buffer_load_dwordx4 v54, s[12:15], s28 offen lds
    s_add_u32 m0, s29, 3072
    s_nop 0
    buffer_load_dwordx4 v55, s[12:15], s28 offen lds
    s_mov_b32 s28, 884736
    s_add_u32 s28, s28, s24
    s_lshl_b32 s29, s19, 12
    s_add_u32 s29, s29, 98304
    s_add_u32 m0, s29, 0
    s_nop 0
    buffer_load_dwordx4 v52, s[12:15], s28 offen lds
    s_add_u32 m0, s29, 1024
    s_nop 0
    buffer_load_dwordx4 v53, s[12:15], s28 offen lds
    s_add_u32 m0, s29, 2048
    s_nop 0
    buffer_load_dwordx4 v54, s[12:15], s28 offen lds
    s_add_u32 m0, s29, 3072
    s_nop 0
    buffer_load_dwordx4 v55, s[12:15], s28 offen lds
    s_mov_b32 s28, 1032192
    s_add_u32 s28, s28, s24
    s_lshl_b32 s29, s19, 12
    s_add_u32 s29, s29, 114688
    s_add_u32 m0, s29, 0
    s_nop 0
    buffer_load_dwordx4 v52, s[12:15], s28 offen lds
    s_add_u32 m0, s29, 1024
    s_nop 0
    buffer_load_dwordx4 v53, s[12:15], s28 offen lds
    s_add_u32 m0, s29, 2048
    s_nop 0
    buffer_load_dwordx4 v54, s[12:15], s28 offen lds
    s_add_u32 m0, s29, 3072
    s_nop 0
    buffer_load_dwordx4 v55, s[12:15], s28 offen lds
    s_mov_b32 s28, 1179648
    s_add_u32 s28, s28, s24
    s_lshl_b32 s29, s19, 12
    s_add_u32 s29, s29, 131072
    s_add_u32 m0, s29, 0
    s_nop 0
    buffer_load_dwordx4 v52, s[12:15], s28 offen lds
    s_add_u32 m0, s29, 1024
    s_nop 0
    buffer_load_dwordx4 v53, s[12:15], s28 offen lds
    s_add_u32 m0, s29, 2048
    s_nop 0
    buffer_load_dwordx4 v54, s[12:15], s28 offen lds
    s_add_u32 m0, s29, 3072
    s_nop 0
    buffer_load_dwordx4 v55, s[12:15], s28 offen lds
    s_mov_b32 s28, 1327104
    s_add_u32 s28, s28, s24
    s_lshl_b32 s29, s19, 12
    s_add_u32 s29, s29, 147456
    s_add_u32 m0, s29, 0
    s_nop 0
    buffer_load_dwordx4 v52, s[12:15], s28 offen lds
    s_add_u32 m0, s29, 1024
    s_nop 0
    buffer_load_dwordx4 v53, s[12:15], s28 offen lds
    s_add_u32 m0, s29, 2048
    s_nop 0
    buffer_load_dwordx4 v54, s[12:15], s28 offen lds
    s_add_u32 m0, s29, 3072
    s_nop 0
    buffer_load_dwordx4 v55, s[12:15], s28 offen lds
    s_waitcnt vmcnt(36)
    s_barrier
    s_cmp_lg_u32 s19, 0
    s_cbranch_scc1 op_sk_105
    v_add_u32 v44, 0, v56
    ds_read_b64_tr_b16 a[0:1], v44 offset:0
    ds_read_b64_tr_b16 a[2:3], v44 offset:2048
    ds_read_b64_tr_b16 a[4:5], v44 offset:4096
    ds_read_b64_tr_b16 a[6:7], v44 offset:6144
    ds_read_b64_tr_b16 a[8:9], v44 offset:8192
    ds_read_b64_tr_b16 a[10:11], v44 offset:10240
    ds_read_b64_tr_b16 a[12:13], v44 offset:12288
    ds_read_b64_tr_b16 a[14:15], v44 offset:14336
    v_add_u32 v44, 0, v57
    ds_read_b64_tr_b16 a[128:129], v44 offset:0
    ds_read_b64_tr_b16 a[130:131], v44 offset:2048
    ds_read_b64_tr_b16 a[132:133], v44 offset:4096
    ds_read_b64_tr_b16 a[134:135], v44 offset:6144
    ds_read_b64_tr_b16 a[136:137], v44 offset:8192
    ds_read_b64_tr_b16 a[138:139], v44 offset:10240
    ds_read_b64_tr_b16 a[140:141], v44 offset:12288
    ds_read_b64_tr_b16 a[142:143], v44 offset:14336
    v_add_u32 v44, 0, v58
    ds_read_b64_tr_b16 v[128:129], v44 offset:0
    ds_read_b64_tr_b16 v[130:131], v44 offset:2048
    ds_read_b64_tr_b16 v[132:133], v44 offset:4096
    ds_read_b64_tr_b16 v[134:135], v44 offset:6144
    ds_read_b64_tr_b16 v[136:137], v44 offset:8192
    ds_read_b64_tr_b16 v[138:139], v44 offset:10240
    ds_read_b64_tr_b16 v[140:141], v44 offset:12288
    ds_read_b64_tr_b16 v[142:143], v44 offset:14336
    s_waitcnt lgkmcnt(0)
op_sk_105:
    s_barrier
    s_mov_b32 s28, 1474560
    s_add_u32 s28, s28, s24
    s_lshl_b32 s29, s19, 12
    s_add_u32 s29, s29, 0
    s_add_u32 m0, s29, 0
    s_nop 0
    buffer_load_dwordx4 v52, s[12:15], s28 offen lds
    s_add_u32 m0, s29, 1024
    s_nop 0
    buffer_load_dwordx4 v53, s[12:15], s28 offen lds
    s_add_u32 m0, s29, 2048
    s_nop 0
    buffer_load_dwordx4 v54, s[12:15], s28 offen lds
    s_add_u32 m0, s29, 3072
    s_nop 0
    buffer_load_dwordx4 v55, s[12:15], s28 offen lds
    s_waitcnt vmcnt(36)
    s_barrier
    s_cmp_lg_u32 s19, 0
    s_cbranch_scc1 op_sk_106
    v_add_u32 v44, 16384, v56
    ds_read_b64_tr_b16 a[16:17], v44 offset:0
    ds_read_b64_tr_b16 a[18:19], v44 offset:2048
    ds_read_b64_tr_b16 a[20:21], v44 offset:4096
    ds_read_b64_tr_b16 a[22:23], v44 offset:6144
    ds_read_b64_tr_b16 a[24:25], v44 offset:8192
    ds_read_b64_tr_b16 a[26:27], v44 offset:10240
    ds_read_b64_tr_b16 a[28:29], v44 offset:12288
    ds_read_b64_tr_b16 a[30:31], v44 offset:14336
    v_add_u32 v44, 16384, v57
    ds_read_b64_tr_b16 a[144:145], v44 offset:0
    ds_read_b64_tr_b16 a[146:147], v44 offset:2048
    ds_read_b64_tr_b16 a[148:149], v44 offset:4096
    ds_read_b64_tr_b16 a[150:151], v44 offset:6144
    ds_read_b64_tr_b16 a[152:153], v44 offset:8192
    ds_read_b64_tr_b16 a[154:155], v44 offset:10240
    ds_read_b64_tr_b16 a[156:157], v44 offset:12288
    ds_read_b64_tr_b16 a[158:159], v44 offset:14336
    v_add_u32 v44, 16384, v58
    ds_read_b64_tr_b16 v[144:145], v44 offset:0
    ds_read_b64_tr_b16 v[146:147], v44 offset:2048
    ds_read_b64_tr_b16 v[148:149], v44 offset:4096
    ds_read_b64_tr_b16 v[150:151], v44 offset:6144
    ds_read_b64_tr_b16 v[152:153], v44 offset:8192
    ds_read_b64_tr_b16 v[154:155], v44 offset:10240
    ds_read_b64_tr_b16 v[156:157], v44 offset:12288
    ds_read_b64_tr_b16 v[158:159], v44 offset:14336
    s_waitcnt lgkmcnt(0)
op_sk_106:
    s_barrier
    s_mov_b32 s28, 1622016
    s_add_u32 s28, s28, s24
    s_lshl_b32 s29, s19, 12
    s_add_u32 s29, s29, 16384
    s_add_u32 m0, s29, 0
    s_nop 0
    buffer_load_dwordx4 v52, s[12:15], s28 offen lds
    s_add_u32 m0, s29, 1024
    s_nop 0
    buffer_load_dwordx4 v53, s[12:15], s28 offen lds
    s_add_u32 m0, s29, 2048
    s_nop 0
    buffer_load_dwordx4 v54, s[12:15], s28 offen lds
    s_add_u32 m0, s29, 3072
    s_nop 0
    buffer_load_dwordx4 v55, s[12:15], s28 offen lds
    s_waitcnt vmcnt(36)
    s_barrier
    s_cmp_lg_u32 s19, 0
    s_cbranch_scc1 op_sk_107
    v_add_u32 v44, 32768, v56
    ds_read_b64_tr_b16 a[32:33], v44 offset:0
    ds_read_b64_tr_b16 a[34:35], v44 offset:2048
    ds_read_b64_tr_b16 a[36:37], v44 offset:4096
    ds_read_b64_tr_b16 a[38:39], v44 offset:6144
    ds_read_b64_tr_b16 a[40:41], v44 offset:8192
    ds_read_b64_tr_b16 a[42:43], v44 offset:10240
    ds_read_b64_tr_b16 a[44:45], v44 offset:12288
    ds_read_b64_tr_b16 a[46:47], v44 offset:14336
    v_add_u32 v44, 32768, v57
    ds_read_b64_tr_b16 a[160:161], v44 offset:0
    ds_read_b64_tr_b16 a[162:163], v44 offset:2048
    ds_read_b64_tr_b16 a[164:165], v44 offset:4096
    ds_read_b64_tr_b16 a[166:167], v44 offset:6144
    ds_read_b64_tr_b16 a[168:169], v44 offset:8192
    ds_read_b64_tr_b16 a[170:171], v44 offset:10240
    ds_read_b64_tr_b16 a[172:173], v44 offset:12288
    ds_read_b64_tr_b16 a[174:175], v44 offset:14336
    v_add_u32 v44, 32768, v58
    ds_read_b64_tr_b16 v[160:161], v44 offset:0
    ds_read_b64_tr_b16 v[162:163], v44 offset:2048
    ds_read_b64_tr_b16 v[164:165], v44 offset:4096
    ds_read_b64_tr_b16 v[166:167], v44 offset:6144
    ds_read_b64_tr_b16 v[168:169], v44 offset:8192
    ds_read_b64_tr_b16 v[170:171], v44 offset:10240
    ds_read_b64_tr_b16 v[172:173], v44 offset:12288
    ds_read_b64_tr_b16 v[174:175], v44 offset:14336
    s_waitcnt lgkmcnt(0)
op_sk_107:
    s_barrier
    s_mov_b32 s28, 1769472
    s_add_u32 s28, s28, s24
    s_lshl_b32 s29, s19, 12
    s_add_u32 s29, s29, 32768
    s_add_u32 m0, s29, 0
    s_nop 0
    buffer_load_dwordx4 v52, s[12:15], s28 offen lds
    s_add_u32 m0, s29, 1024
    s_nop 0
    buffer_load_dwordx4 v53, s[12:15], s28 offen lds
    s_add_u32 m0, s29, 2048
    s_nop 0
    buffer_load_dwordx4 v54, s[12:15], s28 offen lds
    s_add_u32 m0, s29, 3072
    s_nop 0
    buffer_load_dwordx4 v55, s[12:15], s28 offen lds
    s_waitcnt vmcnt(36)
    s_barrier
    s_cmp_lg_u32 s19, 0
    s_cbranch_scc1 op_sk_108
    v_add_u32 v44, 49152, v56
    ds_read_b64_tr_b16 a[48:49], v44 offset:0
    ds_read_b64_tr_b16 a[50:51], v44 offset:2048
    ds_read_b64_tr_b16 a[52:53], v44 offset:4096
    ds_read_b64_tr_b16 a[54:55], v44 offset:6144
    ds_read_b64_tr_b16 a[56:57], v44 offset:8192
    ds_read_b64_tr_b16 a[58:59], v44 offset:10240
    ds_read_b64_tr_b16 a[60:61], v44 offset:12288
    ds_read_b64_tr_b16 a[62:63], v44 offset:14336
    v_add_u32 v44, 49152, v57
    ds_read_b64_tr_b16 a[176:177], v44 offset:0
    ds_read_b64_tr_b16 a[178:179], v44 offset:2048
    ds_read_b64_tr_b16 a[180:181], v44 offset:4096
    ds_read_b64_tr_b16 a[182:183], v44 offset:6144
    ds_read_b64_tr_b16 a[184:185], v44 offset:8192
    ds_read_b64_tr_b16 a[186:187], v44 offset:10240
    ds_read_b64_tr_b16 a[188:189], v44 offset:12288
    ds_read_b64_tr_b16 a[190:191], v44 offset:14336
    v_add_u32 v44, 49152, v58
    ds_read_b64_tr_b16 v[176:177], v44 offset:0
    ds_read_b64_tr_b16 v[178:179], v44 offset:2048
    ds_read_b64_tr_b16 v[180:181], v44 offset:4096
    ds_read_b64_tr_b16 v[182:183], v44 offset:6144
    ds_read_b64_tr_b16 v[184:185], v44 offset:8192
    ds_read_b64_tr_b16 v[186:187], v44 offset:10240
    ds_read_b64_tr_b16 v[188:189], v44 offset:12288
    ds_read_b64_tr_b16 v[190:191], v44 offset:14336
    s_waitcnt lgkmcnt(0)
op_sk_108:
    s_barrier
    s_mov_b32 s28, 1916928
    s_add_u32 s28, s28, s24
    s_lshl_b32 s29, s19, 12
    s_add_u32 s29, s29, 49152
    s_add_u32 m0, s29, 0
    s_nop 0
    buffer_load_dwordx4 v52, s[12:15], s28 offen lds
    s_add_u32 m0, s29, 1024
    s_nop 0
    buffer_load_dwordx4 v53, s[12:15], s28 offen lds
    s_add_u32 m0, s29, 2048
    s_nop 0
    buffer_load_dwordx4 v54, s[12:15], s28 offen lds
    s_add_u32 m0, s29, 3072
    s_nop 0
    buffer_load_dwordx4 v55, s[12:15], s28 offen lds
    s_waitcnt vmcnt(36)
    s_barrier
    s_cmp_lg_u32 s19, 0
    s_cbranch_scc1 op_sk_109
    v_add_u32 v44, 65536, v56
    ds_read_b64_tr_b16 a[64:65], v44 offset:0
    ds_read_b64_tr_b16 a[66:67], v44 offset:2048
    ds_read_b64_tr_b16 a[68:69], v44 offset:4096
    ds_read_b64_tr_b16 a[70:71], v44 offset:6144
    ds_read_b64_tr_b16 a[72:73], v44 offset:8192
    ds_read_b64_tr_b16 a[74:75], v44 offset:10240
    ds_read_b64_tr_b16 a[76:77], v44 offset:12288
    ds_read_b64_tr_b16 a[78:79], v44 offset:14336
    v_add_u32 v44, 65536, v57
    ds_read_b64_tr_b16 a[192:193], v44 offset:0
    ds_read_b64_tr_b16 a[194:195], v44 offset:2048
    ds_read_b64_tr_b16 a[196:197], v44 offset:4096
    ds_read_b64_tr_b16 a[198:199], v44 offset:6144
    ds_read_b64_tr_b16 a[200:201], v44 offset:8192
    ds_read_b64_tr_b16 a[202:203], v44 offset:10240
    ds_read_b64_tr_b16 a[204:205], v44 offset:12288
    ds_read_b64_tr_b16 a[206:207], v44 offset:14336
    v_add_u32 v44, 65536, v58
    ds_read_b64_tr_b16 v[192:193], v44 offset:0
    ds_read_b64_tr_b16 v[194:195], v44 offset:2048
    ds_read_b64_tr_b16 v[196:197], v44 offset:4096
    ds_read_b64_tr_b16 v[198:199], v44 offset:6144
    ds_read_b64_tr_b16 v[200:201], v44 offset:8192
    ds_read_b64_tr_b16 v[202:203], v44 offset:10240
    ds_read_b64_tr_b16 v[204:205], v44 offset:12288
    ds_read_b64_tr_b16 v[206:207], v44 offset:14336
    s_waitcnt lgkmcnt(0)
op_sk_109:
    s_barrier
    s_mov_b32 s28, 2064384
    s_add_u32 s28, s28, s24
    s_lshl_b32 s29, s19, 12
    s_add_u32 s29, s29, 65536
    s_add_u32 m0, s29, 0
    s_nop 0
    buffer_load_dwordx4 v52, s[12:15], s28 offen lds
    s_add_u32 m0, s29, 1024
    s_nop 0
    buffer_load_dwordx4 v53, s[12:15], s28 offen lds
    s_add_u32 m0, s29, 2048
    s_nop 0
    buffer_load_dwordx4 v54, s[12:15], s28 offen lds
    s_add_u32 m0, s29, 3072
    s_nop 0
    buffer_load_dwordx4 v55, s[12:15], s28 offen lds
    s_waitcnt vmcnt(36)
    s_barrier
    s_cmp_lg_u32 s19, 0
    s_cbranch_scc1 op_sk_110
    v_add_u32 v44, 81920, v56
    ds_read_b64_tr_b16 a[80:81], v44 offset:0
    ds_read_b64_tr_b16 a[82:83], v44 offset:2048
    ds_read_b64_tr_b16 a[84:85], v44 offset:4096
    ds_read_b64_tr_b16 a[86:87], v44 offset:6144
    ds_read_b64_tr_b16 a[88:89], v44 offset:8192
    ds_read_b64_tr_b16 a[90:91], v44 offset:10240
    ds_read_b64_tr_b16 a[92:93], v44 offset:12288
    ds_read_b64_tr_b16 a[94:95], v44 offset:14336
    v_add_u32 v44, 81920, v57
    ds_read_b64_tr_b16 a[208:209], v44 offset:0
    ds_read_b64_tr_b16 a[210:211], v44 offset:2048
    ds_read_b64_tr_b16 a[212:213], v44 offset:4096
    ds_read_b64_tr_b16 a[214:215], v44 offset:6144
    ds_read_b64_tr_b16 a[216:217], v44 offset:8192
    ds_read_b64_tr_b16 a[218:219], v44 offset:10240
    ds_read_b64_tr_b16 a[220:221], v44 offset:12288
    ds_read_b64_tr_b16 a[222:223], v44 offset:14336
    v_add_u32 v44, 81920, v58
    ds_read_b64_tr_b16 v[208:209], v44 offset:0
    ds_read_b64_tr_b16 v[210:211], v44 offset:2048
    ds_read_b64_tr_b16 v[212:213], v44 offset:4096
    ds_read_b64_tr_b16 v[214:215], v44 offset:6144
    ds_read_b64_tr_b16 v[216:217], v44 offset:8192
    ds_read_b64_tr_b16 v[218:219], v44 offset:10240
    ds_read_b64_tr_b16 v[220:221], v44 offset:12288
    ds_read_b64_tr_b16 v[222:223], v44 offset:14336
    s_waitcnt lgkmcnt(0)
op_sk_110:
    s_barrier
    s_mov_b32 s28, 2211840
    s_add_u32 s28, s28, s24
    s_lshl_b32 s29, s19, 12
    s_add_u32 s29, s29, 81920
    s_add_u32 m0, s29, 0
    s_nop 0
    buffer_load_dwordx4 v52, s[12:15], s28 offen lds
    s_add_u32 m0, s29, 1024
    s_nop 0
    buffer_load_dwordx4 v53, s[12:15], s28 offen lds
    s_add_u32 m0, s29, 2048
    s_nop 0
    buffer_load_dwordx4 v54, s[12:15], s28 offen lds
    s_add_u32 m0, s29, 3072
    s_nop 0
    buffer_load_dwordx4 v55, s[12:15], s28 offen lds
    s_waitcnt vmcnt(36)
    s_barrier
    s_cmp_lg_u32 s19, 0
    s_cbranch_scc1 op_sk_111
    v_add_u32 v44, 98304, v56
    ds_read_b64_tr_b16 a[96:97], v44 offset:0
    ds_read_b64_tr_b16 a[98:99], v44 offset:2048
    ds_read_b64_tr_b16 a[100:101], v44 offset:4096
    ds_read_b64_tr_b16 a[102:103], v44 offset:6144
    ds_read_b64_tr_b16 a[104:105], v44 offset:8192
    ds_read_b64_tr_b16 a[106:107], v44 offset:10240
    ds_read_b64_tr_b16 a[108:109], v44 offset:12288
    ds_read_b64_tr_b16 a[110:111], v44 offset:14336
    v_add_u32 v44, 98304, v57
    ds_read_b64_tr_b16 a[224:225], v44 offset:0
    ds_read_b64_tr_b16 a[226:227], v44 offset:2048
    ds_read_b64_tr_b16 a[228:229], v44 offset:4096
    ds_read_b64_tr_b16 a[230:231], v44 offset:6144
    ds_read_b64_tr_b16 a[232:233], v44 offset:8192
    ds_read_b64_tr_b16 a[234:235], v44 offset:10240
    ds_read_b64_tr_b16 a[236:237], v44 offset:12288
    ds_read_b64_tr_b16 a[238:239], v44 offset:14336
    v_add_u32 v44, 98304, v58
    ds_read_b64_tr_b16 v[224:225], v44 offset:0
    ds_read_b64_tr_b16 v[226:227], v44 offset:2048
    ds_read_b64_tr_b16 v[228:229], v44 offset:4096
    ds_read_b64_tr_b16 v[230:231], v44 offset:6144
    ds_read_b64_tr_b16 v[232:233], v44 offset:8192
    ds_read_b64_tr_b16 v[234:235], v44 offset:10240
    ds_read_b64_tr_b16 v[236:237], v44 offset:12288
    ds_read_b64_tr_b16 v[238:239], v44 offset:14336
    s_waitcnt lgkmcnt(0)
op_sk_111:
    s_barrier
    s_mov_b32 s28, 2359296
    s_add_u32 s28, s28, s24
    s_lshl_b32 s29, s19, 12
    s_add_u32 s29, s29, 98304
    s_add_u32 m0, s29, 0
    s_nop 0
    buffer_load_dwordx4 v52, s[12:15], s28 offen lds
    s_add_u32 m0, s29, 1024
    s_nop 0
    buffer_load_dwordx4 v53, s[12:15], s28 offen lds
    s_add_u32 m0, s29, 2048
    s_nop 0
    buffer_load_dwordx4 v54, s[12:15], s28 offen lds
    s_add_u32 m0, s29, 3072
    s_nop 0
    buffer_load_dwordx4 v55, s[12:15], s28 offen lds
    s_waitcnt vmcnt(36)
    s_barrier
    s_cmp_lg_u32 s19, 0
    s_cbranch_scc1 op_sk_112
    v_add_u32 v44, 114688, v56
    ds_read_b64_tr_b16 a[112:113], v44 offset:0
    ds_read_b64_tr_b16 a[114:115], v44 offset:2048
    ds_read_b64_tr_b16 a[116:117], v44 offset:4096
    ds_read_b64_tr_b16 a[118:119], v44 offset:6144
    ds_read_b64_tr_b16 a[120:121], v44 offset:8192
    ds_read_b64_tr_b16 a[122:123], v44 offset:10240
    ds_read_b64_tr_b16 a[124:125], v44 offset:12288
    ds_read_b64_tr_b16 a[126:127], v44 offset:14336
    v_add_u32 v44, 114688, v57
    ds_read_b64_tr_b16 a[240:241], v44 offset:0
    ds_read_b64_tr_b16 a[242:243], v44 offset:2048
    ds_read_b64_tr_b16 a[244:245], v44 offset:4096
    ds_read_b64_tr_b16 a[246:247], v44 offset:6144
    ds_read_b64_tr_b16 a[248:249], v44 offset:8192
    ds_read_b64_tr_b16 a[250:251], v44 offset:10240
    ds_read_b64_tr_b16 a[252:253], v44 offset:12288
    ds_read_b64_tr_b16 a[254:255], v44 offset:14336
    v_add_u32 v44, 114688, v58
    ds_read_b64_tr_b16 v[240:241], v44 offset:0
    ds_read_b64_tr_b16 v[242:243], v44 offset:2048
    ds_read_b64_tr_b16 v[244:245], v44 offset:4096
    ds_read_b64_tr_b16 v[246:247], v44 offset:6144
    ds_read_b64_tr_b16 v[248:249], v44 offset:8192
    ds_read_b64_tr_b16 v[250:251], v44 offset:10240
    ds_read_b64_tr_b16 v[252:253], v44 offset:12288
    ds_read_b64_tr_b16 v[254:255], v44 offset:14336
    s_waitcnt lgkmcnt(0)
op_sk_112:
    s_barrier
    s_mov_b32 s28, 2506752
    s_add_u32 s28, s28, s24
    s_lshl_b32 s29, s19, 12
    s_add_u32 s29, s29, 114688
    s_add_u32 m0, s29, 0
    s_nop 0
    buffer_load_dwordx4 v52, s[12:15], s28 offen lds
    s_add_u32 m0, s29, 1024
    s_nop 0
    buffer_load_dwordx4 v53, s[12:15], s28 offen lds
    s_add_u32 m0, s29, 2048
    s_nop 0
    buffer_load_dwordx4 v54, s[12:15], s28 offen lds
    s_add_u32 m0, s29, 3072
    s_nop 0
    buffer_load_dwordx4 v55, s[12:15], s28 offen lds
    s_waitcnt vmcnt(36)
    s_barrier
    s_cmp_lg_u32 s19, 1
    s_cbranch_scc1 op_sk_113
    v_add_u32 v44, 131072, v56
    ds_read_b64_tr_b16 a[0:1], v44 offset:0
    ds_read_b64_tr_b16 a[2:3], v44 offset:2048
    ds_read_b64_tr_b16 a[4:5], v44 offset:4096
    ds_read_b64_tr_b16 a[6:7], v44 offset:6144
    ds_read_b64_tr_b16 a[8:9], v44 offset:8192
    ds_read_b64_tr_b16 a[10:11], v44 offset:10240
    ds_read_b64_tr_b16 a[12:13], v44 offset:12288
    ds_read_b64_tr_b16 a[14:15], v44 offset:14336
    v_add_u32 v44, 131072, v57
    ds_read_b64_tr_b16 a[128:129], v44 offset:0
    ds_read_b64_tr_b16 a[130:131], v44 offset:2048
    ds_read_b64_tr_b16 a[132:133], v44 offset:4096
    ds_read_b64_tr_b16 a[134:135], v44 offset:6144
    ds_read_b64_tr_b16 a[136:137], v44 offset:8192
    ds_read_b64_tr_b16 a[138:139], v44 offset:10240
    ds_read_b64_tr_b16 a[140:141], v44 offset:12288
    ds_read_b64_tr_b16 a[142:143], v44 offset:14336
    v_add_u32 v44, 131072, v58
    ds_read_b64_tr_b16 v[128:129], v44 offset:0
    ds_read_b64_tr_b16 v[130:131], v44 offset:2048
    ds_read_b64_tr_b16 v[132:133], v44 offset:4096
    ds_read_b64_tr_b16 v[134:135], v44 offset:6144
    ds_read_b64_tr_b16 v[136:137], v44 offset:8192
    ds_read_b64_tr_b16 v[138:139], v44 offset:10240
    ds_read_b64_tr_b16 v[140:141], v44 offset:12288
    ds_read_b64_tr_b16 v[142:143], v44 offset:14336
    s_waitcnt lgkmcnt(0)
op_sk_113:
    s_barrier
    s_mov_b32 s28, 2654208
    s_add_u32 s28, s28, s24
    s_lshl_b32 s29, s19, 12
    s_add_u32 s29, s29, 131072
    s_add_u32 m0, s29, 0
    s_nop 0
    buffer_load_dwordx4 v52, s[12:15], s28 offen lds
    s_add_u32 m0, s29, 1024
    s_nop 0
    buffer_load_dwordx4 v53, s[12:15], s28 offen lds
    s_add_u32 m0, s29, 2048
    s_nop 0
    buffer_load_dwordx4 v54, s[12:15], s28 offen lds
    s_add_u32 m0, s29, 3072
    s_nop 0
    buffer_load_dwordx4 v55, s[12:15], s28 offen lds
    s_waitcnt vmcnt(36)
    s_barrier
    s_cmp_lg_u32 s19, 1
    s_cbranch_scc1 op_sk_114
    v_add_u32 v44, 147456, v56
    ds_read_b64_tr_b16 a[16:17], v44 offset:0
    ds_read_b64_tr_b16 a[18:19], v44 offset:2048
    ds_read_b64_tr_b16 a[20:21], v44 offset:4096
    ds_read_b64_tr_b16 a[22:23], v44 offset:6144
    ds_read_b64_tr_b16 a[24:25], v44 offset:8192
    ds_read_b64_tr_b16 a[26:27], v44 offset:10240
    ds_read_b64_tr_b16 a[28:29], v44 offset:12288
    ds_read_b64_tr_b16 a[30:31], v44 offset:14336
    v_add_u32 v44, 147456, v57
    ds_read_b64_tr_b16 a[144:145], v44 offset:0
    ds_read_b64_tr_b16 a[146:147], v44 offset:2048
    ds_read_b64_tr_b16 a[148:149], v44 offset:4096
    ds_read_b64_tr_b16 a[150:151], v44 offset:6144
    ds_read_b64_tr_b16 a[152:153], v44 offset:8192
    ds_read_b64_tr_b16 a[154:155], v44 offset:10240
    ds_read_b64_tr_b16 a[156:157], v44 offset:12288
    ds_read_b64_tr_b16 a[158:159], v44 offset:14336
    v_add_u32 v44, 147456, v58
    ds_read_b64_tr_b16 v[144:145], v44 offset:0
    ds_read_b64_tr_b16 v[146:147], v44 offset:2048
    ds_read_b64_tr_b16 v[148:149], v44 offset:4096
    ds_read_b64_tr_b16 v[150:151], v44 offset:6144
    ds_read_b64_tr_b16 v[152:153], v44 offset:8192
    ds_read_b64_tr_b16 v[154:155], v44 offset:10240
    ds_read_b64_tr_b16 v[156:157], v44 offset:12288
    ds_read_b64_tr_b16 v[158:159], v44 offset:14336
    s_waitcnt lgkmcnt(0)
op_sk_114:
    s_barrier
    s_mov_b32 s28, 2801664
    s_add_u32 s28, s28, s24
    s_lshl_b32 s29, s19, 12
    s_add_u32 s29, s29, 147456
    s_add_u32 m0, s29, 0
    s_nop 0
    buffer_load_dwordx4 v52, s[12:15], s28 offen lds
    s_add_u32 m0, s29, 1024
    s_nop 0
    buffer_load_dwordx4 v53, s[12:15], s28 offen lds
    s_add_u32 m0, s29, 2048
    s_nop 0
    buffer_load_dwordx4 v54, s[12:15], s28 offen lds
    s_add_u32 m0, s29, 3072
    s_nop 0
    buffer_load_dwordx4 v55, s[12:15], s28 offen lds
    s_waitcnt vmcnt(36)
    s_barrier
    s_cmp_lg_u32 s19, 1
    s_cbranch_scc1 op_sk_115
    v_add_u32 v44, 0, v56
    ds_read_b64_tr_b16 a[32:33], v44 offset:0
    ds_read_b64_tr_b16 a[34:35], v44 offset:2048
    ds_read_b64_tr_b16 a[36:37], v44 offset:4096
    ds_read_b64_tr_b16 a[38:39], v44 offset:6144
    ds_read_b64_tr_b16 a[40:41], v44 offset:8192
    ds_read_b64_tr_b16 a[42:43], v44 offset:10240
    ds_read_b64_tr_b16 a[44:45], v44 offset:12288
    ds_read_b64_tr_b16 a[46:47], v44 offset:14336
    v_add_u32 v44, 0, v57
    ds_read_b64_tr_b16 a[160:161], v44 offset:0
    ds_read_b64_tr_b16 a[162:163], v44 offset:2048
    ds_read_b64_tr_b16 a[164:165], v44 offset:4096
    ds_read_b64_tr_b16 a[166:167], v44 offset:6144
    ds_read_b64_tr_b16 a[168:169], v44 offset:8192
    ds_read_b64_tr_b16 a[170:171], v44 offset:10240
    ds_read_b64_tr_b16 a[172:173], v44 offset:12288
    ds_read_b64_tr_b16 a[174:175], v44 offset:14336
    v_add_u32 v44, 0, v58
    ds_read_b64_tr_b16 v[160:161], v44 offset:0
    ds_read_b64_tr_b16 v[162:163], v44 offset:2048
    ds_read_b64_tr_b16 v[164:165], v44 offset:4096
    ds_read_b64_tr_b16 v[166:167], v44 offset:6144
    ds_read_b64_tr_b16 v[168:169], v44 offset:8192
    ds_read_b64_tr_b16 v[170:171], v44 offset:10240
    ds_read_b64_tr_b16 v[172:173], v44 offset:12288
    ds_read_b64_tr_b16 v[174:175], v44 offset:14336
    s_waitcnt lgkmcnt(0)
op_sk_115:
    s_barrier
    s_mov_b32 s28, 2949120
    s_add_u32 s28, s28, s24
    s_lshl_b32 s29, s19, 12
    s_add_u32 s29, s29, 0
    s_add_u32 m0, s29, 0
    s_nop 0
    buffer_load_dwordx4 v52, s[12:15], s28 offen lds
    s_add_u32 m0, s29, 1024
    s_nop 0
    buffer_load_dwordx4 v53, s[12:15], s28 offen lds
    s_add_u32 m0, s29, 2048
    s_nop 0
    buffer_load_dwordx4 v54, s[12:15], s28 offen lds
    s_add_u32 m0, s29, 3072
    s_nop 0
    buffer_load_dwordx4 v55, s[12:15], s28 offen lds
    s_waitcnt vmcnt(36)
    s_barrier
    s_cmp_lg_u32 s19, 1
    s_cbranch_scc1 op_sk_116
    v_add_u32 v44, 16384, v56
    ds_read_b64_tr_b16 a[48:49], v44 offset:0
    ds_read_b64_tr_b16 a[50:51], v44 offset:2048
    ds_read_b64_tr_b16 a[52:53], v44 offset:4096
    ds_read_b64_tr_b16 a[54:55], v44 offset:6144
    ds_read_b64_tr_b16 a[56:57], v44 offset:8192
    ds_read_b64_tr_b16 a[58:59], v44 offset:10240
    ds_read_b64_tr_b16 a[60:61], v44 offset:12288
    ds_read_b64_tr_b16 a[62:63], v44 offset:14336
    v_add_u32 v44, 16384, v57
    ds_read_b64_tr_b16 a[176:177], v44 offset:0
    ds_read_b64_tr_b16 a[178:179], v44 offset:2048
    ds_read_b64_tr_b16 a[180:181], v44 offset:4096
    ds_read_b64_tr_b16 a[182:183], v44 offset:6144
    ds_read_b64_tr_b16 a[184:185], v44 offset:8192
    ds_read_b64_tr_b16 a[186:187], v44 offset:10240
    ds_read_b64_tr_b16 a[188:189], v44 offset:12288
    ds_read_b64_tr_b16 a[190:191], v44 offset:14336
    v_add_u32 v44, 16384, v58
    ds_read_b64_tr_b16 v[176:177], v44 offset:0
    ds_read_b64_tr_b16 v[178:179], v44 offset:2048
    ds_read_b64_tr_b16 v[180:181], v44 offset:4096
    ds_read_b64_tr_b16 v[182:183], v44 offset:6144
    ds_read_b64_tr_b16 v[184:185], v44 offset:8192
    ds_read_b64_tr_b16 v[186:187], v44 offset:10240
    ds_read_b64_tr_b16 v[188:189], v44 offset:12288
    ds_read_b64_tr_b16 v[190:191], v44 offset:14336
    s_waitcnt lgkmcnt(0)
op_sk_116:
    s_barrier
    s_mov_b32 s28, 3096576
    s_add_u32 s28, s28, s24
    s_lshl_b32 s29, s19, 12
    s_add_u32 s29, s29, 16384
    s_add_u32 m0, s29, 0
    s_nop 0
    buffer_load_dwordx4 v52, s[12:15], s28 offen lds
    s_add_u32 m0, s29, 1024
    s_nop 0
    buffer_load_dwordx4 v53, s[12:15], s28 offen lds
    s_add_u32 m0, s29, 2048
    s_nop 0
    buffer_load_dwordx4 v54, s[12:15], s28 offen lds
    s_add_u32 m0, s29, 3072
    s_nop 0
    buffer_load_dwordx4 v55, s[12:15], s28 offen lds
    s_waitcnt vmcnt(36)
    s_barrier
    s_cmp_lg_u32 s19, 1
    s_cbranch_scc1 op_sk_117
    v_add_u32 v44, 32768, v56
    ds_read_b64_tr_b16 a[64:65], v44 offset:0
    ds_read_b64_tr_b16 a[66:67], v44 offset:2048
    ds_read_b64_tr_b16 a[68:69], v44 offset:4096
    ds_read_b64_tr_b16 a[70:71], v44 offset:6144
    ds_read_b64_tr_b16 a[72:73], v44 offset:8192
    ds_read_b64_tr_b16 a[74:75], v44 offset:10240
    ds_read_b64_tr_b16 a[76:77], v44 offset:12288
    ds_read_b64_tr_b16 a[78:79], v44 offset:14336
    v_add_u32 v44, 32768, v57
    ds_read_b64_tr_b16 a[192:193], v44 offset:0
    ds_read_b64_tr_b16 a[194:195], v44 offset:2048
    ds_read_b64_tr_b16 a[196:197], v44 offset:4096
    ds_read_b64_tr_b16 a[198:199], v44 offset:6144
    ds_read_b64_tr_b16 a[200:201], v44 offset:8192
    ds_read_b64_tr_b16 a[202:203], v44 offset:10240
    ds_read_b64_tr_b16 a[204:205], v44 offset:12288
    ds_read_b64_tr_b16 a[206:207], v44 offset:14336
    v_add_u32 v44, 32768, v58
    ds_read_b64_tr_b16 v[192:193], v44 offset:0
    ds_read_b64_tr_b16 v[194:195], v44 offset:2048
    ds_read_b64_tr_b16 v[196:197], v44 offset:4096
    ds_read_b64_tr_b16 v[198:199], v44 offset:6144
    ds_read_b64_tr_b16 v[200:201], v44 offset:8192
    ds_read_b64_tr_b16 v[202:203], v44 offset:10240
    ds_read_b64_tr_b16 v[204:205], v44 offset:12288
    ds_read_b64_tr_b16 v[206:207], v44 offset:14336
    s_waitcnt lgkmcnt(0)
op_sk_117:
    s_barrier
    s_mov_b32 s28, 3244032
    s_add_u32 s28, s28, s24
    s_lshl_b32 s29, s19, 12
    s_add_u32 s29, s29, 32768
    s_add_u32 m0, s29, 0
    s_nop 0
    buffer_load_dwordx4 v52, s[12:15], s28 offen lds
    s_add_u32 m0, s29, 1024
    s_nop 0
    buffer_load_dwordx4 v53, s[12:15], s28 offen lds
    s_add_u32 m0, s29, 2048
    s_nop 0
    buffer_load_dwordx4 v54, s[12:15], s28 offen lds
    s_add_u32 m0, s29, 3072
    s_nop 0
    buffer_load_dwordx4 v55, s[12:15], s28 offen lds
    s_waitcnt vmcnt(36)
    s_barrier
    s_cmp_lg_u32 s19, 1
    s_cbranch_scc1 op_sk_118
    v_add_u32 v44, 49152, v56
    ds_read_b64_tr_b16 a[80:81], v44 offset:0
    ds_read_b64_tr_b16 a[82:83], v44 offset:2048
    ds_read_b64_tr_b16 a[84:85], v44 offset:4096
    ds_read_b64_tr_b16 a[86:87], v44 offset:6144
    ds_read_b64_tr_b16 a[88:89], v44 offset:8192
    ds_read_b64_tr_b16 a[90:91], v44 offset:10240
    ds_read_b64_tr_b16 a[92:93], v44 offset:12288
    ds_read_b64_tr_b16 a[94:95], v44 offset:14336
    v_add_u32 v44, 49152, v57
    ds_read_b64_tr_b16 a[208:209], v44 offset:0
    ds_read_b64_tr_b16 a[210:211], v44 offset:2048
    ds_read_b64_tr_b16 a[212:213], v44 offset:4096
    ds_read_b64_tr_b16 a[214:215], v44 offset:6144
    ds_read_b64_tr_b16 a[216:217], v44 offset:8192
    ds_read_b64_tr_b16 a[218:219], v44 offset:10240
    ds_read_b64_tr_b16 a[220:221], v44 offset:12288
    ds_read_b64_tr_b16 a[222:223], v44 offset:14336
    v_add_u32 v44, 49152, v58
    ds_read_b64_tr_b16 v[208:209], v44 offset:0
    ds_read_b64_tr_b16 v[210:211], v44 offset:2048
    ds_read_b64_tr_b16 v[212:213], v44 offset:4096
    ds_read_b64_tr_b16 v[214:215], v44 offset:6144
    ds_read_b64_tr_b16 v[216:217], v44 offset:8192
    ds_read_b64_tr_b16 v[218:219], v44 offset:10240
    ds_read_b64_tr_b16 v[220:221], v44 offset:12288
    ds_read_b64_tr_b16 v[222:223], v44 offset:14336
    s_waitcnt lgkmcnt(0)
op_sk_118:
    s_barrier
    s_mov_b32 s28, 3391488
    s_add_u32 s28, s28, s24
    s_lshl_b32 s29, s19, 12
    s_add_u32 s29, s29, 49152
    s_add_u32 m0, s29, 0
    s_nop 0
    buffer_load_dwordx4 v52, s[12:15], s28 offen lds
    s_add_u32 m0, s29, 1024
    s_nop 0
    buffer_load_dwordx4 v53, s[12:15], s28 offen lds
    s_add_u32 m0, s29, 2048
    s_nop 0
    buffer_load_dwordx4 v54, s[12:15], s28 offen lds
    s_add_u32 m0, s29, 3072
    s_nop 0
    buffer_load_dwordx4 v55, s[12:15], s28 offen lds
    s_waitcnt vmcnt(36)
    s_barrier
    s_cmp_lg_u32 s19, 1
    s_cbranch_scc1 op_sk_119
    v_add_u32 v44, 65536, v56
    ds_read_b64_tr_b16 a[96:97], v44 offset:0
    ds_read_b64_tr_b16 a[98:99], v44 offset:2048
    ds_read_b64_tr_b16 a[100:101], v44 offset:4096
    ds_read_b64_tr_b16 a[102:103], v44 offset:6144
    ds_read_b64_tr_b16 a[104:105], v44 offset:8192
    ds_read_b64_tr_b16 a[106:107], v44 offset:10240
    ds_read_b64_tr_b16 a[108:109], v44 offset:12288
    ds_read_b64_tr_b16 a[110:111], v44 offset:14336
    v_add_u32 v44, 65536, v57
    ds_read_b64_tr_b16 a[224:225], v44 offset:0
    ds_read_b64_tr_b16 a[226:227], v44 offset:2048
    ds_read_b64_tr_b16 a[228:229], v44 offset:4096
    ds_read_b64_tr_b16 a[230:231], v44 offset:6144
    ds_read_b64_tr_b16 a[232:233], v44 offset:8192
    ds_read_b64_tr_b16 a[234:235], v44 offset:10240
    ds_read_b64_tr_b16 a[236:237], v44 offset:12288
    ds_read_b64_tr_b16 a[238:239], v44 offset:14336
    v_add_u32 v44, 65536, v58
    ds_read_b64_tr_b16 v[224:225], v44 offset:0
    ds_read_b64_tr_b16 v[226:227], v44 offset:2048
    ds_read_b64_tr_b16 v[228:229], v44 offset:4096
    ds_read_b64_tr_b16 v[230:231], v44 offset:6144
    ds_read_b64_tr_b16 v[232:233], v44 offset:8192
    ds_read_b64_tr_b16 v[234:235], v44 offset:10240
    ds_read_b64_tr_b16 v[236:237], v44 offset:12288
    ds_read_b64_tr_b16 v[238:239], v44 offset:14336
    s_waitcnt lgkmcnt(0)
op_sk_119:
    s_barrier
    s_mov_b32 s28, 3538944
    s_add_u32 s28, s28, s24
    s_lshl_b32 s29, s19, 12
    s_add_u32 s29, s29, 65536
    s_add_u32 m0, s29, 0
    s_nop 0
    buffer_load_dwordx4 v52, s[12:15], s28 offen lds
    s_add_u32 m0, s29, 1024
    s_nop 0
    buffer_load_dwordx4 v53, s[12:15], s28 offen lds
    s_add_u32 m0, s29, 2048
    s_nop 0
    buffer_load_dwordx4 v54, s[12:15], s28 offen lds
    s_add_u32 m0, s29, 3072
    s_nop 0
    buffer_load_dwordx4 v55, s[12:15], s28 offen lds
    s_waitcnt vmcnt(36)
    s_barrier
    s_cmp_lg_u32 s19, 1
    s_cbranch_scc1 op_sk_120
    v_add_u32 v44, 81920, v56
    ds_read_b64_tr_b16 a[112:113], v44 offset:0
    ds_read_b64_tr_b16 a[114:115], v44 offset:2048
    ds_read_b64_tr_b16 a[116:117], v44 offset:4096
    ds_read_b64_tr_b16 a[118:119], v44 offset:6144
    ds_read_b64_tr_b16 a[120:121], v44 offset:8192
    ds_read_b64_tr_b16 a[122:123], v44 offset:10240
    ds_read_b64_tr_b16 a[124:125], v44 offset:12288
    ds_read_b64_tr_b16 a[126:127], v44 offset:14336
    v_add_u32 v44, 81920, v57
    ds_read_b64_tr_b16 a[240:241], v44 offset:0
    ds_read_b64_tr_b16 a[242:243], v44 offset:2048
    ds_read_b64_tr_b16 a[244:245], v44 offset:4096
    ds_read_b64_tr_b16 a[246:247], v44 offset:6144
    ds_read_b64_tr_b16 a[248:249], v44 offset:8192
    ds_read_b64_tr_b16 a[250:251], v44 offset:10240
    ds_read_b64_tr_b16 a[252:253], v44 offset:12288
    ds_read_b64_tr_b16 a[254:255], v44 offset:14336
    v_add_u32 v44, 81920, v58
    ds_read_b64_tr_b16 v[240:241], v44 offset:0
    ds_read_b64_tr_b16 v[242:243], v44 offset:2048
    ds_read_b64_tr_b16 v[244:245], v44 offset:4096
    ds_read_b64_tr_b16 v[246:247], v44 offset:6144
    ds_read_b64_tr_b16 v[248:249], v44 offset:8192
    ds_read_b64_tr_b16 v[250:251], v44 offset:10240
    ds_read_b64_tr_b16 v[252:253], v44 offset:12288
    ds_read_b64_tr_b16 v[254:255], v44 offset:14336
    s_waitcnt lgkmcnt(0)
op_sk_120:
    s_barrier
    s_mov_b32 s28, 3686400
    s_add_u32 s28, s28, s24
    s_lshl_b32 s29, s19, 12
    s_add_u32 s29, s29, 81920
    s_add_u32 m0, s29, 0
    s_nop 0
    buffer_load_dwordx4 v52, s[12:15], s28 offen lds
    s_add_u32 m0, s29, 1024
    s_nop 0
    buffer_load_dwordx4 v53, s[12:15], s28 offen lds
    s_add_u32 m0, s29, 2048
    s_nop 0
    buffer_load_dwordx4 v54, s[12:15], s28 offen lds
    s_add_u32 m0, s29, 3072
    s_nop 0
    buffer_load_dwordx4 v55, s[12:15], s28 offen lds
    s_waitcnt vmcnt(36)
    s_barrier
    s_cmp_lg_u32 s19, 2
    s_cbranch_scc1 op_sk_121
    v_add_u32 v44, 98304, v56
    ds_read_b64_tr_b16 a[0:1], v44 offset:0
    ds_read_b64_tr_b16 a[2:3], v44 offset:2048
    ds_read_b64_tr_b16 a[4:5], v44 offset:4096
    ds_read_b64_tr_b16 a[6:7], v44 offset:6144
    ds_read_b64_tr_b16 a[8:9], v44 offset:8192
    ds_read_b64_tr_b16 a[10:11], v44 offset:10240
    ds_read_b64_tr_b16 a[12:13], v44 offset:12288
    ds_read_b64_tr_b16 a[14:15], v44 offset:14336
    v_add_u32 v44, 98304, v57
    ds_read_b64_tr_b16 a[128:129], v44 offset:0
    ds_read_b64_tr_b16 a[130:131], v44 offset:2048
    ds_read_b64_tr_b16 a[132:133], v44 offset:4096
    ds_read_b64_tr_b16 a[134:135], v44 offset:6144
    ds_read_b64_tr_b16 a[136:137], v44 offset:8192
    ds_read_b64_tr_b16 a[138:139], v44 offset:10240
    ds_read_b64_tr_b16 a[140:141], v44 offset:12288
    ds_read_b64_tr_b16 a[142:143], v44 offset:14336
    v_add_u32 v44, 98304, v58
    ds_read_b64_tr_b16 v[128:129], v44 offset:0
    ds_read_b64_tr_b16 v[130:131], v44 offset:2048
    ds_read_b64_tr_b16 v[132:133], v44 offset:4096
    ds_read_b64_tr_b16 v[134:135], v44 offset:6144
    ds_read_b64_tr_b16 v[136:137], v44 offset:8192
    ds_read_b64_tr_b16 v[138:139], v44 offset:10240
    ds_read_b64_tr_b16 v[140:141], v44 offset:12288
    ds_read_b64_tr_b16 v[142:143], v44 offset:14336
    s_waitcnt lgkmcnt(0)
op_sk_121:
    s_barrier
    s_mov_b32 s28, 3833856
    s_add_u32 s28, s28, s24
    s_lshl_b32 s29, s19, 12
    s_add_u32 s29, s29, 98304
    s_add_u32 m0, s29, 0
    s_nop 0
    buffer_load_dwordx4 v52, s[12:15], s28 offen lds
    s_add_u32 m0, s29, 1024
    s_nop 0
    buffer_load_dwordx4 v53, s[12:15], s28 offen lds
    s_add_u32 m0, s29, 2048
    s_nop 0
    buffer_load_dwordx4 v54, s[12:15], s28 offen lds
    s_add_u32 m0, s29, 3072
    s_nop 0
    buffer_load_dwordx4 v55, s[12:15], s28 offen lds
    s_waitcnt vmcnt(36)
    s_barrier
    s_cmp_lg_u32 s19, 2
    s_cbranch_scc1 op_sk_122
    v_add_u32 v44, 114688, v56
    ds_read_b64_tr_b16 a[16:17], v44 offset:0
    ds_read_b64_tr_b16 a[18:19], v44 offset:2048
    ds_read_b64_tr_b16 a[20:21], v44 offset:4096
    ds_read_b64_tr_b16 a[22:23], v44 offset:6144
    ds_read_b64_tr_b16 a[24:25], v44 offset:8192
    ds_read_b64_tr_b16 a[26:27], v44 offset:10240
    ds_read_b64_tr_b16 a[28:29], v44 offset:12288
    ds_read_b64_tr_b16 a[30:31], v44 offset:14336
    v_add_u32 v44, 114688, v57
    ds_read_b64_tr_b16 a[144:145], v44 offset:0
    ds_read_b64_tr_b16 a[146:147], v44 offset:2048
    ds_read_b64_tr_b16 a[148:149], v44 offset:4096
    ds_read_b64_tr_b16 a[150:151], v44 offset:6144
    ds_read_b64_tr_b16 a[152:153], v44 offset:8192
    ds_read_b64_tr_b16 a[154:155], v44 offset:10240
    ds_read_b64_tr_b16 a[156:157], v44 offset:12288
    ds_read_b64_tr_b16 a[158:159], v44 offset:14336
    v_add_u32 v44, 114688, v58
    ds_read_b64_tr_b16 v[144:145], v44 offset:0
    ds_read_b64_tr_b16 v[146:147], v44 offset:2048
    ds_read_b64_tr_b16 v[148:149], v44 offset:4096
    ds_read_b64_tr_b16 v[150:151], v44 offset:6144
    ds_read_b64_tr_b16 v[152:153], v44 offset:8192
    ds_read_b64_tr_b16 v[154:155], v44 offset:10240
    ds_read_b64_tr_b16 v[156:157], v44 offset:12288
    ds_read_b64_tr_b16 v[158:159], v44 offset:14336
    s_waitcnt lgkmcnt(0)
op_sk_122:
    s_barrier
    s_mov_b32 s28, 3981312
    s_add_u32 s28, s28, s24
    s_lshl_b32 s29, s19, 12
    s_add_u32 s29, s29, 114688
    s_add_u32 m0, s29, 0
    s_nop 0
    buffer_load_dwordx4 v52, s[12:15], s28 offen lds
    s_add_u32 m0, s29, 1024
    s_nop 0
    buffer_load_dwordx4 v53, s[12:15], s28 offen lds
    s_add_u32 m0, s29, 2048
    s_nop 0
    buffer_load_dwordx4 v54, s[12:15], s28 offen lds
    s_add_u32 m0, s29, 3072
    s_nop 0
    buffer_load_dwordx4 v55, s[12:15], s28 offen lds
    s_waitcnt vmcnt(36)
    s_barrier
    s_cmp_lg_u32 s19, 2
    s_cbranch_scc1 op_sk_123
    v_add_u32 v44, 131072, v56
    ds_read_b64_tr_b16 a[32:33], v44 offset:0
    ds_read_b64_tr_b16 a[34:35], v44 offset:2048
    ds_read_b64_tr_b16 a[36:37], v44 offset:4096
    ds_read_b64_tr_b16 a[38:39], v44 offset:6144
    ds_read_b64_tr_b16 a[40:41], v44 offset:8192
    ds_read_b64_tr_b16 a[42:43], v44 offset:10240
    ds_read_b64_tr_b16 a[44:45], v44 offset:12288
    ds_read_b64_tr_b16 a[46:47], v44 offset:14336
    v_add_u32 v44, 131072, v57
    ds_read_b64_tr_b16 a[160:161], v44 offset:0
    ds_read_b64_tr_b16 a[162:163], v44 offset:2048
    ds_read_b64_tr_b16 a[164:165], v44 offset:4096
    ds_read_b64_tr_b16 a[166:167], v44 offset:6144
    ds_read_b64_tr_b16 a[168:169], v44 offset:8192
    ds_read_b64_tr_b16 a[170:171], v44 offset:10240
    ds_read_b64_tr_b16 a[172:173], v44 offset:12288
    ds_read_b64_tr_b16 a[174:175], v44 offset:14336
    v_add_u32 v44, 131072, v58
    ds_read_b64_tr_b16 v[160:161], v44 offset:0
    ds_read_b64_tr_b16 v[162:163], v44 offset:2048
    ds_read_b64_tr_b16 v[164:165], v44 offset:4096
    ds_read_b64_tr_b16 v[166:167], v44 offset:6144
    ds_read_b64_tr_b16 v[168:169], v44 offset:8192
    ds_read_b64_tr_b16 v[170:171], v44 offset:10240
    ds_read_b64_tr_b16 v[172:173], v44 offset:12288
    ds_read_b64_tr_b16 v[174:175], v44 offset:14336
    s_waitcnt lgkmcnt(0)
op_sk_123:
    s_barrier
    s_mov_b32 s28, 4128768
    s_add_u32 s28, s28, s24
    s_lshl_b32 s29, s19, 12
    s_add_u32 s29, s29, 131072
    s_add_u32 m0, s29, 0
    s_nop 0
    buffer_load_dwordx4 v52, s[12:15], s28 offen lds
    s_add_u32 m0, s29, 1024
    s_nop 0
    buffer_load_dwordx4 v53, s[12:15], s28 offen lds
    s_add_u32 m0, s29, 2048
    s_nop 0
    buffer_load_dwordx4 v54, s[12:15], s28 offen lds
    s_add_u32 m0, s29, 3072
    s_nop 0
    buffer_load_dwordx4 v55, s[12:15], s28 offen lds
    s_waitcnt vmcnt(36)
    s_barrier
    s_cmp_lg_u32 s19, 2
    s_cbranch_scc1 op_sk_124
    v_add_u32 v44, 147456, v56
    ds_read_b64_tr_b16 a[48:49], v44 offset:0
    ds_read_b64_tr_b16 a[50:51], v44 offset:2048
    ds_read_b64_tr_b16 a[52:53], v44 offset:4096
    ds_read_b64_tr_b16 a[54:55], v44 offset:6144
    ds_read_b64_tr_b16 a[56:57], v44 offset:8192
    ds_read_b64_tr_b16 a[58:59], v44 offset:10240
    ds_read_b64_tr_b16 a[60:61], v44 offset:12288
    ds_read_b64_tr_b16 a[62:63], v44 offset:14336
    v_add_u32 v44, 147456, v57
    ds_read_b64_tr_b16 a[176:177], v44 offset:0
    ds_read_b64_tr_b16 a[178:179], v44 offset:2048
    ds_read_b64_tr_b16 a[180:181], v44 offset:4096
    ds_read_b64_tr_b16 a[182:183], v44 offset:6144
    ds_read_b64_tr_b16 a[184:185], v44 offset:8192
    ds_read_b64_tr_b16 a[186:187], v44 offset:10240
    ds_read_b64_tr_b16 a[188:189], v44 offset:12288
    ds_read_b64_tr_b16 a[190:191], v44 offset:14336
    v_add_u32 v44, 147456, v58
    ds_read_b64_tr_b16 v[176:177], v44 offset:0
    ds_read_b64_tr_b16 v[178:179], v44 offset:2048
    ds_read_b64_tr_b16 v[180:181], v44 offset:4096
    ds_read_b64_tr_b16 v[182:183], v44 offset:6144
    ds_read_b64_tr_b16 v[184:185], v44 offset:8192
    ds_read_b64_tr_b16 v[186:187], v44 offset:10240
    ds_read_b64_tr_b16 v[188:189], v44 offset:12288
    ds_read_b64_tr_b16 v[190:191], v44 offset:14336
    s_waitcnt lgkmcnt(0)
op_sk_124:
    s_barrier
    s_mov_b32 s28, 4276224
    s_add_u32 s28, s28, s24
    s_lshl_b32 s29, s19, 12
    s_add_u32 s29, s29, 147456
    s_add_u32 m0, s29, 0
    s_nop 0
    buffer_load_dwordx4 v52, s[12:15], s28 offen lds
    s_add_u32 m0, s29, 1024
    s_nop 0
    buffer_load_dwordx4 v53, s[12:15], s28 offen lds
    s_add_u32 m0, s29, 2048
    s_nop 0
    buffer_load_dwordx4 v54, s[12:15], s28 offen lds
    s_add_u32 m0, s29, 3072
    s_nop 0
    buffer_load_dwordx4 v55, s[12:15], s28 offen lds
    s_waitcnt vmcnt(36)
    s_barrier
    s_cmp_lg_u32 s19, 2
    s_cbranch_scc1 op_sk_125
    v_add_u32 v44, 0, v56
    ds_read_b64_tr_b16 a[64:65], v44 offset:0
    ds_read_b64_tr_b16 a[66:67], v44 offset:2048
    ds_read_b64_tr_b16 a[68:69], v44 offset:4096
    ds_read_b64_tr_b16 a[70:71], v44 offset:6144
    ds_read_b64_tr_b16 a[72:73], v44 offset:8192
    ds_read_b64_tr_b16 a[74:75], v44 offset:10240
    ds_read_b64_tr_b16 a[76:77], v44 offset:12288
    ds_read_b64_tr_b16 a[78:79], v44 offset:14336
    v_add_u32 v44, 0, v57
    ds_read_b64_tr_b16 a[192:193], v44 offset:0
    ds_read_b64_tr_b16 a[194:195], v44 offset:2048
    ds_read_b64_tr_b16 a[196:197], v44 offset:4096
    ds_read_b64_tr_b16 a[198:199], v44 offset:6144
    ds_read_b64_tr_b16 a[200:201], v44 offset:8192
    ds_read_b64_tr_b16 a[202:203], v44 offset:10240
    ds_read_b64_tr_b16 a[204:205], v44 offset:12288
    ds_read_b64_tr_b16 a[206:207], v44 offset:14336
    v_add_u32 v44, 0, v58
    ds_read_b64_tr_b16 v[192:193], v44 offset:0
    ds_read_b64_tr_b16 v[194:195], v44 offset:2048
    ds_read_b64_tr_b16 v[196:197], v44 offset:4096
    ds_read_b64_tr_b16 v[198:199], v44 offset:6144
    ds_read_b64_tr_b16 v[200:201], v44 offset:8192
    ds_read_b64_tr_b16 v[202:203], v44 offset:10240
    ds_read_b64_tr_b16 v[204:205], v44 offset:12288
    ds_read_b64_tr_b16 v[206:207], v44 offset:14336
    s_waitcnt lgkmcnt(0)
op_sk_125:
    s_barrier
    s_mov_b32 s28, 4423680
    s_add_u32 s28, s28, s24
    s_lshl_b32 s29, s19, 12
    s_add_u32 s29, s29, 0
    s_add_u32 m0, s29, 0
    s_nop 0
    buffer_load_dwordx4 v52, s[12:15], s28 offen lds
    s_add_u32 m0, s29, 1024
    s_nop 0
    buffer_load_dwordx4 v53, s[12:15], s28 offen lds
    s_add_u32 m0, s29, 2048
    s_nop 0
    buffer_load_dwordx4 v54, s[12:15], s28 offen lds
    s_add_u32 m0, s29, 3072
    s_nop 0
    buffer_load_dwordx4 v55, s[12:15], s28 offen lds
    s_waitcnt vmcnt(36)
    s_barrier
    s_cmp_lg_u32 s19, 2
    s_cbranch_scc1 op_sk_126
    v_add_u32 v44, 16384, v56
    ds_read_b64_tr_b16 a[80:81], v44 offset:0
    ds_read_b64_tr_b16 a[82:83], v44 offset:2048
    ds_read_b64_tr_b16 a[84:85], v44 offset:4096
    ds_read_b64_tr_b16 a[86:87], v44 offset:6144
    ds_read_b64_tr_b16 a[88:89], v44 offset:8192
    ds_read_b64_tr_b16 a[90:91], v44 offset:10240
    ds_read_b64_tr_b16 a[92:93], v44 offset:12288
    ds_read_b64_tr_b16 a[94:95], v44 offset:14336
    v_add_u32 v44, 16384, v57
    ds_read_b64_tr_b16 a[208:209], v44 offset:0
    ds_read_b64_tr_b16 a[210:211], v44 offset:2048
    ds_read_b64_tr_b16 a[212:213], v44 offset:4096
    ds_read_b64_tr_b16 a[214:215], v44 offset:6144
    ds_read_b64_tr_b16 a[216:217], v44 offset:8192
    ds_read_b64_tr_b16 a[218:219], v44 offset:10240
    ds_read_b64_tr_b16 a[220:221], v44 offset:12288
    ds_read_b64_tr_b16 a[222:223], v44 offset:14336
    v_add_u32 v44, 16384, v58
    ds_read_b64_tr_b16 v[208:209], v44 offset:0
    ds_read_b64_tr_b16 v[210:211], v44 offset:2048
    ds_read_b64_tr_b16 v[212:213], v44 offset:4096
    ds_read_b64_tr_b16 v[214:215], v44 offset:6144
    ds_read_b64_tr_b16 v[216:217], v44 offset:8192
    ds_read_b64_tr_b16 v[218:219], v44 offset:10240
    ds_read_b64_tr_b16 v[220:221], v44 offset:12288
    ds_read_b64_tr_b16 v[222:223], v44 offset:14336
    s_waitcnt lgkmcnt(0)
op_sk_126:
    s_barrier
    s_mov_b32 s28, 4571136
    s_add_u32 s28, s28, s24
    s_lshl_b32 s29, s19, 12
    s_add_u32 s29, s29, 16384
    s_add_u32 m0, s29, 0
    s_nop 0
    buffer_load_dwordx4 v52, s[12:15], s28 offen lds
    s_add_u32 m0, s29, 1024
    s_nop 0
    buffer_load_dwordx4 v53, s[12:15], s28 offen lds
    s_add_u32 m0, s29, 2048
    s_nop 0
    buffer_load_dwordx4 v54, s[12:15], s28 offen lds
    s_add_u32 m0, s29, 3072
    s_nop 0
    buffer_load_dwordx4 v55, s[12:15], s28 offen lds
    s_waitcnt vmcnt(36)
    s_barrier
    s_cmp_lg_u32 s19, 2
    s_cbranch_scc1 op_sk_127
    v_add_u32 v44, 32768, v56
    ds_read_b64_tr_b16 a[96:97], v44 offset:0
    ds_read_b64_tr_b16 a[98:99], v44 offset:2048
    ds_read_b64_tr_b16 a[100:101], v44 offset:4096
    ds_read_b64_tr_b16 a[102:103], v44 offset:6144
    ds_read_b64_tr_b16 a[104:105], v44 offset:8192
    ds_read_b64_tr_b16 a[106:107], v44 offset:10240
    ds_read_b64_tr_b16 a[108:109], v44 offset:12288
    ds_read_b64_tr_b16 a[110:111], v44 offset:14336
    v_add_u32 v44, 32768, v57
    ds_read_b64_tr_b16 a[224:225], v44 offset:0
    ds_read_b64_tr_b16 a[226:227], v44 offset:2048
    ds_read_b64_tr_b16 a[228:229], v44 offset:4096
    ds_read_b64_tr_b16 a[230:231], v44 offset:6144
    ds_read_b64_tr_b16 a[232:233], v44 offset:8192
    ds_read_b64_tr_b16 a[234:235], v44 offset:10240
    ds_read_b64_tr_b16 a[236:237], v44 offset:12288
    ds_read_b64_tr_b16 a[238:239], v44 offset:14336
    v_add_u32 v44, 32768, v58
    ds_read_b64_tr_b16 v[224:225], v44 offset:0
    ds_read_b64_tr_b16 v[226:227], v44 offset:2048
    ds_read_b64_tr_b16 v[228:229], v44 offset:4096
    ds_read_b64_tr_b16 v[230:231], v44 offset:6144
    ds_read_b64_tr_b16 v[232:233], v44 offset:8192
    ds_read_b64_tr_b16 v[234:235], v44 offset:10240
    ds_read_b64_tr_b16 v[236:237], v44 offset:12288
    ds_read_b64_tr_b16 v[238:239], v44 offset:14336
    s_waitcnt lgkmcnt(0)
op_sk_127:
    s_barrier
    s_waitcnt vmcnt(32)
    s_barrier
    s_cmp_lg_u32 s19, 2
    s_cbranch_scc1 op_sk_128
    v_add_u32 v44, 49152, v56
    ds_read_b64_tr_b16 a[112:113], v44 offset:0
    ds_read_b64_tr_b16 a[114:115], v44 offset:2048
    ds_read_b64_tr_b16 a[116:117], v44 offset:4096
    ds_read_b64_tr_b16 a[118:119], v44 offset:6144
    ds_read_b64_tr_b16 a[120:121], v44 offset:8192
    ds_read_b64_tr_b16 a[122:123], v44 offset:10240
    ds_read_b64_tr_b16 a[124:125], v44 offset:12288
    ds_read_b64_tr_b16 a[126:127], v44 offset:14336
    v_add_u32 v44, 49152, v57
    ds_read_b64_tr_b16 a[240:241], v44 offset:0
    ds_read_b64_tr_b16 a[242:243], v44 offset:2048
    ds_read_b64_tr_b16 a[244:245], v44 offset:4096
    ds_read_b64_tr_b16 a[246:247], v44 offset:6144
    ds_read_b64_tr_b16 a[248:249], v44 offset:8192
    ds_read_b64_tr_b16 a[250:251], v44 offset:10240
    ds_read_b64_tr_b16 a[252:253], v44 offset:12288
    ds_read_b64_tr_b16 a[254:255], v44 offset:14336
    v_add_u32 v44, 49152, v58
    ds_read_b64_tr_b16 v[240:241], v44 offset:0
    ds_read_b64_tr_b16 v[242:243], v44 offset:2048
    ds_read_b64_tr_b16 v[244:245], v44 offset:4096
    ds_read_b64_tr_b16 v[246:247], v44 offset:6144
    ds_read_b64_tr_b16 v[248:249], v44 offset:8192
    ds_read_b64_tr_b16 v[250:251], v44 offset:10240
    ds_read_b64_tr_b16 v[252:253], v44 offset:12288
    ds_read_b64_tr_b16 v[254:255], v44 offset:14336
    s_waitcnt lgkmcnt(0)
op_sk_128:
    s_barrier
    s_waitcnt vmcnt(28)
    s_barrier
    s_cmp_lg_u32 s19, 3
    s_cbranch_scc1 op_sk_129
    v_add_u32 v44, 65536, v56
    ds_read_b64_tr_b16 a[0:1], v44 offset:0
    ds_read_b64_tr_b16 a[2:3], v44 offset:2048
    ds_read_b64_tr_b16 a[4:5], v44 offset:4096
    ds_read_b64_tr_b16 a[6:7], v44 offset:6144
    ds_read_b64_tr_b16 a[8:9], v44 offset:8192
    ds_read_b64_tr_b16 a[10:11], v44 offset:10240
    ds_read_b64_tr_b16 a[12:13], v44 offset:12288
    ds_read_b64_tr_b16 a[14:15], v44 offset:14336
    v_add_u32 v44, 65536, v57
    ds_read_b64_tr_b16 a[128:129], v44 offset:0
    ds_read_b64_tr_b16 a[130:131], v44 offset:2048
    ds_read_b64_tr_b16 a[132:133], v44 offset:4096
    ds_read_b64_tr_b16 a[134:135], v44 offset:6144
    ds_read_b64_tr_b16 a[136:137], v44 offset:8192
    ds_read_b64_tr_b16 a[138:139], v44 offset:10240
    ds_read_b64_tr_b16 a[140:141], v44 offset:12288
    ds_read_b64_tr_b16 a[142:143], v44 offset:14336
    v_add_u32 v44, 65536, v58
    ds_read_b64_tr_b16 v[128:129], v44 offset:0
    ds_read_b64_tr_b16 v[130:131], v44 offset:2048
    ds_read_b64_tr_b16 v[132:133], v44 offset:4096
    ds_read_b64_tr_b16 v[134:135], v44 offset:6144
    ds_read_b64_tr_b16 v[136:137], v44 offset:8192
    ds_read_b64_tr_b16 v[138:139], v44 offset:10240
    ds_read_b64_tr_b16 v[140:141], v44 offset:12288
    ds_read_b64_tr_b16 v[142:143], v44 offset:14336
    s_waitcnt lgkmcnt(0)
op_sk_129:
    s_barrier
    s_waitcnt vmcnt(24)
    s_barrier
    s_cmp_lg_u32 s19, 3
    s_cbranch_scc1 op_sk_130
    v_add_u32 v44, 81920, v56
    ds_read_b64_tr_b16 a[16:17], v44 offset:0
    ds_read_b64_tr_b16 a[18:19], v44 offset:2048
    ds_read_b64_tr_b16 a[20:21], v44 offset:4096
    ds_read_b64_tr_b16 a[22:23], v44 offset:6144
    ds_read_b64_tr_b16 a[24:25], v44 offset:8192
    ds_read_b64_tr_b16 a[26:27], v44 offset:10240
    ds_read_b64_tr_b16 a[28:29], v44 offset:12288
    ds_read_b64_tr_b16 a[30:31], v44 offset:14336
    v_add_u32 v44, 81920, v57
    ds_read_b64_tr_b16 a[144:145], v44 offset:0
    ds_read_b64_tr_b16 a[146:147], v44 offset:2048
    ds_read_b64_tr_b16 a[148:149], v44 offset:4096
    ds_read_b64_tr_b16 a[150:151], v44 offset:6144
    ds_read_b64_tr_b16 a[152:153], v44 offset:8192
    ds_read_b64_tr_b16 a[154:155], v44 offset:10240
    ds_read_b64_tr_b16 a[156:157], v44 offset:12288
    ds_read_b64_tr_b16 a[158:159], v44 offset:14336
    v_add_u32 v44, 81920, v58
    ds_read_b64_tr_b16 v[144:145], v44 offset:0
    ds_read_b64_tr_b16 v[146:147], v44 offset:2048
    ds_read_b64_tr_b16 v[148:149], v44 offset:4096
    ds_read_b64_tr_b16 v[150:151], v44 offset:6144
    ds_read_b64_tr_b16 v[152:153], v44 offset:8192
    ds_read_b64_tr_b16 v[154:155], v44 offset:10240
    ds_read_b64_tr_b16 v[156:157], v44 offset:12288
    ds_read_b64_tr_b16 v[158:159], v44 offset:14336
    s_waitcnt lgkmcnt(0)
op_sk_130:
    s_barrier
    s_waitcnt vmcnt(20)
    s_barrier
    s_cmp_lg_u32 s19, 3
    s_cbranch_scc1 op_sk_131
    v_add_u32 v44, 98304, v56
    ds_read_b64_tr_b16 a[32:33], v44 offset:0
    ds_read_b64_tr_b16 a[34:35], v44 offset:2048
    ds_read_b64_tr_b16 a[36:37], v44 offset:4096
    ds_read_b64_tr_b16 a[38:39], v44 offset:6144
    ds_read_b64_tr_b16 a[40:41], v44 offset:8192
    ds_read_b64_tr_b16 a[42:43], v44 offset:10240
    ds_read_b64_tr_b16 a[44:45], v44 offset:12288
    ds_read_b64_tr_b16 a[46:47], v44 offset:14336
    v_add_u32 v44, 98304, v57
    ds_read_b64_tr_b16 a[160:161], v44 offset:0
    ds_read_b64_tr_b16 a[162:163], v44 offset:2048
    ds_read_b64_tr_b16 a[164:165], v44 offset:4096
    ds_read_b64_tr_b16 a[166:167], v44 offset:6144
    ds_read_b64_tr_b16 a[168:169], v44 offset:8192
    ds_read_b64_tr_b16 a[170:171], v44 offset:10240
    ds_read_b64_tr_b16 a[172:173], v44 offset:12288
    ds_read_b64_tr_b16 a[174:175], v44 offset:14336
    v_add_u32 v44, 98304, v58
    ds_read_b64_tr_b16 v[160:161], v44 offset:0
    ds_read_b64_tr_b16 v[162:163], v44 offset:2048
    ds_read_b64_tr_b16 v[164:165], v44 offset:4096
    ds_read_b64_tr_b16 v[166:167], v44 offset:6144
    ds_read_b64_tr_b16 v[168:169], v44 offset:8192
    ds_read_b64_tr_b16 v[170:171], v44 offset:10240
    ds_read_b64_tr_b16 v[172:173], v44 offset:12288
    ds_read_b64_tr_b16 v[174:175], v44 offset:14336
    s_waitcnt lgkmcnt(0)
op_sk_131:
    s_barrier
    s_waitcnt vmcnt(16)
    s_barrier
    s_cmp_lg_u32 s19, 3
    s_cbranch_scc1 op_sk_132
    v_add_u32 v44, 114688, v56
    ds_read_b64_tr_b16 a[48:49], v44 offset:0
    ds_read_b64_tr_b16 a[50:51], v44 offset:2048
    ds_read_b64_tr_b16 a[52:53], v44 offset:4096
    ds_read_b64_tr_b16 a[54:55], v44 offset:6144
    ds_read_b64_tr_b16 a[56:57], v44 offset:8192
    ds_read_b64_tr_b16 a[58:59], v44 offset:10240
    ds_read_b64_tr_b16 a[60:61], v44 offset:12288
    ds_read_b64_tr_b16 a[62:63], v44 offset:14336
    v_add_u32 v44, 114688, v57
    ds_read_b64_tr_b16 a[176:177], v44 offset:0
    ds_read_b64_tr_b16 a[178:179], v44 offset:2048
    ds_read_b64_tr_b16 a[180:181], v44 offset:4096
    ds_read_b64_tr_b16 a[182:183], v44 offset:6144
    ds_read_b64_tr_b16 a[184:185], v44 offset:8192
    ds_read_b64_tr_b16 a[186:187], v44 offset:10240
    ds_read_b64_tr_b16 a[188:189], v44 offset:12288
    ds_read_b64_tr_b16 a[190:191], v44 offset:14336
    v_add_u32 v44, 114688, v58
    ds_read_b64_tr_b16 v[176:177], v44 offset:0
    ds_read_b64_tr_b16 v[178:179], v44 offset:2048
    ds_read_b64_tr_b16 v[180:181], v44 offset:4096
    ds_read_b64_tr_b16 v[182:183], v44 offset:6144
    ds_read_b64_tr_b16 v[184:185], v44 offset:8192
    ds_read_b64_tr_b16 v[186:187], v44 offset:10240
    ds_read_b64_tr_b16 v[188:189], v44 offset:12288
    ds_read_b64_tr_b16 v[190:191], v44 offset:14336
    s_waitcnt lgkmcnt(0)
op_sk_132:
    s_barrier
    s_waitcnt vmcnt(12)
    s_barrier
    s_cmp_lg_u32 s19, 3
    s_cbranch_scc1 op_sk_133
    v_add_u32 v44, 131072, v56
    ds_read_b64_tr_b16 a[64:65], v44 offset:0
    ds_read_b64_tr_b16 a[66:67], v44 offset:2048
    ds_read_b64_tr_b16 a[68:69], v44 offset:4096
    ds_read_b64_tr_b16 a[70:71], v44 offset:6144
    ds_read_b64_tr_b16 a[72:73], v44 offset:8192
    ds_read_b64_tr_b16 a[74:75], v44 offset:10240
    ds_read_b64_tr_b16 a[76:77], v44 offset:12288
    ds_read_b64_tr_b16 a[78:79], v44 offset:14336
    v_add_u32 v44, 131072, v57
    ds_read_b64_tr_b16 a[192:193], v44 offset:0
    ds_read_b64_tr_b16 a[194:195], v44 offset:2048
    ds_read_b64_tr_b16 a[196:197], v44 offset:4096
    ds_read_b64_tr_b16 a[198:199], v44 offset:6144
    ds_read_b64_tr_b16 a[200:201], v44 offset:8192
    ds_read_b64_tr_b16 a[202:203], v44 offset:10240
    ds_read_b64_tr_b16 a[204:205], v44 offset:12288
    ds_read_b64_tr_b16 a[206:207], v44 offset:14336
    v_add_u32 v44, 131072, v58
    ds_read_b64_tr_b16 v[192:193], v44 offset:0
    ds_read_b64_tr_b16 v[194:195], v44 offset:2048
    ds_read_b64_tr_b16 v[196:197], v44 offset:4096
    ds_read_b64_tr_b16 v[198:199], v44 offset:6144
    ds_read_b64_tr_b16 v[200:201], v44 offset:8192
    ds_read_b64_tr_b16 v[202:203], v44 offset:10240
    ds_read_b64_tr_b16 v[204:205], v44 offset:12288
    ds_read_b64_tr_b16 v[206:207], v44 offset:14336
    s_waitcnt lgkmcnt(0)
op_sk_133:
    s_barrier
    s_waitcnt vmcnt(8)
    s_barrier
    s_cmp_lg_u32 s19, 3
    s_cbranch_scc1 op_sk_134
    v_add_u32 v44, 147456, v56
    ds_read_b64_tr_b16 a[80:81], v44 offset:0
    ds_read_b64_tr_b16 a[82:83], v44 offset:2048
    ds_read_b64_tr_b16 a[84:85], v44 offset:4096
    ds_read_b64_tr_b16 a[86:87], v44 offset:6144
    ds_read_b64_tr_b16 a[88:89], v44 offset:8192
    ds_read_b64_tr_b16 a[90:91], v44 offset:10240
    ds_read_b64_tr_b16 a[92:93], v44 offset:12288
    ds_read_b64_tr_b16 a[94:95], v44 offset:14336
    v_add_u32 v44, 147456, v57
    ds_read_b64_tr_b16 a[208:209], v44 offset:0
    ds_read_b64_tr_b16 a[210:211], v44 offset:2048
    ds_read_b64_tr_b16 a[212:213], v44 offset:4096
    ds_read_b64_tr_b16 a[214:215], v44 offset:6144
    ds_read_b64_tr_b16 a[216:217], v44 offset:8192
    ds_read_b64_tr_b16 a[218:219], v44 offset:10240
    ds_read_b64_tr_b16 a[220:221], v44 offset:12288
    ds_read_b64_tr_b16 a[222:223], v44 offset:14336
    v_add_u32 v44, 147456, v58
    ds_read_b64_tr_b16 v[208:209], v44 offset:0
    ds_read_b64_tr_b16 v[210:211], v44 offset:2048
    ds_read_b64_tr_b16 v[212:213], v44 offset:4096
    ds_read_b64_tr_b16 v[214:215], v44 offset:6144
    ds_read_b64_tr_b16 v[216:217], v44 offset:8192
    ds_read_b64_tr_b16 v[218:219], v44 offset:10240
    ds_read_b64_tr_b16 v[220:221], v44 offset:12288
    ds_read_b64_tr_b16 v[222:223], v44 offset:14336
    s_waitcnt lgkmcnt(0)
op_sk_134:
    s_barrier
    s_waitcnt vmcnt(4)
    s_barrier
    s_cmp_lg_u32 s19, 3
    s_cbranch_scc1 op_sk_135
    v_add_u32 v44, 0, v56
    ds_read_b64_tr_b16 a[96:97], v44 offset:0
    ds_read_b64_tr_b16 a[98:99], v44 offset:2048
    ds_read_b64_tr_b16 a[100:101], v44 offset:4096
    ds_read_b64_tr_b16 a[102:103], v44 offset:6144
    ds_read_b64_tr_b16 a[104:105], v44 offset:8192
    ds_read_b64_tr_b16 a[106:107], v44 offset:10240
    ds_read_b64_tr_b16 a[108:109], v44 offset:12288
    ds_read_b64_tr_b16 a[110:111], v44 offset:14336
    v_add_u32 v44, 0, v57
    ds_read_b64_tr_b16 a[224:225], v44 offset:0
    ds_read_b64_tr_b16 a[226:227], v44 offset:2048
    ds_read_b64_tr_b16 a[228:229], v44 offset:4096
    ds_read_b64_tr_b16 a[230:231], v44 offset:6144
    ds_read_b64_tr_b16 a[232:233], v44 offset:8192
    ds_read_b64_tr_b16 a[234:235], v44 offset:10240
    ds_read_b64_tr_b16 a[236:237], v44 offset:12288
    ds_read_b64_tr_b16 a[238:239], v44 offset:14336
    v_add_u32 v44, 0, v58
    ds_read_b64_tr_b16 v[224:225], v44 offset:0
    ds_read_b64_tr_b16 v[226:227], v44 offset:2048
    ds_read_b64_tr_b16 v[228:229], v44 offset:4096
    ds_read_b64_tr_b16 v[230:231], v44 offset:6144
    ds_read_b64_tr_b16 v[232:233], v44 offset:8192
    ds_read_b64_tr_b16 v[234:235], v44 offset:10240
    ds_read_b64_tr_b16 v[236:237], v44 offset:12288
    ds_read_b64_tr_b16 v[238:239], v44 offset:14336
    s_waitcnt lgkmcnt(0)
op_sk_135:
    s_barrier
    s_waitcnt vmcnt(0)
    s_barrier
    s_cmp_lg_u32 s19, 3
    s_cbranch_scc1 op_sk_136
    v_add_u32 v44, 16384, v56
    ds_read_b64_tr_b16 a[112:113], v44 offset:0
    ds_read_b64_tr_b16 a[114:115], v44 offset:2048
    ds_read_b64_tr_b16 a[116:117], v44 offset:4096
    ds_read_b64_tr_b16 a[118:119], v44 offset:6144
    ds_read_b64_tr_b16 a[120:121], v44 offset:8192
    ds_read_b64_tr_b16 a[122:123], v44 offset:10240
    ds_read_b64_tr_b16 a[124:125], v44 offset:12288
    ds_read_b64_tr_b16 a[126:127], v44 offset:14336
    v_add_u32 v44, 16384, v57
    ds_read_b64_tr_b16 a[240:241], v44 offset:0
    ds_read_b64_tr_b16 a[242:243], v44 offset:2048
    ds_read_b64_tr_b16 a[244:245], v44 offset:4096
    ds_read_b64_tr_b16 a[246:247], v44 offset:6144
    ds_read_b64_tr_b16 a[248:249], v44 offset:8192
    ds_read_b64_tr_b16 a[250:251], v44 offset:10240
    ds_read_b64_tr_b16 a[252:253], v44 offset:12288
    ds_read_b64_tr_b16 a[254:255], v44 offset:14336
    v_add_u32 v44, 16384, v58
    ds_read_b64_tr_b16 v[240:241], v44 offset:0
    ds_read_b64_tr_b16 v[242:243], v44 offset:2048
    ds_read_b64_tr_b16 v[244:245], v44 offset:4096
    ds_read_b64_tr_b16 v[246:247], v44 offset:6144
    ds_read_b64_tr_b16 v[248:249], v44 offset:8192
    ds_read_b64_tr_b16 v[250:251], v44 offset:10240
    ds_read_b64_tr_b16 v[252:253], v44 offset:12288
    ds_read_b64_tr_b16 v[254:255], v44 offset:14336
    s_waitcnt lgkmcnt(0)
op_sk_136:
    s_barrier
L_ol:
    s_lshr_b32 s38, s20, 1
    s_lshl_b32 s38, s38, 2
    s_add_u32 s38, s38, 65012224
    s_cmp_lg_u32 s19, 0
    s_cbranch_scc1 op_nw_137
    s_cmp_lg_u32 s99, 0
    s_cbranch_scc1 pd_139
    s_mov_b32 s29, s38
    s_mov_b32 s30, 0
    v_mov_b32 v30, 0
pw_138:
    buffer_load_dword v31, v30, s[4:7], s29 offen sc1
    s_waitcnt vmcnt(0)
    v_readfirstlane_b32 s28, v31
    s_nop 0
    s_cmp_ge_u32 s28, 32
    s_cbranch_scc1 pd_139
    s_sleep 16
    s_add_u32 s30, s30, 1
    s_cmp_lt_u32 s30, 0x100000
    s_cbranch_scc1 pw_138
    s_mov_b32 s99, 1
pd_139:
op_nw_137:
    s_barrier
    s_lshl_b32 s28, s20, 5
    s_lshl_b32 s29, s19, 3
    s_add_u32 s28, s28, s29
    s_lshl_b32 s28, s28, 12
    s_add_u32 s28, s28, 67108864
    s_add_u32 s29, s28, 0
    buffer_load_dwordx4 v[32:35], v0, s[4:7], s29 offen offset:0 sc1
    buffer_load_dwordx4 v[36:39], v0, s[4:7], s29 offen offset:1024 sc1
    buffer_load_dwordx4 v[40:43], v0, s[4:7], s29 offen offset:2048 sc1
    buffer_load_dwordx4 v[44:47], v0, s[4:7], s29 offen offset:3072 sc1
    s_add_u32 s29, s28, 4096
    buffer_load_dwordx4 v[48:51], v0, s[4:7], s29 offen offset:0 sc1
    buffer_load_dwordx4 v[52:55], v0, s[4:7], s29 offen offset:1024 sc1
    buffer_load_dwordx4 v[56:59], v0, s[4:7], s29 offen offset:2048 sc1
    buffer_load_dwordx4 v[60:63], v0, s[4:7], s29 offen offset:3072 sc1
    s_add_u32 s29, s28, 8192
    buffer_load_dwordx4 v[64:67], v0, s[4:7], s29 offen offset:0 sc1
    buffer_load_dwordx4 v[68:71], v0, s[4:7], s29 offen offset:1024 sc1
    buffer_load_dwordx4 v[72:75], v0, s[4:7], s29 offen offset:2048 sc1
    buffer_load_dwordx4 v[76:79], v0, s[4:7], s29 offen offset:3072 sc1
    s_add_u32 s29, s28, 12288
    buffer_load_dwordx4 v[80:83], v0, s[4:7], s29 offen offset:0 sc1
    buffer_load_dwordx4 v[84:87], v0, s[4:7], s29 offen offset:1024 sc1
    buffer_load_dwordx4 v[88:91], v0, s[4:7], s29 offen offset:2048 sc1
    buffer_load_dwordx4 v[92:95], v0, s[4:7], s29 offen offset:3072 sc1
    s_add_u32 s29, s28, 16384
    buffer_load_dwordx4 v[96:99], v0, s[4:7], s29 offen offset:0 sc1
    buffer_load_dwordx4 v[100:103], v0, s[4:7], s29 offen offset:1024 sc1
    buffer_load_dwordx4 v[104:107], v0, s[4:7], s29 offen offset:2048 sc1
    buffer_load_dwordx4 v[108:111], v0, s[4:7], s29 offen offset:3072 sc1
    s_waitcnt vmcnt(19)
    v_mfma_f32_16x16x32_bf16 v[112:115], v[32:35], a[0:3], 0
    v_mfma_f32_16x16x32_bf16 v[116:119], v[32:35], a[128:131], 0
    v_mfma_f32_16x16x32_bf16 v[120:123], v[32:35], v[128:131], 0
    s_add_u32 s29, s28, 20480
    buffer_load_dwordx4 v[32:35], v0, s[4:7], s29 offen offset:0 sc1
    s_waitcnt vmcnt(19)
    v_mfma_f32_16x16x32_bf16 v[112:115], v[36:39], a[4:7], v[112:115]
    v_mfma_f32_16x16x32_bf16 v[116:119], v[36:39], a[132:135], v[116:119]
    v_mfma_f32_16x16x32_bf16 v[120:123], v[36:39], v[132:135], v[120:123]
    buffer_load_dwordx4 v[36:39], v0, s[4:7], s29 offen offset:1024 sc1
    s_waitcnt vmcnt(19)
    v_mfma_f32_16x16x32_bf16 v[112:115], v[40:43], a[8:11], v[112:115]
    v_mfma_f32_16x16x32_bf16 v[116:119], v[40:43], a[136:139], v[116:119]
    v_mfma_f32_16x16x32_bf16 v[120:123], v[40:43], v[136:139], v[120:123]
    buffer_load_dwordx4 v[40:43], v0, s[4:7], s29 offen offset:2048 sc1
    s_waitcnt vmcnt(19)
    v_mfma_f32_16x16x32_bf16 v[112:115], v[44:47], a[12:15], v[112:115]
    v_mfma_f32_16x16x32_bf16 v[116:119], v[44:47], a[140:143], v[116:119]
    v_mfma_f32_16x16x32_bf16 v[120:123], v[44:47], v[140:143], v[120:123]
    buffer_load_dwordx4 v[44:47], v0, s[4:7], s29 offen offset:3072 sc1
    s_waitcnt vmcnt(19)
    v_mfma_f32_16x16x32_bf16 v[112:115], v[48:51], a[16:19], v[112:115]
    v_mfma_f32_16x16x32_bf16 v[116:119], v[48:51], a[144:147], v[116:119]
    v_mfma_f32_16x16x32_bf16 v[120:123], v[48:51], v[144:147], v[120:123]
    s_add_u32 s29, s28, 24576
    buffer_load_dwordx4 v[48:51], v0, s[4:7], s29 offen offset:0 sc1
    s_waitcnt vmcnt(19)
    v_mfma_f32_16x16x32_bf16 v[112:115], v[52:55], a[20:23], v[112:115]
    v_mfma_f32_16x16x32_bf16 v[116:119], v[52:55], a[148:151], v[116:119]
    v_mfma_f32_16x16x32_bf16 v[120:123], v[52:55], v[148:151], v[120:123]
    buffer_load_dwordx4 v[52:55], v0, s[4:7], s29 offen offset:1024 sc1
    s_waitcnt vmcnt(19)
    v_mfma_f32_16x16x32_bf16 v[112:115], v[56:59], a[24:27], v[112:115]
    v_mfma_f32_16x16x32_bf16 v[116:119], v[56:59], a[152:155], v[116:119]
    v_mfma_f32_16x16x32_bf16 v[120:123], v[56:59], v[152:155], v[120:123]
    buffer_load_dwordx4 v[56:59], v0, s[4:7], s29 offen offset:2048 sc1
    s_waitcnt vmcnt(19)
    v_mfma_f32_16x16x32_bf16 v[112:115], v[60:63], a[28:31], v[112:115]
    v_mfma_f32_16x16x32_bf16 v[116:119], v[60:63], a[156:159], v[116:119]
    v_mfma_f32_16x16x32_bf16 v[120:123], v[60:63], v[156:159], v[120:123]
    buffer_load_dwordx4 v[60:63], v0, s[4:7], s29 offen offset:3072 sc1
    s_waitcnt vmcnt(19)
    v_mfma_f32_16x16x32_bf16 v[112:115], v[64:67], a[32:35], v[112:115]
    v_mfma_f32_16x16x32_bf16 v[116:119], v[64:67], a[160:163], v[116:119]
    v_mfma_f32_16x16x32_bf16 v[120:123], v[64:67], v[160:163], v[120:123]
    s_add_u32 s29, s28, 28672
    buffer_load_dwordx4 v[64:67], v0, s[4:7], s29 offen offset:0 sc1
    s_waitcnt vmcnt(19)
    v_mfma_f32_16x16x32_bf16 v[112:115], v[68:71], a[36:39], v[112:115]
    v_mfma_f32_16x16x32_bf16 v[116:119], v[68:71], a[164:167], v[116:119]
    v_mfma_f32_16x16x32_bf16 v[120:123], v[68:71], v[164:167], v[120:123]
    buffer_load_dwordx4 v[68:71], v0, s[4:7], s29 offen offset:1024 sc1
    s_waitcnt vmcnt(19)
    v_mfma_f32_16x16x32_bf16 v[112:115], v[72:75], a[40:43], v[112:115]
    v_mfma_f32_16x16x32_bf16 v[116:119], v[72:75], a[168:171], v[116:119]
    v_mfma_f32_16x16x32_bf16 v[120:123], v[72:75], v[168:171], v[120:123]
    buffer_load_dwordx4 v[72:75], v0, s[4:7], s29 offen offset:2048 sc1
    s_waitcnt vmcnt(19)
    v_mfma_f32_16x16x32_bf16 v[112:115], v[76:79], a[44:47], v[112:115]
    v_mfma_f32_16x16x32_bf16 v[116:119], v[76:79], a[172:175], v[116:119]
    v_mfma_f32_16x16x32_bf16 v[120:123], v[76:79], v[172:175], v[120:123]
    buffer_load_dwordx4 v[76:79], v0, s[4:7], s29 offen offset:3072 sc1
    s_waitcnt vmcnt(19)
    v_mfma_f32_16x16x32_bf16 v[112:115], v[80:83], a[48:51], v[112:115]
    v_mfma_f32_16x16x32_bf16 v[116:119], v[80:83], a[176:179], v[116:119]
    v_mfma_f32_16x16x32_bf16 v[120:123], v[80:83], v[176:179], v[120:123]
    s_waitcnt vmcnt(18)
    v_mfma_f32_16x16x32_bf16 v[112:115], v[84:87], a[52:55], v[112:115]
    v_mfma_f32_16x16x32_bf16 v[116:119], v[84:87], a[180:183], v[116:119]
    v_mfma_f32_16x16x32_bf16 v[120:123], v[84:87], v[180:183], v[120:123]
    s_waitcnt vmcnt(17)
    v_mfma_f32_16x16x32_bf16 v[112:115], v[88:91], a[56:59], v[112:115]
    v_mfma_f32_16x16x32_bf16 v[116:119], v[88:91], a[184:187], v[116:119]
    v_mfma_f32_16x16x32_bf16 v[120:123], v[88:91], v[184:187], v[120:123]
    s_waitcnt vmcnt(16)
    v_mfma_f32_16x16x32_bf16 v[112:115], v[92:95], a[60:63], v[112:115]
    v_mfma_f32_16x16x32_bf16 v[116:119], v[92:95], a[188:191], v[116:119]
    v_mfma_f32_16x16x32_bf16 v[120:123], v[92:95], v[188:191], v[120:123]
    s_waitcnt vmcnt(15)
    v_mfma_f32_16x16x32_bf16 v[112:115], v[96:99], a[64:67], v[112:115]
    v_mfma_f32_16x16x32_bf16 v[116:119], v[96:99], a[192:195], v[116:119]
    v_mfma_f32_16x16x32_bf16 v[120:123], v[96:99], v[192:195], v[120:123]
    s_waitcnt vmcnt(14)
    v_mfma_f32_16x16x32_bf16 v[112:115], v[100:103], a[68:71], v[112:115]
    v_mfma_f32_16x16x32_bf16 v[116:119], v[100:103], a[196:199], v[116:119]
    v_mfma_f32_16x16x32_bf16 v[120:123], v[100:103], v[196:199], v[120:123]
    s_waitcnt vmcnt(13)
    v_mfma_f32_16x16x32_bf16 v[112:115], v[104:107], a[72:75], v[112:115]
    v_mfma_f32_16x16x32_bf16 v[116:119], v[104:107], a[200:203], v[116:119]
    v_mfma_f32_16x16x32_bf16 v[120:123], v[104:107], v[200:203], v[120:123]
    s_waitcnt vmcnt(12)
    v_mfma_f32_16x16x32_bf16 v[112:115], v[108:111], a[76:79], v[112:115]
    v_mfma_f32_16x16x32_bf16 v[116:119], v[108:111], a[204:207], v[116:119]
    v_mfma_f32_16x16x32_bf16 v[120:123], v[108:111], v[204:207], v[120:123]
    s_waitcnt vmcnt(11)
    v_mfma_f32_16x16x32_bf16 v[112:115], v[32:35], a[80:83], v[112:115]
    v_mfma_f32_16x16x32_bf16 v[116:119], v[32:35], a[208:211], v[116:119]
    v_mfma_f32_16x16x32_bf16 v[120:123], v[32:35], v[208:211], v[120:123]
    s_waitcnt vmcnt(10)
    v_mfma_f32_16x16x32_bf16 v[112:115], v[36:39], a[84:87], v[112:115]
    v_mfma_f32_16x16x32_bf16 v[116:119], v[36:39], a[212:215], v[116:119]
    v_mfma_f32_16x16x32_bf16 v[120:123], v[36:39], v[212:215], v[120:123]
    s_waitcnt vmcnt(9)
    v_mfma_f32_16x16x32_bf16 v[112:115], v[40:43], a[88:91], v[112:115]
    v_mfma_f32_16x16x32_bf16 v[116:119], v[40:43], a[216:219], v[116:119]
    v_mfma_f32_16x16x32_bf16 v[120:123], v[40:43], v[216:219], v[120:123]
    s_waitcnt vmcnt(8)
    v_mfma_f32_16x16x32_bf16 v[112:115], v[44:47], a[92:95], v[112:115]
    v_mfma_f32_16x16x32_bf16 v[116:119], v[44:47], a[220:223], v[116:119]
    v_mfma_f32_16x16x32_bf16 v[120:123], v[44:47], v[220:223], v[120:123]
    s_waitcnt vmcnt(7)
    v_mfma_f32_16x16x32_bf16 v[112:115], v[48:51], a[96:99], v[112:115]
    v_mfma_f32_16x16x32_bf16 v[116:119], v[48:51], a[224:227], v[116:119]
    v_mfma_f32_16x16x32_bf16 v[120:123], v[48:51], v[224:227], v[120:123]
    s_waitcnt vmcnt(6)
    v_mfma_f32_16x16x32_bf16 v[112:115], v[52:55], a[100:103], v[112:115]
    v_mfma_f32_16x16x32_bf16 v[116:119], v[52:55], a[228:231], v[116:119]
    v_mfma_f32_16x16x32_bf16 v[120:123], v[52:55], v[228:231], v[120:123]
    s_waitcnt vmcnt(5)
    v_mfma_f32_16x16x32_bf16 v[112:115], v[56:59], a[104:107], v[112:115]
    v_mfma_f32_16x16x32_bf16 v[116:119], v[56:59], a[232:235], v[116:119]
    v_mfma_f32_16x16x32_bf16 v[120:123], v[56:59], v[232:235], v[120:123]
    s_waitcnt vmcnt(4)
    v_mfma_f32_16x16x32_bf16 v[112:115], v[60:63], a[108:111], v[112:115]
    v_mfma_f32_16x16x32_bf16 v[116:119], v[60:63], a[236:239], v[116:119]
    v_mfma_f32_16x16x32_bf16 v[120:123], v[60:63], v[236:239], v[120:123]
    s_waitcnt vmcnt(3)
    v_mfma_f32_16x16x32_bf16 v[112:115], v[64:67], a[112:115], v[112:115]
    v_mfma_f32_16x16x32_bf16 v[116:119], v[64:67], a[240:243], v[116:119]
    v_mfma_f32_16x16x32_bf16 v[120:123], v[64:67], v[240:243], v[120:123]
    s_waitcnt vmcnt(2)
    v_mfma_f32_16x16x32_bf16 v[112:115], v[68:71], a[116:119], v[112:115]
    v_mfma_f32_16x16x32_bf16 v[116:119], v[68:71], a[244:247], v[116:119]
    v_mfma_f32_16x16x32_bf16 v[120:123], v[68:71], v[244:247], v[120:123]
    s_waitcnt vmcnt(1)
    v_mfma_f32_16x16x32_bf16 v[112:115], v[72:75], a[120:123], v[112:115]
    v_mfma_f32_16x16x32_bf16 v[116:119], v[72:75], a[248:251], v[116:119]
    v_mfma_f32_16x16x32_bf16 v[120:123], v[72:75], v[248:251], v[120:123]
    s_waitcnt vmcnt(0)
    v_mfma_f32_16x16x32_bf16 v[112:115], v[76:79], a[124:127], v[112:115]
    v_mfma_f32_16x16x32_bf16 v[116:119], v[76:79], a[252:255], v[116:119]
    v_mfma_f32_16x16x32_bf16 v[120:123], v[76:79], v[252:255], v[120:123]
    s_mul_i32 s29, s19, 3072
    v_add_u32 v1, s29, v0
    s_barrier
    ds_write_b128 v1, v[112:115] offset:0
    s_nop 0
    ds_write_b128 v1, v[116:119] offset:1024
    s_nop 1
    ds_write_b128 v1, v[120:123] offset:2048
    s_waitcnt lgkmcnt(0)
    s_barrier
    s_cmp_ge_u32 s19, 3
    s_cbranch_scc1 op_r_140
    s_lshl_b32 s30, s19, 10
    v_add_u32 v1, s30, v0
    ds_read_b128 v[32:35], v1 offset:0
    ds_read_b128 v[36:39], v1 offset:3072
    ds_read_b128 v[40:43], v1 offset:6144
    ds_read_b128 v[44:47], v1 offset:9216
    s_waitcnt lgkmcnt(2)
    v_add_f32 v32, v32, v36
    s_waitcnt lgkmcnt(0)
    v_add_f32 v40, v40, v44
    v_add_f32 v32, v32, v40
    v_add_f32 v33, v33, v37
    v_add_f32 v41, v41, v45
    v_add_f32 v33, v33, v41
    v_add_f32 v34, v34, v38
    v_add_f32 v42, v42, v46
    v_add_f32 v34, v34, v42
    v_add_f32 v35, v35, v39
    v_add_f32 v43, v43, v47
    v_add_f32 v35, v35, v43
    v_mov_b32_dpp v36, v32 quad_perm:[1,0,3,2] row_mask:0xf bank_mask:0xf
    v_cvt_pk_bf16_f32 v40, v32, v36
    v_mov_b32_dpp v37, v33 quad_perm:[1,0,3,2] row_mask:0xf bank_mask:0xf
    v_cvt_pk_bf16_f32 v41, v33, v37
    v_mov_b32_dpp v38, v34 quad_perm:[1,0,3,2] row_mask:0xf bank_mask:0xf
    v_cvt_pk_bf16_f32 v42, v34, v38
    v_mov_b32_dpp v39, v35 quad_perm:[1,0,3,2] row_mask:0xf bank_mask:0xf
    v_cvt_pk_bf16_f32 v43, v35, v39
    s_lshl_b32 s29, s20, 4
    s_mul_i32 s29, s29, 2304
    s_lshl_b32 s31, s19, 5
    s_add_u32 s29, s29, s31
    s_add_u32 s29, s29, s24
    s_mov_b64 exec, s[70:71]
    buffer_store_dword v40, v4, s[40:43], s29 offen
    buffer_store_dword v41, v5, s[40:43], s29 offen
    buffer_store_dword v42, v6, s[40:43], s29 offen
    buffer_store_dword v43, v7, s[40:43], s29 offen
    s_mov_b64 exec, -1
op_r_140:
    s_add_u32 s20, s20, 4
    s_cmp_lt_u32 s20, 128
    s_cbranch_scc1 L_ol
    s_waitcnt vmcnt(0)
    s_branch L_end
L_end:
    s_endpgm
.section .rodata,"a"
.p2align 6
.amdhsa_kernel concat_heads__memory_aug_recurrent_mem_tr__grouped_kv_mqa__prompt_kernel
  .amdhsa_next_free_vgpr 512
  .amdhsa_next_free_sgpr 102
  .amdhsa_accum_offset 256
  .amdhsa_group_segment_fixed_size 0
  .amdhsa_kernarg_size 120
  .amdhsa_user_sgpr_count 2
  .amdhsa_user_sgpr_kernarg_segment_ptr 1
  .amdhsa_system_sgpr_workgroup_id_x 1
.end_amdhsa_kernel
```
